```python
import torch

def _softmax(x, axis=-1):
    return torch.softmax(x, dim=axis)
def _gelu(x):
    return torch.nn.functional.gelu(x, approximate="tanh")
def _silu(x):
    return torch.nn.functional.silu(x)
def _sigmoid(x):
    return torch.sigmoid(x)
def _layernorm(x, axis=-1, eps=1e-5):
    m = x.mean(dim=axis, keepdim=True)
    v = x.var(dim=axis, keepdim=True, unbiased=False)
    return (x - m) / torch.sqrt(v + eps)
def _scatter_add(tgt, idx, src, axis=0):
    return tgt.clone().index_add_(axis, idx, src)
def _segment_sum(src, seg, n):
    out = torch.zeros((n,) + src.shape[1:], dtype=src.dtype)
    return out.index_add_(0, seg, src)
def _pad(x, pw):
    flat = tuple(v for pair in reversed(pw) for v in pair)
    return torch.nn.functional.pad(x, flat)

kernel_name = 'concat_heads__ssm_conv_s4__softmax_full_mha__prompt'

def setup_inputs():

    _w = (lambda a: (lambda t: t.to(torch.bfloat16) if t.is_floating_point() else t)(torch.as_tensor(a)))
    def _A_setup():
        B, L, D, N = 1, 2048, 576, 128
        A_re = -(lambda _x: torch.exp(torch.as_tensor(_x)))((lambda *s: torch.randn(*s, dtype=torch.bfloat16) * 6.4)(D, N))
        A_im = torch.pi * (lambda *s: torch.randn(*s, dtype=torch.bfloat16) * 0.1)(D, N)
        B_re = (lambda *s: torch.randn(*s, dtype=torch.bfloat16) * 0.2)(D, N)
        B_im = (lambda *s: torch.randn(*s, dtype=torch.bfloat16) * 0.2)(D, N)
        C_re = (lambda *s: torch.randn(*s, dtype=torch.bfloat16) * 0.2)(D, N)
        C_im = (lambda *s: torch.randn(*s, dtype=torch.bfloat16) * 0.2)(D, N)
        log_dt = (lambda *s: torch.randn(*s, dtype=torch.bfloat16) * 0.1)(D) * 0.5 - 4.0
        Dskip = (lambda *s: torch.randn(*s, dtype=torch.bfloat16) * 0.1)(D)
        return {
            "u": _w((lambda *s: torch.randn(*s, dtype=torch.bfloat16) * 0.05)(B, L, D)),
            "A_re": _w(A_re),
            "A_im": _w(A_im),
            "B_re": _w(B_re),
            "B_im": _w(B_im),
            "C_re": _w(C_re),
            "C_im": _w(C_im),
            "log_dt": _w(log_dt),
            "Dskip": _w(Dskip),
        }
    _A_in = _A_setup()

    def _B_setup():
        B, S, D = 1, 2048, 576
        return {
            "x": _w((lambda *s: torch.randn(*s, dtype=torch.bfloat16) * 0.2)(B, S, D)),
            "wqkv": _w((lambda *s: torch.randn(*s, dtype=torch.bfloat16) * 0.2)(D, 3 * D)),
            "wo": _w((lambda *s: torch.randn(*s, dtype=torch.bfloat16) * 0.05)(D, D)),
        }
    _B_in = _B_setup()

    return {
        "A_u": _A_in["u"],
        "A_A_re": _A_in["A_re"],
        "A_A_im": _A_in["A_im"],
        "A_B_re": _A_in["B_re"],
        "A_B_im": _A_in["B_im"],
        "A_C_re": _A_in["C_re"],
        "A_C_im": _A_in["C_im"],
        "A_log_dt": _A_in["log_dt"],
        "A_Dskip": _A_in["Dskip"],
        "B_x": _B_in["x"],
        "B_wqkv": _B_in["wqkv"],
        "B_wo": _B_in["wo"],
    }

def reference(A_u, A_A_re, A_A_im, A_B_re, A_B_im, A_C_re, A_C_im, A_log_dt, A_Dskip, B_x, B_wqkv, B_wo):
    def _A_ref(u, A_re, A_im, B_re, B_im, C_re, C_im, log_dt, Dskip):
        Bsz, L, D = u.shape
        dt = torch.exp(log_dt)[:, None]
        A = A_re + 1j * A_im
        Bc = B_re + 1j * B_im
        Cc = C_re + 1j * C_im
        logdA = dt * A
        dB = dt * Bc
        l = (lambda x, dt: x.to(dt))(torch.arange(L), A_re.dtype)
        P = torch.exp(logdA[:, :, None] * l[None, None, :])
        K = torch.einsum("dn,dnl,dn->dl", Cc, P, dB).real
        L2 = 2 * L
        Kp = _pad(K, ((0, 0), (0, L)))
        up = (lambda x, *d: x.permute(*d))(u, 0, 2, 1)
        up = _pad(up, ((0, 0), (0, 0), (0, L)))
        Kf = (lambda x, axes=(-2,-1): torch.fft.rfft2(x.float(), dim=axes))(Kp[:, None, :], axes=(-2, -1))
        Uf = (lambda x, axes=(-2,-1): torch.fft.rfft2(x.float(), dim=axes))(up[:, :, None, :], axes=(-2, -1))
        Yf = Uf * Kf[None, :, :, :]
        y = (lambda x, s, axes=(-2,-1): torch.fft.irfft2(x, s=s, dim=axes).to(torch.bfloat16))(Yf, (1, L2), axes=(-2, -1))[:, :, 0, :L]
        y = (lambda x, *d: x.permute(*d))(y, 0, 2, 1) + u * Dskip[None, None, :]
        return y

    def _B_ref(x, wqkv, wo):
        B, S, D = x.shape
        H = 32; Dh = D // H
        qkv = (lambda x, *d: x.permute(*d))((x @ wqkv).reshape(B, S, 3, H, Dh), 2, 0, 3, 1, 4)
        q, k, v = qkv[0], qkv[1], qkv[2]
        scale = Dh ** -0.5
        scores = torch.einsum("bhqd,bhkd->bhqk", q, k) * scale
        p = _softmax(scores, axis=-1)
        o = torch.einsum("bhqk,bhkd->bhqd", p, v)
        return (lambda x, *d: x.permute(*d))(o, 0, 2, 1, 3).reshape(B, S, D) @ wo

    a = _A_ref(A_u, A_A_re, A_A_im, A_B_re, A_B_im, A_C_re, A_C_im, A_log_dt, A_Dskip)
    b = _B_ref(B_x, B_wqkv, B_wo)
    return torch.concatenate([a, b], axis=-1)
```

```asm
; @launch kernel=k1_kernel grid=(454,1,1) block=(512,1,1) lds=81920
; @launch kernel=k2_kernel grid=(256,1,1) block=(768,1,1) lds=163840
.amdgcn_target "amdgcn-amd-amdhsa--gfx950"
.text
.globl k1_kernel
.p2align 8
.type k1_kernel,@function
k1_kernel:
    s_cmp_ge_u32 s2, 454
    s_cbranch_scc1 L_k1_kernel_end
    s_load_dwordx4 s[4:7], s[0:1], 72
    s_load_dwordx2 s[8:9], s[0:1], 112
    s_load_dwordx8 s[36:43], s[0:1], 0
    s_load_dwordx8 s[44:51], s[0:1], 32
    v_lshrrev_b32 v1, 6, v0
    v_and_b32 v2, 63, v0
    s_and_b32 s25, s2, 7
    v_readfirstlane_b32 s24, v1
    s_lshr_b32 s26, s2, 3
    s_sub_u32 s26, s26, 24
    s_cmp_lt_u32 s25, 6
    s_cselect_b32 s27, 1, 0
    s_sub_u32 s26, s26, s27
    s_and_b32 s27, s25, 3
    s_lshl_b32 s27, s27, 2
    s_and_b32 s28, s26, 3
    s_add_u32 s27, s27, s28
    s_lshr_b32 s28, s25, 2
    s_lshl_b32 s28, s28, 3
    s_lshr_b32 s29, s26, 2
    s_add_u32 s28, s28, s29
    s_and_b32 s29, s24, 3
    s_lshr_b32 s30, s24, 2
    s_waitcnt lgkmcnt(0)

    s_mov_b32 s20, s8
    s_mov_b32 s21, s9
    s_mov_b32 s22, 67108864
    s_mov_b32 s23, 0x20000
    s_cmp_ge_u32 s2, 198
    s_cbranch_scc1 L_gemm_100001
    s_mov_b32 s31, s2
    s_cmp_ge_u32 s31, 144
    s_cbranch_scc1 L_tr_100002
    s_lshl_b32 s52, s31, 2
    s_lshr_b32 s54, s24, 1
    s_add_u32 s52, s52, s54
    s_and_b32 s53, s24, 1
    s_lshl_b32 s55, s52, 8
    s_lshl_b32 s56, s53, 7
    s_add_u32 s55, s55, s56
    v_lshlrev_b32 v5, 1, v2
    s_lshl_b32 s56, s52, 1
    v_mov_b32 v6, s56

    s_mov_b32 s12, s38
    s_mov_b32 s13, s39
    s_mov_b32 s14, 147456
    s_mov_b32 s15, 0x20000
    buffer_load_ushort v8, v5, s[12:15], s55 offen
    s_mov_b32 s12, s40
    s_mov_b32 s13, s41
    s_mov_b32 s14, 147456
    s_mov_b32 s15, 0x20000
    buffer_load_ushort v9, v5, s[12:15], s55 offen
    s_mov_b32 s12, s42
    s_mov_b32 s13, s43
    s_mov_b32 s14, 147456
    s_mov_b32 s15, 0x20000
    buffer_load_ushort v10, v5, s[12:15], s55 offen
    s_mov_b32 s12, s44
    s_mov_b32 s13, s45
    s_mov_b32 s14, 147456
    s_mov_b32 s15, 0x20000
    buffer_load_ushort v11, v5, s[12:15], s55 offen
    s_mov_b32 s12, s46
    s_mov_b32 s13, s47
    s_mov_b32 s14, 147456
    s_mov_b32 s15, 0x20000
    buffer_load_ushort v12, v5, s[12:15], s55 offen
    s_mov_b32 s12, s48
    s_mov_b32 s13, s49
    s_mov_b32 s14, 147456
    s_mov_b32 s15, 0x20000
    buffer_load_ushort v13, v5, s[12:15], s55 offen
    s_mov_b32 s12, s50
    s_mov_b32 s13, s51
    s_mov_b32 s14, 1152
    s_mov_b32 s15, 0x20000
    buffer_load_ushort v14, v6, s[12:15], 0 offen
    s_mul_i32 s57, s24, 9216
    v_lshlrev_b32 v5, 4, v2
    v_add_u32 v5, s57, v5
    v_lshrrev_b32 v6, 2, v2
    v_lshlrev_b32 v6, 4, v6
    v_bfe_u32 v7, v2, 1, 1
    v_mul_u32_u24 v7, 1152, v7
    v_add_u32 v6, v6, v7
    v_and_b32 v7, 1, v2
    v_lshlrev_b32 v7, 3, v7
    v_add_u32 v6, v6, v7
    v_add_u32 v6, s57, v6
    s_setprio 2
    s_waitcnt vmcnt(0)

    v_lshlrev_b32 v8, 16, v8
    v_lshlrev_b32 v9, 16, v9
    v_lshlrev_b32 v10, 16, v10
    v_lshlrev_b32 v11, 16, v11
    v_lshlrev_b32 v12, 16, v12
    v_lshlrev_b32 v13, 16, v13
    v_lshlrev_b32 v14, 16, v14
    v_mul_f32 v14, 0x3fb8aa3b, v14
    v_exp_f32 v14, v14
    s_nop 0
    v_cvt_pk_bf16_f32 v14, v14, v14
    v_lshlrev_b32 v14, 16, v14
    v_mul_f32 v15, v14, v8
    v_mul_f32 v15, 0x3fb8aa3b, v15
    v_mul_f32 v16, v14, v9
    v_mul_f32 v16, 0x3e22f983, v16
    v_mul_f32 v18, v14, v10
    v_mul_f32 v19, v14, v11
    v_mov_b32 v20, v12
    v_mov_b32 v21, v13

    v_pk_mul_f32 v[8:9], v[20:21], v[18:19] op_sel_hi:[1,0]
    v_pk_fma_f32 v[8:9], v[20:21], v[18:19], v[8:9] op_sel:[1,1,0] op_sel_hi:[0,1,1] neg_lo:[1,0,0]
    v_mov_b32 v26, 1.0
    v_mov_b32 v27, 0
    v_mov_b32 v58, 1.0
    v_mov_b32 v59, 0
    v_mul_f32 v24, 0x3f800000, v15
    v_mul_f32 v25, 0x3f800000, v16
    v_exp_f32 v24, v24
    v_fract_f32 v25, v25
    s_nop 0
    v_cos_f32 v28, v25
    v_sin_f32 v29, v25
    s_nop 0
    v_mul_f32 v28, v24, v28
    v_mul_f32 v29, v24, v29
    v_mul_f32 v24, 0x41800000, v15
    v_mul_f32 v25, 0x41800000, v16
    v_exp_f32 v24, v24
    v_fract_f32 v25, v25
    s_nop 0
    v_cos_f32 v60, v25
    v_sin_f32 v61, v25
    s_nop 0
    v_mul_f32 v60, v24, v60
    v_mul_f32 v61, v24, v61
    v_mul_f32 v24, 0x43800000, v15
    v_mul_f32 v25, 0x43800000, v16
    v_exp_f32 v24, v24
    v_fract_f32 v25, v25
    s_nop 0
    v_cos_f32 v10, v25
    v_sin_f32 v11, v25
    s_nop 0
    v_mul_f32 v10, v24, v10
    v_mul_f32 v11, v24, v11
    v_pk_mul_f32 v[30:31], v[28:29], v[28:29] op_sel_hi:[1,0]
    v_pk_mul_f32 v[62:63], v[60:61], v[60:61] op_sel_hi:[1,0]
    v_pk_fma_f32 v[30:31], v[28:29], v[28:29], v[30:31] op_sel:[1,1,0] op_sel_hi:[0,1,1] neg_lo:[1,0,0]
    v_pk_fma_f32 v[62:63], v[60:61], v[60:61], v[62:63] op_sel:[1,1,0] op_sel_hi:[0,1,1] neg_lo:[1,0,0]
    v_pk_mul_f32 v[32:33], v[28:29], v[30:31] op_sel_hi:[1,0]
    v_pk_mul_f32 v[64:65], v[60:61], v[62:63] op_sel_hi:[1,0]
    v_pk_fma_f32 v[32:33], v[28:29], v[30:31], v[32:33] op_sel:[1,1,0] op_sel_hi:[0,1,1] neg_lo:[1,0,0]
    v_pk_fma_f32 v[64:65], v[60:61], v[62:63], v[64:65] op_sel:[1,1,0] op_sel_hi:[0,1,1] neg_lo:[1,0,0]
    v_pk_mul_f32 v[34:35], v[30:31], v[30:31] op_sel_hi:[1,0]
    v_pk_mul_f32 v[66:67], v[62:63], v[62:63] op_sel_hi:[1,0]
    v_pk_fma_f32 v[34:35], v[30:31], v[30:31], v[34:35] op_sel:[1,1,0] op_sel_hi:[0,1,1] neg_lo:[1,0,0]
    v_pk_fma_f32 v[66:67], v[62:63], v[62:63], v[66:67] op_sel:[1,1,0] op_sel_hi:[0,1,1] neg_lo:[1,0,0]
    v_pk_mul_f32 v[36:37], v[30:31], v[32:33] op_sel_hi:[1,0]
    v_pk_mul_f32 v[68:69], v[62:63], v[64:65] op_sel_hi:[1,0]
    v_pk_fma_f32 v[36:37], v[30:31], v[32:33], v[36:37] op_sel:[1,1,0] op_sel_hi:[0,1,1] neg_lo:[1,0,0]
    v_pk_fma_f32 v[68:69], v[62:63], v[64:65], v[68:69] op_sel:[1,1,0] op_sel_hi:[0,1,1] neg_lo:[1,0,0]
    v_pk_mul_f32 v[38:39], v[32:33], v[32:33] op_sel_hi:[1,0]
    v_pk_mul_f32 v[70:71], v[64:65], v[64:65] op_sel_hi:[1,0]
    v_pk_fma_f32 v[38:39], v[32:33], v[32:33], v[38:39] op_sel:[1,1,0] op_sel_hi:[0,1,1] neg_lo:[1,0,0]
    v_pk_fma_f32 v[70:71], v[64:65], v[64:65], v[70:71] op_sel:[1,1,0] op_sel_hi:[0,1,1] neg_lo:[1,0,0]
    v_pk_mul_f32 v[40:41], v[32:33], v[34:35] op_sel_hi:[1,0]
    v_pk_mul_f32 v[72:73], v[64:65], v[66:67] op_sel_hi:[1,0]
    v_pk_fma_f32 v[40:41], v[32:33], v[34:35], v[40:41] op_sel:[1,1,0] op_sel_hi:[0,1,1] neg_lo:[1,0,0]
    v_pk_fma_f32 v[72:73], v[64:65], v[66:67], v[72:73] op_sel:[1,1,0] op_sel_hi:[0,1,1] neg_lo:[1,0,0]
    v_pk_mul_f32 v[42:43], v[34:35], v[34:35] op_sel_hi:[1,0]
    v_pk_mul_f32 v[74:75], v[66:67], v[66:67] op_sel_hi:[1,0]
    v_pk_fma_f32 v[42:43], v[34:35], v[34:35], v[42:43] op_sel:[1,1,0] op_sel_hi:[0,1,1] neg_lo:[1,0,0]
    v_pk_fma_f32 v[74:75], v[66:67], v[66:67], v[74:75] op_sel:[1,1,0] op_sel_hi:[0,1,1] neg_lo:[1,0,0]
    v_pk_mul_f32 v[44:45], v[34:35], v[36:37] op_sel_hi:[1,0]
    v_pk_mul_f32 v[76:77], v[66:67], v[68:69] op_sel_hi:[1,0]
    v_pk_fma_f32 v[44:45], v[34:35], v[36:37], v[44:45] op_sel:[1,1,0] op_sel_hi:[0,1,1] neg_lo:[1,0,0]
    v_pk_fma_f32 v[76:77], v[66:67], v[68:69], v[76:77] op_sel:[1,1,0] op_sel_hi:[0,1,1] neg_lo:[1,0,0]
    v_pk_mul_f32 v[46:47], v[36:37], v[36:37] op_sel_hi:[1,0]
    v_pk_mul_f32 v[78:79], v[68:69], v[68:69] op_sel_hi:[1,0]
    v_pk_fma_f32 v[46:47], v[36:37], v[36:37], v[46:47] op_sel:[1,1,0] op_sel_hi:[0,1,1] neg_lo:[1,0,0]
    v_pk_fma_f32 v[78:79], v[68:69], v[68:69], v[78:79] op_sel:[1,1,0] op_sel_hi:[0,1,1] neg_lo:[1,0,0]
    v_pk_mul_f32 v[48:49], v[36:37], v[38:39] op_sel_hi:[1,0]
    v_pk_mul_f32 v[80:81], v[68:69], v[70:71] op_sel_hi:[1,0]
    v_pk_fma_f32 v[48:49], v[36:37], v[38:39], v[48:49] op_sel:[1,1,0] op_sel_hi:[0,1,1] neg_lo:[1,0,0]
    v_pk_fma_f32 v[80:81], v[68:69], v[70:71], v[80:81] op_sel:[1,1,0] op_sel_hi:[0,1,1] neg_lo:[1,0,0]
    v_pk_mul_f32 v[50:51], v[38:39], v[38:39] op_sel_hi:[1,0]
    v_pk_mul_f32 v[82:83], v[70:71], v[70:71] op_sel_hi:[1,0]
    v_pk_fma_f32 v[50:51], v[38:39], v[38:39], v[50:51] op_sel:[1,1,0] op_sel_hi:[0,1,1] neg_lo:[1,0,0]
    v_pk_fma_f32 v[82:83], v[70:71], v[70:71], v[82:83] op_sel:[1,1,0] op_sel_hi:[0,1,1] neg_lo:[1,0,0]
    v_pk_mul_f32 v[52:53], v[38:39], v[40:41] op_sel_hi:[1,0]
    v_pk_mul_f32 v[84:85], v[70:71], v[72:73] op_sel_hi:[1,0]
    v_pk_fma_f32 v[52:53], v[38:39], v[40:41], v[52:53] op_sel:[1,1,0] op_sel_hi:[0,1,1] neg_lo:[1,0,0]
    v_pk_fma_f32 v[84:85], v[70:71], v[72:73], v[84:85] op_sel:[1,1,0] op_sel_hi:[0,1,1] neg_lo:[1,0,0]
    v_pk_mul_f32 v[54:55], v[40:41], v[40:41] op_sel_hi:[1,0]
    v_pk_mul_f32 v[86:87], v[72:73], v[72:73] op_sel_hi:[1,0]
    v_pk_fma_f32 v[54:55], v[40:41], v[40:41], v[54:55] op_sel:[1,1,0] op_sel_hi:[0,1,1] neg_lo:[1,0,0]
    v_pk_fma_f32 v[86:87], v[72:73], v[72:73], v[86:87] op_sel:[1,1,0] op_sel_hi:[0,1,1] neg_lo:[1,0,0]
    v_pk_mul_f32 v[56:57], v[40:41], v[42:43] op_sel_hi:[1,0]
    v_pk_mul_f32 v[88:89], v[72:73], v[74:75] op_sel_hi:[1,0]
    v_pk_fma_f32 v[56:57], v[40:41], v[42:43], v[56:57] op_sel:[1,1,0] op_sel_hi:[0,1,1] neg_lo:[1,0,0]
    v_pk_fma_f32 v[88:89], v[72:73], v[74:75], v[88:89] op_sel:[1,1,0] op_sel_hi:[0,1,1] neg_lo:[1,0,0]
    v_pk_mul_f32 v[12:13], v[10:11], v[10:11] op_sel_hi:[1,0]
    v_pk_fma_f32 v[12:13], v[10:11], v[10:11], v[12:13] op_sel:[1,1,0] op_sel_hi:[0,1,1] neg_lo:[1,0,0]
    v_pk_mul_f32 v[90:91], v[58:59], v[8:9] op_sel_hi:[1,0]
    v_pk_mul_f32 v[92:93], v[60:61], v[8:9] op_sel_hi:[1,0]
    v_pk_mul_f32 v[94:95], v[62:63], v[8:9] op_sel_hi:[1,0]
    v_pk_mul_f32 v[96:97], v[64:65], v[8:9] op_sel_hi:[1,0]
    v_pk_mul_f32 v[98:99], v[66:67], v[8:9] op_sel_hi:[1,0]
    v_pk_mul_f32 v[100:101], v[68:69], v[8:9] op_sel_hi:[1,0]
    v_pk_mul_f32 v[102:103], v[70:71], v[8:9] op_sel_hi:[1,0]
    v_pk_mul_f32 v[104:105], v[72:73], v[8:9] op_sel_hi:[1,0]
    v_pk_fma_f32 v[90:91], v[58:59], v[8:9], v[90:91] op_sel:[1,1,0] op_sel_hi:[0,1,1] neg_lo:[1,0,0]
    v_pk_fma_f32 v[92:93], v[60:61], v[8:9], v[92:93] op_sel:[1,1,0] op_sel_hi:[0,1,1] neg_lo:[1,0,0]
    v_pk_fma_f32 v[94:95], v[62:63], v[8:9], v[94:95] op_sel:[1,1,0] op_sel_hi:[0,1,1] neg_lo:[1,0,0]
    v_pk_fma_f32 v[96:97], v[64:65], v[8:9], v[96:97] op_sel:[1,1,0] op_sel_hi:[0,1,1] neg_lo:[1,0,0]
    v_pk_fma_f32 v[98:99], v[66:67], v[8:9], v[98:99] op_sel:[1,1,0] op_sel_hi:[0,1,1] neg_lo:[1,0,0]
    v_pk_fma_f32 v[100:101], v[68:69], v[8:9], v[100:101] op_sel:[1,1,0] op_sel_hi:[0,1,1] neg_lo:[1,0,0]
    v_pk_fma_f32 v[102:103], v[70:71], v[8:9], v[102:103] op_sel:[1,1,0] op_sel_hi:[0,1,1] neg_lo:[1,0,0]
    v_pk_fma_f32 v[104:105], v[72:73], v[8:9], v[104:105] op_sel:[1,1,0] op_sel_hi:[0,1,1] neg_lo:[1,0,0]
    v_cvt_pk_bf16_f32 v14, v90, v92
    v_cvt_pk_bf16_f32 v18, -v91, -v93
    v_cvt_pk_bf16_f32 v15, v94, v96
    v_cvt_pk_bf16_f32 v19, -v95, -v97
    v_cvt_pk_bf16_f32 v16, v98, v100
    v_cvt_pk_bf16_f32 v20, -v99, -v101
    v_cvt_pk_bf16_f32 v17, v102, v104
    v_cvt_pk_bf16_f32 v21, -v103, -v105
    ds_write_b128 v5, v[14:17] offset:0
    ds_write_b128 v5, v[18:21] offset:2304
    v_pk_mul_f32 v[90:91], v[74:75], v[8:9] op_sel_hi:[1,0]
    v_pk_mul_f32 v[92:93], v[76:77], v[8:9] op_sel_hi:[1,0]
    v_pk_mul_f32 v[94:95], v[78:79], v[8:9] op_sel_hi:[1,0]
    v_pk_mul_f32 v[96:97], v[80:81], v[8:9] op_sel_hi:[1,0]
    v_pk_mul_f32 v[98:99], v[82:83], v[8:9] op_sel_hi:[1,0]
    v_pk_mul_f32 v[100:101], v[84:85], v[8:9] op_sel_hi:[1,0]
    v_pk_mul_f32 v[102:103], v[86:87], v[8:9] op_sel_hi:[1,0]
    v_pk_mul_f32 v[104:105], v[88:89], v[8:9] op_sel_hi:[1,0]
    v_pk_fma_f32 v[90:91], v[74:75], v[8:9], v[90:91] op_sel:[1,1,0] op_sel_hi:[0,1,1] neg_lo:[1,0,0]
    v_pk_fma_f32 v[92:93], v[76:77], v[8:9], v[92:93] op_sel:[1,1,0] op_sel_hi:[0,1,1] neg_lo:[1,0,0]
    v_pk_fma_f32 v[94:95], v[78:79], v[8:9], v[94:95] op_sel:[1,1,0] op_sel_hi:[0,1,1] neg_lo:[1,0,0]
    v_pk_fma_f32 v[96:97], v[80:81], v[8:9], v[96:97] op_sel:[1,1,0] op_sel_hi:[0,1,1] neg_lo:[1,0,0]
    v_pk_fma_f32 v[98:99], v[82:83], v[8:9], v[98:99] op_sel:[1,1,0] op_sel_hi:[0,1,1] neg_lo:[1,0,0]
    v_pk_fma_f32 v[100:101], v[84:85], v[8:9], v[100:101] op_sel:[1,1,0] op_sel_hi:[0,1,1] neg_lo:[1,0,0]
    v_pk_fma_f32 v[102:103], v[86:87], v[8:9], v[102:103] op_sel:[1,1,0] op_sel_hi:[0,1,1] neg_lo:[1,0,0]
    v_pk_fma_f32 v[104:105], v[88:89], v[8:9], v[104:105] op_sel:[1,1,0] op_sel_hi:[0,1,1] neg_lo:[1,0,0]
    v_cvt_pk_bf16_f32 v14, v90, v92
    v_cvt_pk_bf16_f32 v18, -v91, -v93
    v_cvt_pk_bf16_f32 v15, v94, v96
    v_cvt_pk_bf16_f32 v19, -v95, -v97
    v_cvt_pk_bf16_f32 v16, v98, v100
    v_cvt_pk_bf16_f32 v20, -v99, -v101
    v_cvt_pk_bf16_f32 v17, v102, v104
    v_cvt_pk_bf16_f32 v21, -v103, -v105
    ds_write_b128 v5, v[14:17] offset:1152
    ds_write_b128 v5, v[18:21] offset:3456
    v_cvt_pk_bf16_f32 v14, v26, v28
    v_cvt_pk_bf16_f32 v18, v27, v29
    v_cvt_pk_bf16_f32 v15, v30, v32
    v_cvt_pk_bf16_f32 v19, v31, v33
    v_cvt_pk_bf16_f32 v16, v34, v36
    v_cvt_pk_bf16_f32 v20, v35, v37
    v_cvt_pk_bf16_f32 v17, v38, v40
    v_cvt_pk_bf16_f32 v21, v39, v41
    ds_write_b128 v5, v[14:17] offset:4608
    ds_write_b128 v5, v[18:21] offset:6912
    v_cvt_pk_bf16_f32 v14, v42, v44
    v_cvt_pk_bf16_f32 v18, v43, v45
    v_cvt_pk_bf16_f32 v15, v46, v48
    v_cvt_pk_bf16_f32 v19, v47, v49
    v_cvt_pk_bf16_f32 v16, v50, v52
    v_cvt_pk_bf16_f32 v20, v51, v53
    v_cvt_pk_bf16_f32 v17, v54, v56
    v_cvt_pk_bf16_f32 v21, v55, v57
    ds_write_b128 v5, v[14:17] offset:5760
    ds_write_b128 v5, v[18:21] offset:8064
    ds_read_b64_tr_b16 v[90:91], v6 offset:0
    ds_read_b64_tr_b16 v[92:93], v6 offset:256
    ds_read_b64_tr_b16 v[94:95], v6 offset:4608
    ds_read_b64_tr_b16 v[96:97], v6 offset:4864
    ds_read_b64_tr_b16 v[98:99], v6 offset:512
    ds_read_b64_tr_b16 v[100:101], v6 offset:768
    ds_read_b64_tr_b16 v[102:103], v6 offset:5120
    ds_read_b64_tr_b16 v[104:105], v6 offset:5376
    s_waitcnt lgkmcnt(4)
    v_mfma_f32_16x16x32_bf16 v[112:115], v[90:93], v[94:97], 0
    ds_read_b64_tr_b16 v[90:91], v6 offset:2304
    ds_read_b64_tr_b16 v[92:93], v6 offset:2560
    ds_read_b64_tr_b16 v[94:95], v6 offset:6912
    ds_read_b64_tr_b16 v[96:97], v6 offset:7168
    s_waitcnt lgkmcnt(4)
    v_mfma_f32_16x16x32_bf16 v[112:115], v[98:101], v[102:105], v[112:115]
    ds_read_b64_tr_b16 v[98:99], v6 offset:2816
    ds_read_b64_tr_b16 v[100:101], v6 offset:3072
    ds_read_b64_tr_b16 v[102:103], v6 offset:7424
    ds_read_b64_tr_b16 v[104:105], v6 offset:7680
    s_waitcnt lgkmcnt(4)
    v_mfma_f32_16x16x32_bf16 v[112:115], v[90:93], v[94:97], v[112:115]
    s_waitcnt lgkmcnt(0)
    v_mfma_f32_16x16x32_bf16 v[112:115], v[98:101], v[102:105], v[112:115]
    v_pk_mul_f32 v[22:23], v[8:9], v[10:11] op_sel_hi:[1,0]
    v_pk_fma_f32 v[22:23], v[8:9], v[10:11], v[22:23] op_sel:[1,1,0] op_sel_hi:[0,1,1] neg_lo:[1,0,0]
    v_pk_mul_f32 v[90:91], v[58:59], v[22:23] op_sel_hi:[1,0]
    v_pk_mul_f32 v[92:93], v[62:63], v[22:23] op_sel_hi:[1,0]
    v_pk_mul_f32 v[94:95], v[66:67], v[22:23] op_sel_hi:[1,0]
    v_pk_mul_f32 v[96:97], v[70:71], v[22:23] op_sel_hi:[1,0]
    v_pk_mul_f32 v[98:99], v[74:75], v[22:23] op_sel_hi:[1,0]
    v_pk_mul_f32 v[100:101], v[78:79], v[22:23] op_sel_hi:[1,0]
    v_pk_mul_f32 v[102:103], v[82:83], v[22:23] op_sel_hi:[1,0]
    v_pk_mul_f32 v[104:105], v[86:87], v[22:23] op_sel_hi:[1,0]
    v_pk_fma_f32 v[90:91], v[58:59], v[22:23], v[90:91] op_sel:[1,1,0] op_sel_hi:[0,1,1] neg_lo:[1,0,0]
    v_pk_fma_f32 v[92:93], v[62:63], v[22:23], v[92:93] op_sel:[1,1,0] op_sel_hi:[0,1,1] neg_lo:[1,0,0]
    v_pk_fma_f32 v[94:95], v[66:67], v[22:23], v[94:95] op_sel:[1,1,0] op_sel_hi:[0,1,1] neg_lo:[1,0,0]
    v_pk_fma_f32 v[96:97], v[70:71], v[22:23], v[96:97] op_sel:[1,1,0] op_sel_hi:[0,1,1] neg_lo:[1,0,0]
    v_pk_fma_f32 v[98:99], v[74:75], v[22:23], v[98:99] op_sel:[1,1,0] op_sel_hi:[0,1,1] neg_lo:[1,0,0]
    v_pk_fma_f32 v[100:101], v[78:79], v[22:23], v[100:101] op_sel:[1,1,0] op_sel_hi:[0,1,1] neg_lo:[1,0,0]
    v_pk_fma_f32 v[102:103], v[82:83], v[22:23], v[102:103] op_sel:[1,1,0] op_sel_hi:[0,1,1] neg_lo:[1,0,0]
    v_pk_fma_f32 v[104:105], v[86:87], v[22:23], v[104:105] op_sel:[1,1,0] op_sel_hi:[0,1,1] neg_lo:[1,0,0]
    v_cvt_pk_bf16_f32 v14, v90, v92
    v_cvt_pk_bf16_f32 v18, -v91, -v93
    v_cvt_pk_bf16_f32 v15, v94, v96
    v_cvt_pk_bf16_f32 v19, -v95, -v97
    v_cvt_pk_bf16_f32 v16, v98, v100
    v_cvt_pk_bf16_f32 v20, -v99, -v101
    v_cvt_pk_bf16_f32 v17, v102, v104
    v_cvt_pk_bf16_f32 v21, -v103, -v105
    ds_write_b128 v5, v[14:17] offset:0
    ds_write_b128 v5, v[18:21] offset:2304
    v_cvt_pk_bf16_f32 v14, v26, v30
    v_cvt_pk_bf16_f32 v18, v27, v31
    v_cvt_pk_bf16_f32 v15, v34, v38
    v_cvt_pk_bf16_f32 v19, v35, v39
    v_cvt_pk_bf16_f32 v16, v42, v46
    v_cvt_pk_bf16_f32 v20, v43, v47
    v_cvt_pk_bf16_f32 v17, v50, v54
    v_cvt_pk_bf16_f32 v21, v51, v55
    ds_write_b128 v5, v[14:17] offset:4608
    ds_write_b128 v5, v[18:21] offset:6912
    v_pk_mul_f32 v[90:91], v[26:27], v[60:61] op_sel_hi:[1,0]
    v_pk_mul_f32 v[92:93], v[30:31], v[60:61] op_sel_hi:[1,0]
    v_pk_mul_f32 v[94:95], v[34:35], v[60:61] op_sel_hi:[1,0]
    v_pk_mul_f32 v[96:97], v[38:39], v[60:61] op_sel_hi:[1,0]
    v_pk_mul_f32 v[98:99], v[42:43], v[60:61] op_sel_hi:[1,0]
    v_pk_mul_f32 v[100:101], v[46:47], v[60:61] op_sel_hi:[1,0]
    v_pk_mul_f32 v[102:103], v[50:51], v[60:61] op_sel_hi:[1,0]
    v_pk_mul_f32 v[104:105], v[54:55], v[60:61] op_sel_hi:[1,0]
    v_pk_fma_f32 v[90:91], v[26:27], v[60:61], v[90:91] op_sel:[1,1,0] op_sel_hi:[0,1,1] neg_lo:[1,0,0]
    v_pk_fma_f32 v[92:93], v[30:31], v[60:61], v[92:93] op_sel:[1,1,0] op_sel_hi:[0,1,1] neg_lo:[1,0,0]
    v_pk_fma_f32 v[94:95], v[34:35], v[60:61], v[94:95] op_sel:[1,1,0] op_sel_hi:[0,1,1] neg_lo:[1,0,0]
    v_pk_fma_f32 v[96:97], v[38:39], v[60:61], v[96:97] op_sel:[1,1,0] op_sel_hi:[0,1,1] neg_lo:[1,0,0]
    v_pk_fma_f32 v[98:99], v[42:43], v[60:61], v[98:99] op_sel:[1,1,0] op_sel_hi:[0,1,1] neg_lo:[1,0,0]
    v_pk_fma_f32 v[100:101], v[46:47], v[60:61], v[100:101] op_sel:[1,1,0] op_sel_hi:[0,1,1] neg_lo:[1,0,0]
    v_pk_fma_f32 v[102:103], v[50:51], v[60:61], v[102:103] op_sel:[1,1,0] op_sel_hi:[0,1,1] neg_lo:[1,0,0]
    v_pk_fma_f32 v[104:105], v[54:55], v[60:61], v[104:105] op_sel:[1,1,0] op_sel_hi:[0,1,1] neg_lo:[1,0,0]
    v_cvt_pk_bf16_f32 v14, v90, v92
    v_cvt_pk_bf16_f32 v18, v91, v93
    v_cvt_pk_bf16_f32 v15, v94, v96
    v_cvt_pk_bf16_f32 v19, v95, v97
    v_cvt_pk_bf16_f32 v16, v98, v100
    v_cvt_pk_bf16_f32 v20, v99, v101
    v_cvt_pk_bf16_f32 v17, v102, v104
    v_cvt_pk_bf16_f32 v21, v103, v105
    ds_write_b128 v5, v[14:17] offset:5760
    ds_write_b128 v5, v[18:21] offset:8064
    ds_read_b64_tr_b16 v[90:91], v6 offset:0
    ds_read_b64_tr_b16 v[92:93], v6 offset:256
    ds_read_b64_tr_b16 v[94:95], v6 offset:4608
    ds_read_b64_tr_b16 v[96:97], v6 offset:4864
    ds_read_b64_tr_b16 v[98:99], v6 offset:512
    ds_read_b64_tr_b16 v[100:101], v6 offset:768
    ds_read_b64_tr_b16 v[102:103], v6 offset:5120
    ds_read_b64_tr_b16 v[104:105], v6 offset:5376
    s_waitcnt lgkmcnt(4)
    v_mfma_f32_16x16x32_bf16 v[116:119], v[90:93], v[94:97], 0
    ds_read_b64_tr_b16 v[90:91], v6 offset:2304
    ds_read_b64_tr_b16 v[92:93], v6 offset:2560
    ds_read_b64_tr_b16 v[94:95], v6 offset:6912
    ds_read_b64_tr_b16 v[96:97], v6 offset:7168
    s_waitcnt lgkmcnt(4)
    v_mfma_f32_16x16x32_bf16 v[116:119], v[98:101], v[102:105], v[116:119]
    ds_read_b64_tr_b16 v[98:99], v6 offset:2816
    ds_read_b64_tr_b16 v[100:101], v6 offset:3072
    ds_read_b64_tr_b16 v[102:103], v6 offset:7424
    ds_read_b64_tr_b16 v[104:105], v6 offset:7680
    s_waitcnt lgkmcnt(4)
    v_mfma_f32_16x16x32_bf16 v[116:119], v[90:93], v[94:97], v[116:119]
    s_waitcnt lgkmcnt(0)
    v_mfma_f32_16x16x32_bf16 v[116:119], v[98:101], v[102:105], v[116:119]
    v_pk_mul_f32 v[22:23], v[8:9], v[12:13] op_sel_hi:[1,0]
    v_pk_fma_f32 v[22:23], v[8:9], v[12:13], v[22:23] op_sel:[1,1,0] op_sel_hi:[0,1,1] neg_lo:[1,0,0]
    v_pk_mul_f32 v[24:25], v[22:23], v[10:11] op_sel_hi:[1,0]
    v_pk_fma_f32 v[24:25], v[22:23], v[10:11], v[24:25] op_sel:[1,1,0] op_sel_hi:[0,1,1] neg_lo:[1,0,0]
    v_pk_mul_f32 v[90:91], v[58:59], v[22:23] op_sel_hi:[1,0]
    v_pk_mul_f32 v[98:99], v[58:59], v[24:25] op_sel_hi:[1,0]
    v_pk_mul_f32 v[92:93], v[66:67], v[22:23] op_sel_hi:[1,0]
    v_pk_mul_f32 v[100:101], v[66:67], v[24:25] op_sel_hi:[1,0]
    v_pk_mul_f32 v[94:95], v[74:75], v[22:23] op_sel_hi:[1,0]
    v_pk_mul_f32 v[102:103], v[74:75], v[24:25] op_sel_hi:[1,0]
    v_pk_mul_f32 v[96:97], v[82:83], v[22:23] op_sel_hi:[1,0]
    v_pk_mul_f32 v[104:105], v[82:83], v[24:25] op_sel_hi:[1,0]
    v_pk_fma_f32 v[90:91], v[58:59], v[22:23], v[90:91] op_sel:[1,1,0] op_sel_hi:[0,1,1] neg_lo:[1,0,0]
    v_pk_fma_f32 v[98:99], v[58:59], v[24:25], v[98:99] op_sel:[1,1,0] op_sel_hi:[0,1,1] neg_lo:[1,0,0]
    v_pk_fma_f32 v[92:93], v[66:67], v[22:23], v[92:93] op_sel:[1,1,0] op_sel_hi:[0,1,1] neg_lo:[1,0,0]
    v_pk_fma_f32 v[100:101], v[66:67], v[24:25], v[100:101] op_sel:[1,1,0] op_sel_hi:[0,1,1] neg_lo:[1,0,0]
    v_pk_fma_f32 v[94:95], v[74:75], v[22:23], v[94:95] op_sel:[1,1,0] op_sel_hi:[0,1,1] neg_lo:[1,0,0]
    v_pk_fma_f32 v[102:103], v[74:75], v[24:25], v[102:103] op_sel:[1,1,0] op_sel_hi:[0,1,1] neg_lo:[1,0,0]
    v_pk_fma_f32 v[96:97], v[82:83], v[22:23], v[96:97] op_sel:[1,1,0] op_sel_hi:[0,1,1] neg_lo:[1,0,0]
    v_pk_fma_f32 v[104:105], v[82:83], v[24:25], v[104:105] op_sel:[1,1,0] op_sel_hi:[0,1,1] neg_lo:[1,0,0]
    v_cvt_pk_bf16_f32 v14, v90, v92
    v_cvt_pk_bf16_f32 v18, -v91, -v93
    v_cvt_pk_bf16_f32 v15, v94, v96
    v_cvt_pk_bf16_f32 v19, -v95, -v97
    v_cvt_pk_bf16_f32 v16, v98, v100
    v_cvt_pk_bf16_f32 v20, -v99, -v101
    v_cvt_pk_bf16_f32 v17, v102, v104
    v_cvt_pk_bf16_f32 v21, -v103, -v105
    ds_write_b128 v5, v[14:17] offset:0
    ds_write_b128 v5, v[18:21] offset:2304
    v_pk_mul_f32 v[90:91], v[60:61], v[34:35] op_sel_hi:[1,0]
    v_pk_mul_f32 v[92:93], v[60:61], v[42:43] op_sel_hi:[1,0]
    v_pk_mul_f32 v[94:95], v[60:61], v[50:51] op_sel_hi:[1,0]
    v_pk_fma_f32 v[90:91], v[60:61], v[34:35], v[90:91] op_sel:[1,1,0] op_sel_hi:[0,1,1] neg_lo:[1,0,0]
    v_pk_fma_f32 v[92:93], v[60:61], v[42:43], v[92:93] op_sel:[1,1,0] op_sel_hi:[0,1,1] neg_lo:[1,0,0]
    v_pk_fma_f32 v[94:95], v[60:61], v[50:51], v[94:95] op_sel:[1,1,0] op_sel_hi:[0,1,1] neg_lo:[1,0,0]
    v_cvt_pk_bf16_f32 v14, v26, v34
    v_cvt_pk_bf16_f32 v18, v27, v35
    v_cvt_pk_bf16_f32 v15, v42, v50
    v_cvt_pk_bf16_f32 v19, v43, v51
    v_cvt_pk_bf16_f32 v16, v60, v90
    v_cvt_pk_bf16_f32 v20, v61, v91
    v_cvt_pk_bf16_f32 v17, v92, v94
    v_cvt_pk_bf16_f32 v21, v93, v95
    ds_write_b128 v5, v[14:17] offset:4608
    ds_write_b128 v5, v[18:21] offset:6912
    v_pk_mul_f32 v[90:91], v[62:63], v[34:35] op_sel_hi:[1,0]
    v_pk_mul_f32 v[92:93], v[62:63], v[42:43] op_sel_hi:[1,0]
    v_pk_mul_f32 v[94:95], v[62:63], v[50:51] op_sel_hi:[1,0]
    v_pk_mul_f32 v[96:97], v[64:65], v[34:35] op_sel_hi:[1,0]
    v_pk_mul_f32 v[98:99], v[64:65], v[42:43] op_sel_hi:[1,0]
    v_pk_mul_f32 v[100:101], v[64:65], v[50:51] op_sel_hi:[1,0]
    v_pk_fma_f32 v[90:91], v[62:63], v[34:35], v[90:91] op_sel:[1,1,0] op_sel_hi:[0,1,1] neg_lo:[1,0,0]
    v_pk_fma_f32 v[92:93], v[62:63], v[42:43], v[92:93] op_sel:[1,1,0] op_sel_hi:[0,1,1] neg_lo:[1,0,0]
    v_pk_fma_f32 v[94:95], v[62:63], v[50:51], v[94:95] op_sel:[1,1,0] op_sel_hi:[0,1,1] neg_lo:[1,0,0]
    v_pk_fma_f32 v[96:97], v[64:65], v[34:35], v[96:97] op_sel:[1,1,0] op_sel_hi:[0,1,1] neg_lo:[1,0,0]
    v_pk_fma_f32 v[98:99], v[64:65], v[42:43], v[98:99] op_sel:[1,1,0] op_sel_hi:[0,1,1] neg_lo:[1,0,0]
    v_pk_fma_f32 v[100:101], v[64:65], v[50:51], v[100:101] op_sel:[1,1,0] op_sel_hi:[0,1,1] neg_lo:[1,0,0]
    v_cvt_pk_bf16_f32 v14, v62, v90
    v_cvt_pk_bf16_f32 v18, v63, v91
    v_cvt_pk_bf16_f32 v15, v92, v94
    v_cvt_pk_bf16_f32 v19, v93, v95
    v_cvt_pk_bf16_f32 v16, v64, v96
    v_cvt_pk_bf16_f32 v20, v65, v97
    v_cvt_pk_bf16_f32 v17, v98, v100
    v_cvt_pk_bf16_f32 v21, v99, v101
    ds_write_b128 v5, v[14:17] offset:5760
    ds_write_b128 v5, v[18:21] offset:8064
    ds_read_b64_tr_b16 v[90:91], v6 offset:0
    ds_read_b64_tr_b16 v[92:93], v6 offset:256
    ds_read_b64_tr_b16 v[94:95], v6 offset:4608
    ds_read_b64_tr_b16 v[96:97], v6 offset:4864
    ds_read_b64_tr_b16 v[98:99], v6 offset:512
    ds_read_b64_tr_b16 v[100:101], v6 offset:768
    ds_read_b64_tr_b16 v[102:103], v6 offset:5120
    ds_read_b64_tr_b16 v[104:105], v6 offset:5376
    s_waitcnt lgkmcnt(4)
    v_mfma_f32_16x16x32_bf16 v[120:123], v[90:93], v[94:97], 0
    ds_read_b64_tr_b16 v[90:91], v6 offset:2304
    ds_read_b64_tr_b16 v[92:93], v6 offset:2560
    ds_read_b64_tr_b16 v[94:95], v6 offset:6912
    ds_read_b64_tr_b16 v[96:97], v6 offset:7168
    s_waitcnt lgkmcnt(4)
    v_mfma_f32_16x16x32_bf16 v[120:123], v[98:101], v[102:105], v[120:123]
    ds_read_b64_tr_b16 v[98:99], v6 offset:2816
    ds_read_b64_tr_b16 v[100:101], v6 offset:3072
    ds_read_b64_tr_b16 v[102:103], v6 offset:7424
    ds_read_b64_tr_b16 v[104:105], v6 offset:7680
    s_waitcnt lgkmcnt(4)
    v_mfma_f32_16x16x32_bf16 v[120:123], v[90:93], v[94:97], v[120:123]
    s_waitcnt lgkmcnt(0)
    v_mfma_f32_16x16x32_bf16 v[120:123], v[98:101], v[102:105], v[120:123]
    v_pk_mul_f32 v[90:91], v[22:23], v[12:13] op_sel_hi:[1,0]
    v_pk_fma_f32 v[90:91], v[22:23], v[12:13], v[90:91] op_sel:[1,1,0] op_sel_hi:[0,1,1] neg_lo:[1,0,0]
    v_pk_mul_f32 v[94:95], v[90:91], v[10:11] op_sel_hi:[1,0]
    v_pk_fma_f32 v[94:95], v[90:91], v[10:11], v[94:95] op_sel:[1,1,0] op_sel_hi:[0,1,1] neg_lo:[1,0,0]
    v_pk_mul_f32 v[98:99], v[94:95], v[10:11] op_sel_hi:[1,0]
    v_pk_fma_f32 v[98:99], v[94:95], v[10:11], v[98:99] op_sel:[1,1,0] op_sel_hi:[0,1,1] neg_lo:[1,0,0]
    v_pk_mul_f32 v[102:103], v[98:99], v[10:11] op_sel_hi:[1,0]
    v_pk_fma_f32 v[102:103], v[98:99], v[10:11], v[102:103] op_sel:[1,1,0] op_sel_hi:[0,1,1] neg_lo:[1,0,0]
    v_pk_mul_f32 v[24:25], v[102:103], v[10:11] op_sel_hi:[1,0]
    v_pk_fma_f32 v[24:25], v[102:103], v[10:11], v[24:25] op_sel:[1,1,0] op_sel_hi:[0,1,1] neg_lo:[1,0,0]
    v_pk_mul_f32 v[92:93], v[90:91], v[74:75] op_sel_hi:[1,0]
    v_pk_mul_f32 v[96:97], v[94:95], v[74:75] op_sel_hi:[1,0]
    v_pk_mul_f32 v[100:101], v[98:99], v[74:75] op_sel_hi:[1,0]
    v_pk_mul_f32 v[104:105], v[102:103], v[74:75] op_sel_hi:[1,0]
    v_pk_fma_f32 v[92:93], v[90:91], v[74:75], v[92:93] op_sel:[1,1,0] op_sel_hi:[0,1,1] neg_lo:[1,0,0]
    v_pk_fma_f32 v[96:97], v[94:95], v[74:75], v[96:97] op_sel:[1,1,0] op_sel_hi:[0,1,1] neg_lo:[1,0,0]
    v_pk_fma_f32 v[100:101], v[98:99], v[74:75], v[100:101] op_sel:[1,1,0] op_sel_hi:[0,1,1] neg_lo:[1,0,0]
    v_pk_fma_f32 v[104:105], v[102:103], v[74:75], v[104:105] op_sel:[1,1,0] op_sel_hi:[0,1,1] neg_lo:[1,0,0]
    v_cvt_pk_bf16_f32 v14, v90, v92
    v_cvt_pk_bf16_f32 v18, -v91, -v93
    v_cvt_pk_bf16_f32 v15, v94, v96
    v_cvt_pk_bf16_f32 v19, -v95, -v97
    v_cvt_pk_bf16_f32 v16, v98, v100
    v_cvt_pk_bf16_f32 v20, -v99, -v101
    v_cvt_pk_bf16_f32 v17, v102, v104
    v_cvt_pk_bf16_f32 v21, -v103, -v105
    ds_write_b128 v5, v[14:17] offset:0
    ds_write_b128 v5, v[18:21] offset:2304
    v_cvt_pk_bf16_f32 v14, v24, 0
    v_cvt_pk_bf16_f32 v18, -v25, 0
    v_cvt_pk_bf16_f32 v15, 0, 0
    v_cvt_pk_bf16_f32 v19, 0, 0
    v_cvt_pk_bf16_f32 v16, 0, 0
    v_cvt_pk_bf16_f32 v20, 0, 0
    v_cvt_pk_bf16_f32 v17, 0, 0
    v_cvt_pk_bf16_f32 v21, 0, 0
    ds_write_b128 v5, v[14:17] offset:1152
    ds_write_b128 v5, v[18:21] offset:3456
    v_pk_mul_f32 v[90:91], v[60:61], v[42:43] op_sel_hi:[1,0]
    v_pk_mul_f32 v[92:93], v[62:63], v[42:43] op_sel_hi:[1,0]
    v_pk_mul_f32 v[94:95], v[64:65], v[42:43] op_sel_hi:[1,0]
    v_pk_fma_f32 v[90:91], v[60:61], v[42:43], v[90:91] op_sel:[1,1,0] op_sel_hi:[0,1,1] neg_lo:[1,0,0]
    v_pk_fma_f32 v[92:93], v[62:63], v[42:43], v[92:93] op_sel:[1,1,0] op_sel_hi:[0,1,1] neg_lo:[1,0,0]
    v_pk_fma_f32 v[94:95], v[64:65], v[42:43], v[94:95] op_sel:[1,1,0] op_sel_hi:[0,1,1] neg_lo:[1,0,0]
    v_cvt_pk_bf16_f32 v14, v26, v42
    v_cvt_pk_bf16_f32 v18, v27, v43
    v_cvt_pk_bf16_f32 v15, v60, v90
    v_cvt_pk_bf16_f32 v19, v61, v91
    v_cvt_pk_bf16_f32 v16, v62, v92
    v_cvt_pk_bf16_f32 v20, v63, v93
    v_cvt_pk_bf16_f32 v17, v64, v94
    v_cvt_pk_bf16_f32 v21, v65, v95
    ds_write_b128 v5, v[14:17] offset:4608
    ds_write_b128 v5, v[18:21] offset:6912
    v_pk_mul_f32 v[90:91], v[66:67], v[42:43] op_sel_hi:[1,0]
    v_pk_mul_f32 v[92:93], v[68:69], v[42:43] op_sel_hi:[1,0]
    v_pk_mul_f32 v[94:95], v[70:71], v[42:43] op_sel_hi:[1,0]
    v_pk_mul_f32 v[96:97], v[72:73], v[42:43] op_sel_hi:[1,0]
    v_pk_fma_f32 v[90:91], v[66:67], v[42:43], v[90:91] op_sel:[1,1,0] op_sel_hi:[0,1,1] neg_lo:[1,0,0]
    v_pk_fma_f32 v[92:93], v[68:69], v[42:43], v[92:93] op_sel:[1,1,0] op_sel_hi:[0,1,1] neg_lo:[1,0,0]
    v_pk_fma_f32 v[94:95], v[70:71], v[42:43], v[94:95] op_sel:[1,1,0] op_sel_hi:[0,1,1] neg_lo:[1,0,0]
    v_pk_fma_f32 v[96:97], v[72:73], v[42:43], v[96:97] op_sel:[1,1,0] op_sel_hi:[0,1,1] neg_lo:[1,0,0]
    v_cvt_pk_bf16_f32 v14, v66, v90
    v_cvt_pk_bf16_f32 v18, v67, v91
    v_cvt_pk_bf16_f32 v15, v68, v92
    v_cvt_pk_bf16_f32 v19, v69, v93
    v_cvt_pk_bf16_f32 v16, v70, v94
    v_cvt_pk_bf16_f32 v20, v71, v95
    v_cvt_pk_bf16_f32 v17, v72, v96
    v_cvt_pk_bf16_f32 v21, v73, v97
    ds_write_b128 v5, v[14:17] offset:5760
    ds_write_b128 v5, v[18:21] offset:8064
    ds_read_b64_tr_b16 v[90:91], v6 offset:0
    ds_read_b64_tr_b16 v[92:93], v6 offset:256
    ds_read_b64_tr_b16 v[94:95], v6 offset:4608
    ds_read_b64_tr_b16 v[96:97], v6 offset:4864
    ds_read_b64_tr_b16 v[98:99], v6 offset:512
    ds_read_b64_tr_b16 v[100:101], v6 offset:768
    ds_read_b64_tr_b16 v[102:103], v6 offset:5120
    ds_read_b64_tr_b16 v[104:105], v6 offset:5376
    s_waitcnt lgkmcnt(4)
    v_mfma_f32_16x16x32_bf16 v[124:127], v[90:93], v[94:97], 0
    ds_read_b64_tr_b16 v[90:91], v6 offset:2304
    ds_read_b64_tr_b16 v[92:93], v6 offset:2560
    ds_read_b64_tr_b16 v[94:95], v6 offset:6912
    ds_read_b64_tr_b16 v[96:97], v6 offset:7168
    s_waitcnt lgkmcnt(4)
    v_mfma_f32_16x16x32_bf16 v[124:127], v[98:101], v[102:105], v[124:127]
    ds_read_b64_tr_b16 v[98:99], v6 offset:2816
    ds_read_b64_tr_b16 v[100:101], v6 offset:3072
    ds_read_b64_tr_b16 v[102:103], v6 offset:7424
    ds_read_b64_tr_b16 v[104:105], v6 offset:7680
    s_waitcnt lgkmcnt(4)
    v_mfma_f32_16x16x32_bf16 v[124:127], v[90:93], v[94:97], v[124:127]
    s_waitcnt lgkmcnt(0)
    v_mfma_f32_16x16x32_bf16 v[124:127], v[98:101], v[102:105], v[124:127]
    s_mul_i32 s59, s54, 18432
    s_add_u32 s58, s59, 9216
    v_lshlrev_b32 v7, 4, v2
    v_add_u32 v7, s58, v7
    s_nop 4
    s_cmp_eq_u32 s53, 0
    s_cbranch_scc1 L_nh1_100003

    ds_write_b128 v7, v[112:115] offset:0
    ds_write_b128 v7, v[116:119] offset:1024
    ds_write_b128 v7, v[120:123] offset:2048
    ds_write_b128 v7, v[124:127] offset:3072
L_nh1_100003:
    s_waitcnt lgkmcnt(0)
    s_barrier
    s_cmp_eq_u32 s53, 1
    s_cbranch_scc1 L_nh1b_100004
    ds_read_b128 v[90:93], v7 offset:0
    ds_read_b128 v[94:97], v7 offset:1024
    ds_read_b128 v[98:101], v7 offset:2048
    ds_read_b128 v[102:105], v7 offset:3072
    v_and_b32 v8, 15, v2
    v_lshrrev_b32 v9, 4, v2
    v_lshlrev_b32 v10, 6, v9
    v_add_u32 v10, v10, v8
    s_waitcnt lgkmcnt(0)

    v_add_f32 v112, v112, v90
    v_add_f32 v113, v113, v91
    v_add_f32 v114, v114, v92
    v_add_f32 v115, v115, v93
    v_add_f32 v116, v116, v94
    v_add_f32 v117, v117, v95
    v_add_f32 v118, v118, v96
    v_add_f32 v119, v119, v97
    v_add_f32 v120, v120, v98
    v_add_f32 v121, v121, v99
    v_add_f32 v122, v122, v100
    v_add_f32 v123, v123, v101
    v_add_f32 v124, v124, v102
    v_add_f32 v125, v125, v103
    v_add_f32 v126, v126, v104
    v_add_f32 v127, v127, v105
    v_add_u32 v11, 0, v10
    v_cvt_f32_u32 v11, v11
    v_cvt_pk_bf16_f32 v11, v11, v11
    v_and_b32 v11, 0xffff, v11
    v_max_u32 v11, 0x3f7f, v11
    v_subrev_u32 v11, 0x3f7f, v11
    v_lshlrev_b32 v11, 1, v11
    v_add_u32 v11, s59, v11
    v_cvt_pk_bf16_f32 v12, v112, v112
    ds_write_b16 v11, v12

    v_add_u32 v11, 16, v10
    v_cvt_f32_u32 v11, v11
    v_cvt_pk_bf16_f32 v11, v11, v11
    v_and_b32 v11, 0xffff, v11
    v_max_u32 v11, 0x3f7f, v11
    v_subrev_u32 v11, 0x3f7f, v11
    v_lshlrev_b32 v11, 1, v11
    v_add_u32 v11, s59, v11
    v_cvt_pk_bf16_f32 v12, v113, v113
    ds_write_b16 v11, v12

    v_add_u32 v11, 32, v10
    v_cvt_f32_u32 v11, v11
    v_cvt_pk_bf16_f32 v11, v11, v11
    v_and_b32 v11, 0xffff, v11
    v_max_u32 v11, 0x3f7f, v11
    v_subrev_u32 v11, 0x3f7f, v11
    v_lshlrev_b32 v11, 1, v11
    v_add_u32 v11, s59, v11
    v_cvt_pk_bf16_f32 v12, v114, v114
    ds_write_b16 v11, v12

    v_add_u32 v11, 48, v10
    v_cvt_f32_u32 v11, v11
    v_cvt_pk_bf16_f32 v11, v11, v11
    v_and_b32 v11, 0xffff, v11
    v_max_u32 v11, 0x3f7f, v11
    v_subrev_u32 v11, 0x3f7f, v11
    v_lshlrev_b32 v11, 1, v11
    v_add_u32 v11, s59, v11
    v_cvt_pk_bf16_f32 v12, v115, v115
    ds_write_b16 v11, v12

    v_lshlrev_b32 v11, 1, v10
    v_add_u32 v11, s59, v11
    v_cmp_gt_u32 vcc, 2, v9
    s_and_saveexec_b64 s[60:61], vcc
    v_cvt_pk_bf16_f32 v12, v116, v116
    ds_write_b16 v11, v12 offset:2050
    v_cvt_pk_bf16_f32 v12, v117, v117
    ds_write_b16 v11, v12 offset:2082
    v_cvt_pk_bf16_f32 v12, v118, v118
    ds_write_b16 v11, v12 offset:2114
    v_cvt_pk_bf16_f32 v12, v119, v119
    ds_write_b16 v11, v12 offset:2146
    v_cvt_pk_bf16_f32 v12, v120, v120
    ds_write_b16 v11, v12 offset:2306
    v_cvt_pk_bf16_f32 v12, v121, v121
    ds_write_b16 v11, v12 offset:2338
    v_cvt_pk_bf16_f32 v12, v122, v122
    ds_write_b16 v11, v12 offset:2370
    v_cvt_pk_bf16_f32 v12, v123, v123
    ds_write_b16 v11, v12 offset:2402
    v_cvt_pk_bf16_f32 v12, v124, v124
    ds_write_b16 v11, v12 offset:2562
    v_cvt_pk_bf16_f32 v12, v125, v125
    ds_write_b16 v11, v12 offset:2594
    v_cvt_pk_bf16_f32 v12, v126, v126
    ds_write_b16 v11, v12 offset:2626
    v_cvt_pk_bf16_f32 v12, v127, v127
    ds_write_b16 v11, v12 offset:2658
    s_mov_b64 exec, s[60:61]
    v_cmp_eq_u32 vcc, 32, v2
    s_and_saveexec_b64 s[60:61], vcc
    v_mov_b32 v11, s59
    v_cvt_pk_bf16_f32 v12, v124, v124
    ds_write_b16 v11, v12 offset:2818
    s_mov_b64 exec, s[60:61]

L_nh1b_100004:
    s_waitcnt lgkmcnt(0)
    s_barrier
    s_mul_i32 s56, s52, 8320
    s_add_u32 s56, s56, 16777216
    s_add_u32 s57, s56, 4160
    v_mov_b32 v7, 0x3f7f3f7f

    s_lshl_b32 s58, s53, 7
    s_add_u32 s58, s58, 0
    v_add_u32 v8, s58, v2
    v_lshlrev_b32 v9, 3, v8
    v_sub_u32 v9, 2047, v9
    v_cvt_f32_i32 v9, v9

    v_subrev_f32 v10, 0x3f800000, v9
    v_subrev_f32 v11, 0x40000000, v9
    v_subrev_f32 v12, 0x40400000, v9
    v_subrev_f32 v13, 0x40800000, v9
    v_subrev_f32 v14, 0x40a00000, v9
    v_subrev_f32 v15, 0x40c00000, v9
    v_subrev_f32 v16, 0x40e00000, v9
    v_subrev_f32 v17, 0x41000000, v9
    v_max_f32 v17, 0, v17
    v_cvt_pk_bf16_f32 v20, v9, v10
    v_cvt_pk_bf16_f32 v21, v11, v12
    v_cvt_pk_bf16_f32 v22, v13, v14
    v_cvt_pk_bf16_f32 v23, v15, v16
    v_cvt_pk_bf16_f32 v24, v17, v17
    v_pk_max_u16 v20, v20, v7
    v_pk_sub_u16 v20, v20, v7
    v_pk_max_u16 v21, v21, v7
    v_pk_sub_u16 v21, v21, v7
    v_pk_max_u16 v22, v22, v7
    v_pk_sub_u16 v22, v22, v7
    v_pk_max_u16 v23, v23, v7
    v_pk_sub_u16 v23, v23, v7
    v_pk_max_u16 v24, v24, v7
    v_pk_sub_u16 v24, v24, v7
    v_and_b32 v26, 0xffff, v20
    v_lshl_add_u32 v26, v26, 1, s59
    v_lshrrev_b32 v27, 16, v20
    v_lshl_add_u32 v27, v27, 1, s59
    v_and_b32 v28, 0xffff, v21
    v_lshl_add_u32 v28, v28, 1, s59
    v_lshrrev_b32 v29, 16, v21
    v_lshl_add_u32 v29, v29, 1, s59
    v_and_b32 v30, 0xffff, v22
    v_lshl_add_u32 v30, v30, 1, s59
    v_lshrrev_b32 v31, 16, v22
    v_lshl_add_u32 v31, v31, 1, s59
    v_and_b32 v32, 0xffff, v23
    v_lshl_add_u32 v32, v32, 1, s59
    v_lshrrev_b32 v33, 16, v23
    v_lshl_add_u32 v33, v33, 1, s59
    v_and_b32 v34, 0xffff, v24
    v_lshl_add_u32 v34, v34, 1, s59
    ds_read_u16 v40, v26
    ds_read_u16 v52, v27
    ds_read_u16 v41, v28
    ds_read_u16 v53, v29
    ds_read_u16 v42, v30
    ds_read_u16 v54, v31
    ds_read_u16 v43, v32
    ds_read_u16 v55, v33
    ds_read_u16 v44, v34
    s_lshl_b32 s58, s53, 7
    s_add_u32 s58, s58, 64
    v_add_u32 v68, s58, v2
    v_lshlrev_b32 v69, 3, v68
    v_sub_u32 v69, 2047, v69
    v_cvt_f32_i32 v69, v69

    v_subrev_f32 v70, 0x3f800000, v69
    v_subrev_f32 v71, 0x40000000, v69
    v_subrev_f32 v72, 0x40400000, v69
    v_subrev_f32 v73, 0x40800000, v69
    v_subrev_f32 v74, 0x40a00000, v69
    v_subrev_f32 v75, 0x40c00000, v69
    v_subrev_f32 v76, 0x40e00000, v69
    v_subrev_f32 v77, 0x41000000, v69
    v_max_f32 v77, 0, v77
    v_cvt_pk_bf16_f32 v80, v69, v70
    v_cvt_pk_bf16_f32 v81, v71, v72
    v_cvt_pk_bf16_f32 v82, v73, v74
    v_cvt_pk_bf16_f32 v83, v75, v76
    v_cvt_pk_bf16_f32 v84, v77, v77
    v_pk_max_u16 v80, v80, v7
    v_pk_sub_u16 v80, v80, v7
    v_pk_max_u16 v81, v81, v7
    v_pk_sub_u16 v81, v81, v7
    v_pk_max_u16 v82, v82, v7
    v_pk_sub_u16 v82, v82, v7
    v_pk_max_u16 v83, v83, v7
    v_pk_sub_u16 v83, v83, v7
    v_pk_max_u16 v84, v84, v7
    v_pk_sub_u16 v84, v84, v7
    v_and_b32 v86, 0xffff, v80
    v_lshl_add_u32 v86, v86, 1, s59
    v_lshrrev_b32 v87, 16, v80
    v_lshl_add_u32 v87, v87, 1, s59
    v_and_b32 v88, 0xffff, v81
    v_lshl_add_u32 v88, v88, 1, s59
    v_lshrrev_b32 v89, 16, v81
    v_lshl_add_u32 v89, v89, 1, s59
    v_and_b32 v90, 0xffff, v82
    v_lshl_add_u32 v90, v90, 1, s59
    v_lshrrev_b32 v91, 16, v82
    v_lshl_add_u32 v91, v91, 1, s59
    v_and_b32 v92, 0xffff, v83
    v_lshl_add_u32 v92, v92, 1, s59
    v_lshrrev_b32 v93, 16, v83
    v_lshl_add_u32 v93, v93, 1, s59
    v_and_b32 v94, 0xffff, v84
    v_lshl_add_u32 v94, v94, 1, s59
    ds_read_u16 v100, v86
    ds_read_u16 v112, v87
    ds_read_u16 v101, v88
    ds_read_u16 v113, v89
    ds_read_u16 v102, v90
    ds_read_u16 v114, v91
    ds_read_u16 v103, v92
    ds_read_u16 v115, v93
    ds_read_u16 v104, v94
    v_cmp_eq_u32 vcc, 255, v8
    s_waitcnt lgkmcnt(9)
    s_nop 0
    v_cndmask_b32_e64 v44, v44, 0, vcc
    v_lshl_or_b32 v40, v52, 16, v40
    v_lshl_or_b32 v41, v53, 16, v41
    v_lshl_or_b32 v42, v54, 16, v42
    v_lshl_or_b32 v43, v55, 16, v43
    v_alignbit_b32 v48, v41, v40, 16
    v_alignbit_b32 v49, v42, v41, 16
    v_alignbit_b32 v50, v43, v42, 16
    v_alignbit_b32 v51, v44, v43, 16
    v_lshlrev_b32 v9, 4, v8
    buffer_store_dwordx4 v[40:43], v9, s[20:23], s56 offen nt
    buffer_store_dwordx4 v[48:51], v9, s[20:23], s57 offen nt
    v_cmp_eq_u32 vcc, 255, v68
    s_waitcnt lgkmcnt(0)
    s_nop 0
    v_cndmask_b32_e64 v104, v104, 0, vcc
    v_lshl_or_b32 v100, v112, 16, v100
    v_lshl_or_b32 v101, v113, 16, v101
    v_lshl_or_b32 v102, v114, 16, v102
    v_lshl_or_b32 v103, v115, 16, v103
    v_alignbit_b32 v108, v101, v100, 16
    v_alignbit_b32 v109, v102, v101, 16
    v_alignbit_b32 v110, v103, v102, 16
    v_alignbit_b32 v111, v104, v103, 16
    v_lshlrev_b32 v69, 4, v68
    buffer_store_dwordx4 v[100:103], v69, s[20:23], s56 offen nt
    buffer_store_dwordx4 v[108:111], v69, s[20:23], s57 offen nt
    s_cmp_eq_u32 s53, 1
    s_cbranch_scc1 L_k1_kernel_fin
    v_mov_b32 v40, 0
    v_mov_b32 v41, 0
    v_mov_b32 v42, 0
    v_mov_b32 v43, 0
    v_lshrrev_b32 v9, 2, v2
    v_mul_u32_u24 v9, 4160, v9
    v_and_b32 v10, 3, v2
    v_lshlrev_b32 v10, 4, v10
    v_add_u32 v9, v9, v10
    v_add_u32 v9, 4096, v9
    v_cmp_gt_u32 vcc, 8, v2
    s_and_saveexec_b64 s[60:61], vcc
    buffer_store_dwordx4 v[40:43], v9, s[20:23], s56 offen nt
    s_mov_b64 exec, s[60:61]
    s_branch L_k1_kernel_fin

L_tr_100002:
    s_cmp_ge_u32 s31, 180
    s_cbranch_scc1 L_wo_100005
    s_sub_u32 s52, s31, 144
    s_mul_i32 s53, s52, 57
    s_lshr_b32 s53, s53, 9
    s_mul_i32 s54, s53, 9
    s_sub_u32 s54, s52, s54

    s_setprio 2
    s_mov_b32 s12, s36
    s_mov_b32 s13, s37
    s_mov_b32 s14, 2359296
    s_mov_b32 s15, 0x20000
    v_lshrrev_b32 v5, 3, v2
    v_mul_u32_u24 v5, 1152, v5
    v_and_b32 v6, 7, v2
    v_lshlrev_b32 v6, 4, v6
    v_add_u32 v5, v5, v6
    s_lshl_b32 s55, s53, 3
    s_add_u32 s55, s55, s24
    s_mul_i32 s55, s55, 73728
    s_lshl_b32 s56, s54, 7
    s_add_u32 s55, s55, s56
    s_lshl_b32 s57, s24, 13
    s_mov_b32 m0, s57

    buffer_load_dwordx4 v5, s[12:15], s55 offen lds
    s_add_u32 m0, m0, 1024
    s_add_u32 s55, s55, 9216
    buffer_load_dwordx4 v5, s[12:15], s55 offen lds
    s_add_u32 m0, m0, 1024
    s_add_u32 s55, s55, 9216
    buffer_load_dwordx4 v5, s[12:15], s55 offen lds
    s_add_u32 m0, m0, 1024
    s_add_u32 s55, s55, 9216
    buffer_load_dwordx4 v5, s[12:15], s55 offen lds
    s_add_u32 m0, m0, 1024
    s_add_u32 s55, s55, 9216
    buffer_load_dwordx4 v5, s[12:15], s55 offen lds
    s_add_u32 m0, m0, 1024
    s_add_u32 s55, s55, 9216
    buffer_load_dwordx4 v5, s[12:15], s55 offen lds
    s_add_u32 m0, m0, 1024
    s_add_u32 s55, s55, 9216
    buffer_load_dwordx4 v5, s[12:15], s55 offen lds
    s_add_u32 m0, m0, 1024
    s_add_u32 s55, s55, 9216
    buffer_load_dwordx4 v5, s[12:15], s55 offen lds
    v_mov_b32 v48, 0
    v_mov_b32 v49, 0
    v_mov_b32 v50, 0
    v_mov_b32 v51, 0
    v_lshrrev_b32 v7, 3, v2
    v_mul_u32_u24 v7, 6144, v7
    v_and_b32 v8, 7, v2
    v_lshlrev_b32 v8, 4, v8
    v_add_u32 v7, v7, v8
    s_lshl_b32 s58, s54, 6
    s_lshl_b32 s59, s24, 3
    s_add_u32 s58, s58, s59
    s_mul_i32 s58, s58, 6144
    s_add_u32 s58, s58, 23068672
    s_lshl_b32 s59, s53, 7
    s_add_u32 s59, s59, s58

    buffer_store_dwordx4 v[48:51], v7, s[20:23], s59 offen offset:0 nt
    buffer_store_dwordx4 v[48:51], v7, s[20:23], s59 offen offset:1536 nt
    s_add_u32 s59, s59, 3072
    buffer_store_dwordx4 v[48:51], v7, s[20:23], s59 offen offset:0 nt
    buffer_store_dwordx4 v[48:51], v7, s[20:23], s59 offen offset:1536 nt
    v_bfe_u32 v5, v2, 2, 2
    v_lshlrev_b32 v5, 7, v5
    v_lshrrev_b32 v6, 4, v2
    v_lshlrev_b32 v6, 5, v6
    v_add_u32 v5, v5, v6
    v_and_b32 v6, 3, v2
    v_lshlrev_b32 v6, 3, v6
    v_add_u32 v5, v5, v6
    v_add_u32 v5, s57, v5
    s_waitcnt vmcnt(4)

    ds_read_b64_tr_b16 v[16:17], v5 offset:0
    ds_read_b64_tr_b16 v[18:19], v5 offset:512
    ds_read_b64_tr_b16 v[20:21], v5 offset:1024
    ds_read_b64_tr_b16 v[22:23], v5 offset:1536
    ds_read_b64_tr_b16 v[24:25], v5 offset:2048
    ds_read_b64_tr_b16 v[26:27], v5 offset:2560
    ds_read_b64_tr_b16 v[28:29], v5 offset:3072
    ds_read_b64_tr_b16 v[30:31], v5 offset:3584
    ds_read_b64_tr_b16 v[32:33], v5 offset:4096
    ds_read_b64_tr_b16 v[34:35], v5 offset:4608
    ds_read_b64_tr_b16 v[36:37], v5 offset:5120
    ds_read_b64_tr_b16 v[38:39], v5 offset:5632
    ds_read_b64_tr_b16 v[40:41], v5 offset:6144
    ds_read_b64_tr_b16 v[42:43], v5 offset:6656
    ds_read_b64_tr_b16 v[44:45], v5 offset:7168
    ds_read_b64_tr_b16 v[46:47], v5 offset:7680
    v_lshlrev_b32 v6, 10, v2
    v_and_b32 v7, 15, v2
    s_lshl_b32 s59, s24, 1
    v_xor_b32 v8, s59, v7
    v_lshlrev_b32 v8, 4, v8
    v_add_u32 v8, v8, v6
    s_add_u32 s59, s59, 1
    v_xor_b32 v9, s59, v7
    v_lshlrev_b32 v9, 4, v9
    v_add_u32 v9, v9, v6
    s_waitcnt lgkmcnt(0)
    s_barrier

    ds_write_b128 v8, v[16:19] offset:0
    ds_write_b128 v8, v[20:23] offset:256
    ds_write_b128 v8, v[24:27] offset:512
    ds_write_b128 v8, v[28:31] offset:768
    ds_write_b128 v9, v[32:35] offset:0
    ds_write_b128 v9, v[36:39] offset:256
    ds_write_b128 v9, v[40:43] offset:512
    ds_write_b128 v9, v[44:47] offset:768
    s_waitcnt lgkmcnt(0)
    s_barrier
    v_lshrrev_b32 v6, 4, v2
    v_and_b32 v7, 15, v2
    v_mul_u32_u24 v10, 1536, v6
    v_lshlrev_b32 v11, 4, v7
    v_add_u32 v10, v10, v11
    v_lshlrev_b32 v6, 8, v6
    s_lshl_b32 s59, s53, 8
    s_add_u32 s58, s58, s59
    s_add_u32 s58, s58, 512
    s_lshl_b32 s55, s24, 3

    s_add_u32 s56, s55, 0
    s_and_b32 s57, s56, 15
    v_xor_b32 v12, s57, v7
    v_lshlrev_b32 v12, 4, v12
    v_add_u32 v12, v12, v6
    s_lshl_b32 s56, s56, 10
    v_add_u32 v12, s56, v12
    ds_read_b128 v[16:19], v12

    s_add_u32 s56, s55, 1
    s_and_b32 s57, s56, 15
    v_xor_b32 v12, s57, v7
    v_lshlrev_b32 v12, 4, v12
    v_add_u32 v12, v12, v6
    s_lshl_b32 s56, s56, 10
    v_add_u32 v12, s56, v12
    ds_read_b128 v[20:23], v12

    s_add_u32 s56, s55, 2
    s_and_b32 s57, s56, 15
    v_xor_b32 v12, s57, v7
    v_lshlrev_b32 v12, 4, v12
    v_add_u32 v12, v12, v6
    s_lshl_b32 s56, s56, 10
    v_add_u32 v12, s56, v12
    ds_read_b128 v[24:27], v12

    s_add_u32 s56, s55, 3
    s_and_b32 s57, s56, 15
    v_xor_b32 v12, s57, v7
    v_lshlrev_b32 v12, 4, v12
    v_add_u32 v12, v12, v6
    s_lshl_b32 s56, s56, 10
    v_add_u32 v12, s56, v12
    ds_read_b128 v[28:31], v12

    s_add_u32 s56, s55, 4
    s_and_b32 s57, s56, 15
    v_xor_b32 v12, s57, v7
    v_lshlrev_b32 v12, 4, v12
    v_add_u32 v12, v12, v6
    s_lshl_b32 s56, s56, 10
    v_add_u32 v12, s56, v12
    ds_read_b128 v[32:35], v12

    s_add_u32 s56, s55, 5
    s_and_b32 s57, s56, 15
    v_xor_b32 v12, s57, v7
    v_lshlrev_b32 v12, 4, v12
    v_add_u32 v12, v12, v6
    s_lshl_b32 s56, s56, 10
    v_add_u32 v12, s56, v12
    ds_read_b128 v[36:39], v12

    s_add_u32 s56, s55, 6
    s_and_b32 s57, s56, 15
    v_xor_b32 v12, s57, v7
    v_lshlrev_b32 v12, 4, v12
    v_add_u32 v12, v12, v6
    s_lshl_b32 s56, s56, 10
    v_add_u32 v12, s56, v12
    ds_read_b128 v[40:43], v12

    s_add_u32 s56, s55, 7
    s_and_b32 s57, s56, 15
    v_xor_b32 v12, s57, v7
    v_lshlrev_b32 v12, 4, v12
    v_add_u32 v12, v12, v6
    s_lshl_b32 s56, s56, 10
    v_add_u32 v12, s56, v12
    ds_read_b128 v[44:47], v12

    s_waitcnt lgkmcnt(7)
    buffer_store_dwordx4 v[16:19], v10, s[20:23], s58 offen nt
    s_add_u32 s58, s58, 6144
    s_waitcnt lgkmcnt(6)
    buffer_store_dwordx4 v[20:23], v10, s[20:23], s58 offen nt
    s_add_u32 s58, s58, 6144
    s_waitcnt lgkmcnt(5)
    buffer_store_dwordx4 v[24:27], v10, s[20:23], s58 offen nt
    s_add_u32 s58, s58, 6144
    s_waitcnt lgkmcnt(4)
    buffer_store_dwordx4 v[28:31], v10, s[20:23], s58 offen nt
    s_add_u32 s58, s58, 6144
    s_waitcnt lgkmcnt(3)
    buffer_store_dwordx4 v[32:35], v10, s[20:23], s58 offen nt
    s_add_u32 s58, s58, 6144
    s_waitcnt lgkmcnt(2)
    buffer_store_dwordx4 v[36:39], v10, s[20:23], s58 offen nt
    s_add_u32 s58, s58, 6144
    s_waitcnt lgkmcnt(1)
    buffer_store_dwordx4 v[40:43], v10, s[20:23], s58 offen nt
    s_add_u32 s58, s58, 6144
    s_waitcnt lgkmcnt(0)
    buffer_store_dwordx4 v[44:47], v10, s[20:23], s58 offen nt
    s_add_u32 s58, s58, 6144
    s_branch L_k1_kernel_fin
L_wo_100005:
    s_sub_u32 s52, s31, 180
    s_load_dwordx2 s[10:11], s[0:1], 88
    v_lshrrev_b32 v5, 2, v2
    v_mul_u32_u24 v5, 1152, v5
    v_and_b32 v6, 3, v2
    v_lshlrev_b32 v6, 4, v6
    v_add_u32 v5, v5, v6
    s_lshl_b32 s53, s52, 6
    s_mul_i32 s54, s24, 18432
    s_add_u32 s53, s53, s54
    s_lshl_b32 s55, s24, 10
    s_setprio 2
    s_waitcnt lgkmcnt(0)

    s_mov_b32 s12, s10
    s_mov_b32 s13, s11
    s_mov_b32 s14, 663552
    s_mov_b32 s15, 0x20000
    s_cmp_lg_u32 s52, 0
    s_cbranch_scc1 L_zc_100006
    s_cmp_lg_u32 s24, 7
    s_cbranch_scc1 L_zc_100006
    v_lshlrev_b32 v20, 6, v2
    v_mov_b32 v21, 0
    s_mov_b32 s60, 31457280
    buffer_store_dword v21, v20, s[20:23], s60 offen nt
    v_lshlrev_b32 v20, 4, v2
    v_mov_b32 v24, 0
    v_mov_b32 v25, 0
    v_mov_b32 v26, 0
    v_mov_b32 v27, 0
    s_mov_b32 s60, 31461376
    buffer_store_dwordx4 v[24:27], v20, s[20:23], s60 offen offset:0 nt
    buffer_store_dwordx4 v[24:27], v20, s[20:23], s60 offen offset:1024 nt
    buffer_store_dwordx4 v[24:27], v20, s[20:23], s60 offen offset:2048 nt
    buffer_store_dwordx4 v[24:27], v20, s[20:23], s60 offen offset:3072 nt
    s_add_u32 s60, s60, 4096
    buffer_store_dwordx4 v[24:27], v20, s[20:23], s60 offen offset:0 nt
    buffer_store_dwordx4 v[24:27], v20, s[20:23], s60 offen offset:1024 nt
    buffer_store_dwordx4 v[24:27], v20, s[20:23], s60 offen offset:2048 nt
    buffer_store_dwordx4 v[24:27], v20, s[20:23], s60 offen offset:3072 nt

L_zc_100006:
    s_mov_b32 m0, s55
    s_add_u32 s55, s55, 8192
    buffer_load_dwordx4 v5, s[12:15], s53 offen lds
    s_add_u32 s53, s53, 147456
    s_mov_b32 m0, s55
    s_add_u32 s55, s55, 8192
    buffer_load_dwordx4 v5, s[12:15], s53 offen lds
    s_add_u32 s53, s53, 147456
    s_mov_b32 m0, s55
    s_add_u32 s55, s55, 8192
    buffer_load_dwordx4 v5, s[12:15], s53 offen lds
    s_add_u32 s53, s53, 147456
    s_mov_b32 m0, s55
    s_add_u32 s55, s55, 8192
    buffer_load_dwordx4 v5, s[12:15], s53 offen lds
    s_add_u32 s53, s53, 147456
    s_cmp_ge_u32 s24, 4
    s_cbranch_scc1 L_wsk_100007
    s_mov_b32 m0, s55
    s_add_u32 s55, s55, 8192
    buffer_load_dwordx4 v5, s[12:15], s53 offen lds
    s_add_u32 s53, s53, 147456
L_wsk_100007:
    v_bfe_u32 v7, v2, 2, 2
    v_and_b32 v8, 3, v2
    v_bfe_u32 v9, v2, 4, 1
    v_lshrrev_b32 v10, 5, v2
    v_and_b32 v11, 1, v8
    v_lshlrev_b32 v11, 4, v11
    v_lshrrev_b32 v12, 1, v8
    v_lshlrev_b32 v12, 3, v12
    v_add_u32 v11, v11, v12
    v_lshlrev_b32 v12, 5, v9
    v_add_u32 v11, v11, v12
    v_lshlrev_b32 v12, 3, v10
    v_add_u32 v12, v12, v7
    v_lshlrev_b32 v12, 6, v12
    v_add_u32 v12, v12, v11
    v_lshlrev_b32 v14, 4, v2
    s_mul_i32 s56, s52, 36864
    s_add_u32 s56, s56, 30408704
    s_waitcnt vmcnt(0)
    s_barrier

    s_add_u32 s57, s24, 0
    s_mul_i32 s58, s57, 18
    s_and_b32 s59, s57, 1
    s_lshl_b32 s59, s59, 1
    s_add_u32 s58, s58, s59
    s_lshl_b32 s58, s58, 6
    v_add_u32 v13, s58, v12
    ds_read_b64_tr_b16 v[16:17], v13
    ds_read_b64_tr_b16 v[18:19], v13 offset:256

    s_add_u32 s57, s24, 8
    s_mul_i32 s58, s57, 18
    s_and_b32 s59, s57, 1
    s_lshl_b32 s59, s59, 1
    s_add_u32 s58, s58, s59
    s_lshl_b32 s58, s58, 6
    v_add_u32 v13, s58, v12
    ds_read_b64_tr_b16 v[20:21], v13
    ds_read_b64_tr_b16 v[22:23], v13 offset:256

    s_add_u32 s57, s24, 16
    s_mul_i32 s58, s57, 18
    s_and_b32 s59, s57, 1
    s_lshl_b32 s59, s59, 1
    s_add_u32 s58, s58, s59
    s_lshl_b32 s58, s58, 6
    v_add_u32 v13, s58, v12
    ds_read_b64_tr_b16 v[24:25], v13
    ds_read_b64_tr_b16 v[26:27], v13 offset:256

    s_add_u32 s57, s24, 24
    s_mul_i32 s58, s57, 18
    s_and_b32 s59, s57, 1
    s_lshl_b32 s59, s59, 1
    s_add_u32 s58, s58, s59
    s_lshl_b32 s58, s58, 6
    v_add_u32 v13, s58, v12
    ds_read_b64_tr_b16 v[28:29], v13
    ds_read_b64_tr_b16 v[30:31], v13 offset:256

    s_cmp_ge_u32 s24, 4
    s_cbranch_scc1 L_wsk2_100008
    s_lshl_b32 s57, s24, 3
    v_lshlrev_b32 v15, 2, v10
    v_lshrrev_b32 v13, 1, v7
    v_add_u32 v15, v15, v13
    v_add_u32 v15, s57, v15
    v_mul_u32_u24 v13, 18, v15
    v_and_b32 v15, 1, v15
    v_lshlrev_b32 v15, 4, v15
    v_sub_u32 v15, 16, v15
    v_add_u32 v13, v13, v15
    v_and_b32 v15, 1, v7
    v_add_u32 v13, v13, v15
    v_lshlrev_b32 v13, 6, v13
    v_add_u32 v13, v13, v11
    ds_read_b64_tr_b16 v[32:33], v13
    ds_read_b64_tr_b16 v[34:35], v13 offset:2304
    s_add_u32 s58, s24, 32
    s_lshl_b32 s58, s58, 10
    s_add_u32 s58, s58, s56
    s_waitcnt lgkmcnt(0)
    buffer_store_dwordx4 v[32:35], v14, s[20:23], s58 offen nt

L_wsk2_100008:
    s_waitcnt lgkmcnt(0)
    s_add_u32 s58, s24, 0
    s_lshl_b32 s58, s58, 10
    s_add_u32 s58, s58, s56
    buffer_store_dwordx4 v[16:19], v14, s[20:23], s58 offen nt

    s_add_u32 s58, s24, 8
    s_lshl_b32 s58, s58, 10
    s_add_u32 s58, s58, s56
    buffer_store_dwordx4 v[20:23], v14, s[20:23], s58 offen nt

    s_add_u32 s58, s24, 16
    s_lshl_b32 s58, s58, 10
    s_add_u32 s58, s58, s56
    buffer_store_dwordx4 v[24:27], v14, s[20:23], s58 offen nt

    s_add_u32 s58, s24, 24
    s_lshl_b32 s58, s58, 10
    s_add_u32 s58, s58, s56
    buffer_store_dwordx4 v[28:31], v14, s[20:23], s58 offen nt

    s_branch L_k1_kernel_fin
L_gemm_100001:
    s_mov_b32 s64, s4
    s_mov_b32 s65, s5
    s_mov_b32 s66, 2359296
    s_mov_b32 s67, 0x20000
    s_mov_b32 s16, s6
    s_mov_b32 s17, s7
    s_mov_b32 s18, 1990656
    s_mov_b32 s19, 0x20000
    v_lshrrev_b32 v15, 3, v2
    v_add_u32 v15, 0, v15
    v_mul_u32_u24 v16, 1152, v15
    v_lshrrev_b32 v17, 1, v15
    v_and_b32 v17, 7, v17
    v_and_b32 v18, 7, v2
    v_xor_b32 v17, v17, v18
    v_lshlrev_b32 v17, 4, v17
    v_add_u32 v34, v16, v17

    v_lshrrev_b32 v15, 3, v2
    v_add_u32 v15, 8, v15
    v_mul_u32_u24 v16, 1152, v15
    v_lshrrev_b32 v17, 1, v15
    v_and_b32 v17, 7, v17
    v_and_b32 v18, 7, v2
    v_xor_b32 v17, v17, v18
    v_lshlrev_b32 v17, 4, v17
    v_add_u32 v35, v16, v17

    v_lshrrev_b32 v15, 4, v2
    v_and_b32 v16, 15, v2
    v_lshlrev_b32 v17, 2, v15
    v_sub_u32 v16, v16, v17
    v_and_b32 v16, 15, v16
    v_lshlrev_b32 v16, 4, v16
    v_mul_u32_u24 v15, 3456, v15
    v_add_u32 v36, v15, v16
    s_lshl_b32 s32, s28, 7
    s_lshl_b32 s33, s24, 4
    s_add_u32 s32, s32, s33
    s_mul_i32 s32, s32, 1152
    s_mul_i32 s33, s24, 13824
    s_mul_i32 s34, s27, 216
    s_add_u32 s33, s33, s34
    s_lshl_b32 s34, s24, 11
    s_lshl_b32 s35, s24, 10

    s_add_u32 m0, s35, 49152
    s_nop 0
    buffer_load_dwordx4 v36, s[16:19], s33 offen lds
    s_add_u32 s33, s33, 110592
    s_add_u32 m0, s34, 0
    s_nop 0
    buffer_load_dwordx4 v34, s[64:67], s32 offen lds
    s_add_u32 m0, s34, 1024
    s_nop 0
    buffer_load_dwordx4 v35, s[64:67], s32 offen lds
    s_add_u32 s32, s32, 128
    s_add_u32 m0, s35, 57344
    s_nop 0
    buffer_load_dwordx4 v36, s[16:19], s33 offen lds
    s_add_u32 s33, s33, 110592
    s_add_u32 m0, s35, 65536
    s_nop 0
    buffer_load_dwordx4 v36, s[16:19], s33 offen lds
    s_add_u32 s33, s33, 110592
    s_add_u32 m0, s34, 16384
    s_nop 0
    buffer_load_dwordx4 v34, s[64:67], s32 offen lds
    s_add_u32 m0, s34, 17408
    s_nop 0
    buffer_load_dwordx4 v35, s[64:67], s32 offen lds
    s_add_u32 s32, s32, 128
    s_cmp_ge_u32 s24, 5
    s_cbranch_scc1 L_pw_100009
    s_lshr_b32 s58, s25, 2
    s_mul_i32 s58, s58, 1179648
    s_mul_i32 s59, s26, 36864
    s_add_u32 s58, s58, s59
    s_lshl_b32 s59, s24, 13
    s_add_u32 s58, s58, s59
    v_lshlrev_b32 v37, 7, v2
    buffer_load_dword v38, v37, s[64:67], s58 offen
    s_branch L_pd_100010

L_pw_100009:
    s_sub_u32 s59, s24, 5
    s_lshl_b32 s59, s59, 3
    s_mul_i32 s58, s26, 18
    s_add_u32 s58, s58, s59
    s_mul_i32 s58, s58, 3456
    s_and_b32 s59, s25, 3
    s_mul_i32 s59, s59, 864
    s_and_b32 s59, s59, 0xffffff80
    s_add_u32 s58, s58, s59
    v_lshrrev_b32 v37, 3, v2
    v_mul_u32_u24 v37, 3456, v37
    v_and_b32 v38, 7, v2
    v_lshlrev_b32 v38, 7, v38
    v_add_u32 v37, v37, v38
    buffer_load_dword v38, v37, s[16:19], s58 offen

L_pd_100010:
    v_and_b32 v3, 31, v2
    v_lshrrev_b32 v4, 5, v2
    s_lshl_b32 s37, s29, 5
    v_add_u32 v5, s37, v3
    v_lshrrev_b32 v6, 1, v5
    v_and_b32 v6, 7, v6
    v_lshlrev_b32 v5, 7, v5

    v_add_u32 v7, 0, v4
    v_xor_b32 v8, v7, v6
    v_lshlrev_b32 v8, 4, v8
    v_add_u32 v58, v5, v8

    v_add_u32 v7, 2, v4
    v_xor_b32 v8, v7, v6
    v_lshlrev_b32 v8, 4, v8
    v_add_u32 v59, v5, v8

    v_add_u32 v7, 4, v4
    v_xor_b32 v8, v7, v6
    v_lshlrev_b32 v8, 4, v8
    v_add_u32 v60, v5, v8

    v_add_u32 v7, 6, v4
    v_xor_b32 v8, v7, v6
    v_lshlrev_b32 v8, 4, v8
    v_add_u32 v61, v5, v8

    v_bfe_u32 v5, v2, 2, 2
    v_and_b32 v6, 3, v2
    v_bfe_u32 v7, v2, 4, 1
    v_and_b32 v8, 1, v6
    v_lshlrev_b32 v8, 4, v8
    v_lshrrev_b32 v9, 1, v6
    v_lshlrev_b32 v9, 3, v9
    v_add_u32 v8, v8, v9
    v_lshlrev_b32 v9, 3, v4
    v_add_u32 v9, v9, v5
    v_lshlrev_b32 v9, 8, v9
    v_add_u32 v9, 49152, v9
    v_lshlrev_b32 v10, 6, v5
    v_cmp_eq_u32 vcc, 1, v7
    s_cmp_eq_u32 s30, 0
    s_cselect_b32 s37, 40, 0
    s_mov_b32 s38, 184
    s_cselect_b32 s38, 72, s38
    v_mov_b32 v11, s37
    v_mov_b32 v12, s38
    v_cndmask_b32 v11, v11, v12, vcc
    v_add_u32 v11, v11, v8
    v_add_u32 v11, v11, v10
    v_and_b32 v11, 255, v11
    v_add_u32 v62, v11, v9
    v_mov_b32 v11, 112
    v_mov_b32 v12, 144
    v_cndmask_b32 v11, v11, v12, vcc
    v_add_u32 v11, v11, v8
    v_lshlrev_b32 v12, 2, v7
    v_add_u32 v12, v12, v6
    v_cmp_gt_u32 vcc, 3, v12
    v_mul_u32_u24 v12, 72, v12
    v_add_u32 v12, 32, v12
    v_mov_b32 v13, 32
    v_cndmask_b32 v12, v13, v12, vcc
    s_cmp_eq_u32 s30, 0
    s_cselect_b64 vcc, -1, 0
    s_nop 1
    v_cndmask_b32 v11, v12, v11, vcc
    v_add_u32 v11, v11, v10
    v_and_b32 v11, 255, v11
    v_add_u32 v63, v11, v9

    s_lshl_b32 s37, s28, 2
    s_add_u32 s36, s37, s29
    s_lshl_b32 s37, s36, 5
    v_add_u32 v24, s37, v3
    s_lshl_b32 s38, s36, 2
    s_add_u32 s38, s38, 7340032
    v_cmp_eq_u32 s[60:61], 31, v3
    v_lshlrev_b32 v25, 8, v4
    s_mul_i32 s39, s27, 6
    v_lshlrev_b32 v26, 4, v24
    v_lshlrev_b32 v27, 15, v4
    v_add_u32 v26, v26, v27
    v_mul_u32_u24 v27, 40, v24
    v_lshlrev_b32 v28, 4, v4
    v_add_u32 v27, v27, v28

    s_cmp_eq_u32 s30, 0
    s_cselect_b32 s40, 1, 0
    s_add_u32 s40, s40, s39
    s_lshr_b32 s41, s40, 5
    s_and_b32 s42, s40, 31
    s_mul_i32 s44, s42, 155648
    s_add_u32 s44, s44, 2359296
    s_add_u32 s43, s44, 73728
    s_lshl_b32 s36, s42, 16
    s_mov_b32 s46, 1.0
    s_cmp_eq_u32 s41, 0
    s_cselect_b32 s44, s36, s44
    s_cselect_b32 s46, 1051597459, s46
    s_cmp_eq_u32 s41, 2
    s_cselect_b32 s44, s43, s44
    s_cselect_b64 vcc, -1, 0
    s_lshl_b32 s45, s40, 10
    s_add_u32 s45, s45, s38
    v_cndmask_b32 v30, v26, v27, vcc

    s_cmp_eq_u32 s30, 0
    s_cselect_b32 s40, 2, 5
    s_add_u32 s40, s40, s39
    s_lshr_b32 s41, s40, 5
    s_and_b32 s42, s40, 31
    s_mul_i32 s47, s42, 155648
    s_add_u32 s47, s47, 2359296
    s_add_u32 s43, s47, 73728
    s_lshl_b32 s36, s42, 16
    s_mov_b32 s49, 1.0
    s_cmp_eq_u32 s41, 0
    s_cselect_b32 s47, s36, s47
    s_cselect_b32 s49, 1051597459, s49
    s_cmp_eq_u32 s41, 2
    s_cselect_b32 s47, s43, s47
    s_cselect_b64 vcc, -1, 0
    s_lshl_b32 s48, s40, 10
    s_add_u32 s48, s48, s38
    v_cndmask_b32 v31, v26, v27, vcc

    s_add_u32 s40, s39, 3
    s_lshr_b32 s41, s40, 5
    s_and_b32 s42, s40, 31
    s_mul_i32 s50, s42, 155648
    s_add_u32 s50, s50, 2359296
    s_add_u32 s43, s50, 73728
    s_lshl_b32 s36, s42, 16
    s_mov_b32 s52, 1.0
    s_cmp_eq_u32 s41, 0
    s_cselect_b32 s50, s36, s50
    s_cselect_b32 s52, 1051597459, s52
    s_cmp_eq_u32 s41, 2
    s_cselect_b32 s50, s43, s50
    s_cselect_b64 vcc, -1, 0
    s_lshl_b32 s51, s40, 10
    s_add_u32 s51, s51, s38
    v_cndmask_b32 v32, v26, v27, vcc

    s_add_u32 s40, s39, 4
    s_lshr_b32 s41, s40, 5
    s_and_b32 s42, s40, 31
    s_mul_i32 s53, s42, 155648
    s_add_u32 s53, s53, 2359296
    s_add_u32 s43, s53, 73728
    s_lshl_b32 s36, s42, 16
    s_mov_b32 s55, 1.0
    s_cmp_eq_u32 s41, 0
    s_cselect_b32 s53, s36, s53
    s_cselect_b32 s55, 1051597459, s55
    s_cmp_eq_u32 s41, 2
    s_cselect_b32 s53, s43, s53
    s_cselect_b64 vcc, -1, 0
    s_lshl_b32 s54, s40, 10
    s_add_u32 s54, s54, s38
    v_cndmask_b32 v33, v26, v27, vcc

    s_waitcnt vmcnt(5)
    s_barrier
    ds_read_b128 v[96:99], v58 offset:0
    ds_read_b64_tr_b16 v[104:105], v62 offset:0
    ds_read_b64_tr_b16 v[106:107], v62 offset:1024
    ds_read_b64_tr_b16 v[108:109], v63 offset:0
    ds_read_b64_tr_b16 v[110:111], v63 offset:1024
    ds_read_b128 v[100:103], v59 offset:0
    ds_read_b64_tr_b16 v[112:113], v62 offset:4096
    ds_read_b64_tr_b16 v[114:115], v62 offset:5120
    ds_read_b64_tr_b16 v[116:117], v63 offset:4096
    ds_read_b64_tr_b16 v[118:119], v63 offset:5120
    s_add_u32 m0, s35, 73728
    s_nop 0
    buffer_load_dwordx4 v36, s[16:19], s33 offen lds
    s_add_u32 s33, s33, 110592
    s_add_u32 m0, s34, 32768
    s_nop 0
    buffer_load_dwordx4 v34, s[64:67], s32 offen lds
    s_add_u32 m0, s34, 33792
    s_nop 0
    buffer_load_dwordx4 v35, s[64:67], s32 offen lds
    s_add_u32 s32, s32, 128
    s_waitcnt lgkmcnt(5)
    v_mfma_f32_32x32x16_bf16 v[64:79], v[104:107], v[96:99], 0
    v_mfma_f32_32x32x16_bf16 v[80:95], v[108:111], v[96:99], 0
    s_waitcnt lgkmcnt(0)
    v_mfma_f32_32x32x16_bf16 v[64:79], v[112:115], v[100:103], v[64:79]
    v_mfma_f32_32x32x16_bf16 v[80:95], v[116:119], v[100:103], v[80:95]
    s_waitcnt vmcnt(7)
    s_barrier
    ds_read_b128 v[96:99], v60 offset:0
    ds_read_b64_tr_b16 v[104:105], v62 offset:8192
    ds_read_b64_tr_b16 v[106:107], v62 offset:9216
    ds_read_b64_tr_b16 v[108:109], v63 offset:8192
    ds_read_b64_tr_b16 v[110:111], v63 offset:9216
    ds_read_b128 v[100:103], v61 offset:0
    ds_read_b64_tr_b16 v[112:113], v62 offset:12288
    ds_read_b64_tr_b16 v[114:115], v62 offset:13312
    ds_read_b64_tr_b16 v[116:117], v63 offset:12288
    ds_read_b64_tr_b16 v[118:119], v63 offset:13312
    s_add_u32 m0, s35, 49152
    s_nop 0
    buffer_load_dwordx4 v36, s[16:19], s33 offen lds
    s_add_u32 s33, s33, 110592
    s_waitcnt lgkmcnt(5)
    v_mfma_f32_32x32x16_bf16 v[64:79], v[104:107], v[96:99], v[64:79]
    v_mfma_f32_32x32x16_bf16 v[80:95], v[108:111], v[96:99], v[80:95]
    s_waitcnt lgkmcnt(0)
    v_mfma_f32_32x32x16_bf16 v[64:79], v[112:115], v[100:103], v[64:79]
    v_mfma_f32_32x32x16_bf16 v[80:95], v[116:119], v[100:103], v[80:95]
    s_waitcnt vmcnt(5)
    s_barrier
    ds_read_b128 v[96:99], v58 offset:16384
    ds_read_b64_tr_b16 v[104:105], v62 offset:16384
    ds_read_b64_tr_b16 v[106:107], v62 offset:17408
    ds_read_b64_tr_b16 v[108:109], v63 offset:16384
    ds_read_b64_tr_b16 v[110:111], v63 offset:17408
    ds_read_b128 v[100:103], v59 offset:16384
    ds_read_b64_tr_b16 v[112:113], v62 offset:20480
    ds_read_b64_tr_b16 v[114:115], v62 offset:21504
    ds_read_b64_tr_b16 v[116:117], v63 offset:20480
    ds_read_b64_tr_b16 v[118:119], v63 offset:21504
    s_add_u32 m0, s35, 57344
    s_nop 0
    buffer_load_dwordx4 v36, s[16:19], s33 offen lds
    s_add_u32 s33, s33, 110592
    s_add_u32 m0, s34, 0
    s_nop 0
    buffer_load_dwordx4 v34, s[64:67], s32 offen lds
    s_add_u32 m0, s34, 1024
    s_nop 0
    buffer_load_dwordx4 v35, s[64:67], s32 offen lds
    s_add_u32 s32, s32, 128
    s_waitcnt lgkmcnt(5)
    v_mfma_f32_32x32x16_bf16 v[64:79], v[104:107], v[96:99], v[64:79]
    v_mfma_f32_32x32x16_bf16 v[80:95], v[108:111], v[96:99], v[80:95]
    s_waitcnt lgkmcnt(0)
    v_mfma_f32_32x32x16_bf16 v[64:79], v[112:115], v[100:103], v[64:79]
    v_mfma_f32_32x32x16_bf16 v[80:95], v[116:119], v[100:103], v[80:95]
    s_waitcnt vmcnt(6)
    s_barrier
    ds_read_b128 v[96:99], v60 offset:16384
    ds_read_b64_tr_b16 v[104:105], v62 offset:24576
    ds_read_b64_tr_b16 v[106:107], v62 offset:25600
    ds_read_b64_tr_b16 v[108:109], v63 offset:24576
    ds_read_b64_tr_b16 v[110:111], v63 offset:25600
    ds_read_b128 v[100:103], v61 offset:16384
    ds_read_b64_tr_b16 v[112:113], v62 offset:28672
    ds_read_b64_tr_b16 v[114:115], v62 offset:29696
    ds_read_b64_tr_b16 v[116:117], v63 offset:28672
    ds_read_b64_tr_b16 v[118:119], v63 offset:29696
    s_add_u32 m0, s35, 65536
    s_nop 0
    buffer_load_dwordx4 v36, s[16:19], s33 offen lds
    s_add_u32 s33, s33, 110592
    s_waitcnt lgkmcnt(5)
    v_mfma_f32_32x32x16_bf16 v[64:79], v[104:107], v[96:99], v[64:79]
    v_mfma_f32_32x32x16_bf16 v[80:95], v[108:111], v[96:99], v[80:95]
    s_waitcnt lgkmcnt(0)
    v_mfma_f32_32x32x16_bf16 v[64:79], v[112:115], v[100:103], v[64:79]
    v_mfma_f32_32x32x16_bf16 v[80:95], v[116:119], v[100:103], v[80:95]
    s_waitcnt vmcnt(4)
    s_barrier
    ds_read_b128 v[96:99], v58 offset:32768
    ds_read_b64_tr_b16 v[104:105], v62 offset:0
    ds_read_b64_tr_b16 v[106:107], v62 offset:1024
    ds_read_b64_tr_b16 v[108:109], v63 offset:0
    ds_read_b64_tr_b16 v[110:111], v63 offset:1024
    ds_read_b128 v[100:103], v59 offset:32768
    ds_read_b64_tr_b16 v[112:113], v62 offset:4096
    ds_read_b64_tr_b16 v[114:115], v62 offset:5120
    ds_read_b64_tr_b16 v[116:117], v63 offset:4096
    ds_read_b64_tr_b16 v[118:119], v63 offset:5120
    s_add_u32 m0, s35, 73728
    s_nop 0
    buffer_load_dwordx4 v36, s[16:19], s33 offen lds
    s_add_u32 s33, s33, 110592
    s_add_u32 m0, s34, 16384
    s_nop 0
    buffer_load_dwordx4 v34, s[64:67], s32 offen lds
    s_add_u32 m0, s34, 17408
    s_nop 0
    buffer_load_dwordx4 v35, s[64:67], s32 offen lds
    s_add_u32 s32, s32, 128
    s_waitcnt lgkmcnt(5)
    v_mfma_f32_32x32x16_bf16 v[64:79], v[104:107], v[96:99], v[64:79]
    v_mfma_f32_32x32x16_bf16 v[80:95], v[108:111], v[96:99], v[80:95]
    s_waitcnt lgkmcnt(0)
    v_mfma_f32_32x32x16_bf16 v[64:79], v[112:115], v[100:103], v[64:79]
    v_mfma_f32_32x32x16_bf16 v[80:95], v[116:119], v[100:103], v[80:95]
    s_waitcnt vmcnt(6)
    s_barrier
    ds_read_b128 v[96:99], v60 offset:32768
    ds_read_b64_tr_b16 v[104:105], v62 offset:8192
    ds_read_b64_tr_b16 v[106:107], v62 offset:9216
    ds_read_b64_tr_b16 v[108:109], v63 offset:8192
    ds_read_b64_tr_b16 v[110:111], v63 offset:9216
    ds_read_b128 v[100:103], v61 offset:32768
    ds_read_b64_tr_b16 v[112:113], v62 offset:12288
    ds_read_b64_tr_b16 v[114:115], v62 offset:13312
    ds_read_b64_tr_b16 v[116:117], v63 offset:12288
    ds_read_b64_tr_b16 v[118:119], v63 offset:13312
    s_add_u32 m0, s35, 49152
    s_nop 0
    buffer_load_dwordx4 v36, s[16:19], s33 offen lds
    s_add_u32 s33, s33, 110592
    s_waitcnt lgkmcnt(5)
    v_mfma_f32_32x32x16_bf16 v[64:79], v[104:107], v[96:99], v[64:79]
    v_mfma_f32_32x32x16_bf16 v[80:95], v[108:111], v[96:99], v[80:95]
    s_waitcnt lgkmcnt(0)
    v_mfma_f32_32x32x16_bf16 v[64:79], v[112:115], v[100:103], v[64:79]
    v_mfma_f32_32x32x16_bf16 v[80:95], v[116:119], v[100:103], v[80:95]
    s_waitcnt vmcnt(4)
    s_barrier
    ds_read_b128 v[96:99], v58 offset:0
    ds_read_b64_tr_b16 v[104:105], v62 offset:16384
    ds_read_b64_tr_b16 v[106:107], v62 offset:17408
    ds_read_b64_tr_b16 v[108:109], v63 offset:16384
    ds_read_b64_tr_b16 v[110:111], v63 offset:17408
    ds_read_b128 v[100:103], v59 offset:0
    ds_read_b64_tr_b16 v[112:113], v62 offset:20480
    ds_read_b64_tr_b16 v[114:115], v62 offset:21504
    ds_read_b64_tr_b16 v[116:117], v63 offset:20480
    ds_read_b64_tr_b16 v[118:119], v63 offset:21504
    s_add_u32 m0, s35, 57344
    s_nop 0
    buffer_load_dwordx4 v36, s[16:19], s33 offen lds
    s_add_u32 s33, s33, 110592
    s_add_u32 m0, s34, 32768
    s_nop 0
    buffer_load_dwordx4 v34, s[64:67], s32 offen lds
    s_add_u32 m0, s34, 33792
    s_nop 0
    buffer_load_dwordx4 v35, s[64:67], s32 offen lds
    s_add_u32 s32, s32, 128
    s_waitcnt lgkmcnt(5)
    v_mfma_f32_32x32x16_bf16 v[64:79], v[104:107], v[96:99], v[64:79]
    v_mfma_f32_32x32x16_bf16 v[80:95], v[108:111], v[96:99], v[80:95]
    s_waitcnt lgkmcnt(0)
    v_mfma_f32_32x32x16_bf16 v[64:79], v[112:115], v[100:103], v[64:79]
    v_mfma_f32_32x32x16_bf16 v[80:95], v[116:119], v[100:103], v[80:95]
    s_waitcnt vmcnt(6)
    s_barrier
    ds_read_b128 v[96:99], v60 offset:0
    ds_read_b64_tr_b16 v[104:105], v62 offset:24576
    ds_read_b64_tr_b16 v[106:107], v62 offset:25600
    ds_read_b64_tr_b16 v[108:109], v63 offset:24576
    ds_read_b64_tr_b16 v[110:111], v63 offset:25600
    ds_read_b128 v[100:103], v61 offset:0
    ds_read_b64_tr_b16 v[112:113], v62 offset:28672
    ds_read_b64_tr_b16 v[114:115], v62 offset:29696
    ds_read_b64_tr_b16 v[116:117], v63 offset:28672
    ds_read_b64_tr_b16 v[118:119], v63 offset:29696
    s_add_u32 m0, s35, 65536
    s_nop 0
    buffer_load_dwordx4 v36, s[16:19], s33 offen lds
    s_add_u32 s33, s33, 110592
    s_waitcnt lgkmcnt(5)
    v_mfma_f32_32x32x16_bf16 v[64:79], v[104:107], v[96:99], v[64:79]
    v_mfma_f32_32x32x16_bf16 v[80:95], v[108:111], v[96:99], v[80:95]
    s_waitcnt lgkmcnt(0)
    v_mfma_f32_32x32x16_bf16 v[64:79], v[112:115], v[100:103], v[64:79]
    v_mfma_f32_32x32x16_bf16 v[80:95], v[116:119], v[100:103], v[80:95]
    s_waitcnt vmcnt(4)
    s_barrier
    ds_read_b128 v[96:99], v58 offset:16384
    ds_read_b64_tr_b16 v[104:105], v62 offset:0
    ds_read_b64_tr_b16 v[106:107], v62 offset:1024
    ds_read_b64_tr_b16 v[108:109], v63 offset:0
    ds_read_b64_tr_b16 v[110:111], v63 offset:1024
    ds_read_b128 v[100:103], v59 offset:16384
    ds_read_b64_tr_b16 v[112:113], v62 offset:4096
    ds_read_b64_tr_b16 v[114:115], v62 offset:5120
    ds_read_b64_tr_b16 v[116:117], v63 offset:4096
    ds_read_b64_tr_b16 v[118:119], v63 offset:5120
    s_add_u32 m0, s35, 73728
    s_nop 0
    buffer_load_dwordx4 v36, s[16:19], s33 offen lds
    s_add_u32 s33, s33, 110592
    s_add_u32 m0, s34, 0
    s_nop 0
    buffer_load_dwordx4 v34, s[64:67], s32 offen lds
    s_add_u32 m0, s34, 1024
    s_nop 0
    buffer_load_dwordx4 v35, s[64:67], s32 offen lds
    s_add_u32 s32, s32, 128
    s_waitcnt lgkmcnt(5)
    v_mfma_f32_32x32x16_bf16 v[64:79], v[104:107], v[96:99], v[64:79]
    v_mfma_f32_32x32x16_bf16 v[80:95], v[108:111], v[96:99], v[80:95]
    s_waitcnt lgkmcnt(0)
    v_mfma_f32_32x32x16_bf16 v[64:79], v[112:115], v[100:103], v[64:79]
    v_mfma_f32_32x32x16_bf16 v[80:95], v[116:119], v[100:103], v[80:95]
    s_waitcnt vmcnt(6)
    s_barrier
    ds_read_b128 v[96:99], v60 offset:16384
    ds_read_b64_tr_b16 v[104:105], v62 offset:8192
    ds_read_b64_tr_b16 v[106:107], v62 offset:9216
    ds_read_b64_tr_b16 v[108:109], v63 offset:8192
    ds_read_b64_tr_b16 v[110:111], v63 offset:9216
    ds_read_b128 v[100:103], v61 offset:16384
    ds_read_b64_tr_b16 v[112:113], v62 offset:12288
    ds_read_b64_tr_b16 v[114:115], v62 offset:13312
    ds_read_b64_tr_b16 v[116:117], v63 offset:12288
    ds_read_b64_tr_b16 v[118:119], v63 offset:13312
    s_add_u32 m0, s35, 49152
    s_nop 0
    buffer_load_dwordx4 v36, s[16:19], s33 offen lds
    s_add_u32 s33, s33, 110592
    s_waitcnt lgkmcnt(5)
    v_mfma_f32_32x32x16_bf16 v[64:79], v[104:107], v[96:99], v[64:79]
    v_mfma_f32_32x32x16_bf16 v[80:95], v[108:111], v[96:99], v[80:95]
    s_waitcnt lgkmcnt(0)
    v_mfma_f32_32x32x16_bf16 v[64:79], v[112:115], v[100:103], v[64:79]
    v_mfma_f32_32x32x16_bf16 v[80:95], v[116:119], v[100:103], v[80:95]
    s_waitcnt vmcnt(4)
    s_barrier
    ds_read_b128 v[96:99], v58 offset:32768
    ds_read_b64_tr_b16 v[104:105], v62 offset:16384
    ds_read_b64_tr_b16 v[106:107], v62 offset:17408
    ds_read_b64_tr_b16 v[108:109], v63 offset:16384
    ds_read_b64_tr_b16 v[110:111], v63 offset:17408
    ds_read_b128 v[100:103], v59 offset:32768
    ds_read_b64_tr_b16 v[112:113], v62 offset:20480
    ds_read_b64_tr_b16 v[114:115], v62 offset:21504
    ds_read_b64_tr_b16 v[116:117], v63 offset:20480
    ds_read_b64_tr_b16 v[118:119], v63 offset:21504
    s_add_u32 m0, s35, 57344
    s_nop 0
    buffer_load_dwordx4 v36, s[16:19], s33 offen lds
    s_add_u32 s33, s33, 110592
    s_add_u32 m0, s34, 16384
    s_nop 0
    buffer_load_dwordx4 v34, s[64:67], s32 offen lds
    s_add_u32 m0, s34, 17408
    s_nop 0
    buffer_load_dwordx4 v35, s[64:67], s32 offen lds
    s_add_u32 s32, s32, 128
    s_waitcnt lgkmcnt(5)
    v_mfma_f32_32x32x16_bf16 v[64:79], v[104:107], v[96:99], v[64:79]
    v_mfma_f32_32x32x16_bf16 v[80:95], v[108:111], v[96:99], v[80:95]
    s_waitcnt lgkmcnt(0)
    v_mfma_f32_32x32x16_bf16 v[64:79], v[112:115], v[100:103], v[64:79]
    v_mfma_f32_32x32x16_bf16 v[80:95], v[116:119], v[100:103], v[80:95]
    s_waitcnt vmcnt(6)
    s_barrier
    ds_read_b128 v[96:99], v60 offset:32768
    ds_read_b64_tr_b16 v[104:105], v62 offset:24576
    ds_read_b64_tr_b16 v[106:107], v62 offset:25600
    ds_read_b64_tr_b16 v[108:109], v63 offset:24576
    ds_read_b64_tr_b16 v[110:111], v63 offset:25600
    ds_read_b128 v[100:103], v61 offset:32768
    ds_read_b64_tr_b16 v[112:113], v62 offset:28672
    ds_read_b64_tr_b16 v[114:115], v62 offset:29696
    ds_read_b64_tr_b16 v[116:117], v63 offset:28672
    ds_read_b64_tr_b16 v[118:119], v63 offset:29696
    s_add_u32 m0, s35, 65536
    s_nop 0
    buffer_load_dwordx4 v36, s[16:19], s33 offen lds
    s_add_u32 s33, s33, 110592
    s_waitcnt lgkmcnt(5)
    v_mfma_f32_32x32x16_bf16 v[64:79], v[104:107], v[96:99], v[64:79]
    v_mfma_f32_32x32x16_bf16 v[80:95], v[108:111], v[96:99], v[80:95]
    s_waitcnt lgkmcnt(0)
    v_mfma_f32_32x32x16_bf16 v[64:79], v[112:115], v[100:103], v[64:79]
    v_mfma_f32_32x32x16_bf16 v[80:95], v[116:119], v[100:103], v[80:95]
    s_waitcnt vmcnt(4)
    s_barrier
    ds_read_b128 v[96:99], v58 offset:0
    ds_read_b64_tr_b16 v[104:105], v62 offset:0
    ds_read_b64_tr_b16 v[106:107], v62 offset:1024
    ds_read_b64_tr_b16 v[108:109], v63 offset:0
    ds_read_b64_tr_b16 v[110:111], v63 offset:1024
    ds_read_b128 v[100:103], v59 offset:0
    ds_read_b64_tr_b16 v[112:113], v62 offset:4096
    ds_read_b64_tr_b16 v[114:115], v62 offset:5120
    ds_read_b64_tr_b16 v[116:117], v63 offset:4096
    ds_read_b64_tr_b16 v[118:119], v63 offset:5120
    s_add_u32 m0, s35, 73728
    s_nop 0
    buffer_load_dwordx4 v36, s[16:19], s33 offen lds
    s_add_u32 s33, s33, 110592
    s_add_u32 m0, s34, 32768
    s_nop 0
    buffer_load_dwordx4 v34, s[64:67], s32 offen lds
    s_add_u32 m0, s34, 33792
    s_nop 0
    buffer_load_dwordx4 v35, s[64:67], s32 offen lds
    s_add_u32 s32, s32, 128
    s_waitcnt lgkmcnt(5)
    v_mfma_f32_32x32x16_bf16 v[64:79], v[104:107], v[96:99], v[64:79]
    v_mfma_f32_32x32x16_bf16 v[80:95], v[108:111], v[96:99], v[80:95]
    s_waitcnt lgkmcnt(0)
    v_mfma_f32_32x32x16_bf16 v[64:79], v[112:115], v[100:103], v[64:79]
    v_mfma_f32_32x32x16_bf16 v[80:95], v[116:119], v[100:103], v[80:95]
    s_waitcnt vmcnt(6)
    s_barrier
    ds_read_b128 v[96:99], v60 offset:0
    ds_read_b64_tr_b16 v[104:105], v62 offset:8192
    ds_read_b64_tr_b16 v[106:107], v62 offset:9216
    ds_read_b64_tr_b16 v[108:109], v63 offset:8192
    ds_read_b64_tr_b16 v[110:111], v63 offset:9216
    ds_read_b128 v[100:103], v61 offset:0
    ds_read_b64_tr_b16 v[112:113], v62 offset:12288
    ds_read_b64_tr_b16 v[114:115], v62 offset:13312
    ds_read_b64_tr_b16 v[116:117], v63 offset:12288
    ds_read_b64_tr_b16 v[118:119], v63 offset:13312
    s_add_u32 m0, s35, 49152
    s_nop 0
    buffer_load_dwordx4 v36, s[16:19], s33 offen lds
    s_add_u32 s33, s33, 110592
    s_waitcnt lgkmcnt(5)
    v_mfma_f32_32x32x16_bf16 v[64:79], v[104:107], v[96:99], v[64:79]
    v_mfma_f32_32x32x16_bf16 v[80:95], v[108:111], v[96:99], v[80:95]
    s_waitcnt lgkmcnt(0)
    v_mfma_f32_32x32x16_bf16 v[64:79], v[112:115], v[100:103], v[64:79]
    v_mfma_f32_32x32x16_bf16 v[80:95], v[116:119], v[100:103], v[80:95]
    s_waitcnt vmcnt(4)
    s_barrier
    ds_read_b128 v[96:99], v58 offset:16384
    ds_read_b64_tr_b16 v[104:105], v62 offset:16384
    ds_read_b64_tr_b16 v[106:107], v62 offset:17408
    ds_read_b64_tr_b16 v[108:109], v63 offset:16384
    ds_read_b64_tr_b16 v[110:111], v63 offset:17408
    ds_read_b128 v[100:103], v59 offset:16384
    ds_read_b64_tr_b16 v[112:113], v62 offset:20480
    ds_read_b64_tr_b16 v[114:115], v62 offset:21504
    ds_read_b64_tr_b16 v[116:117], v63 offset:20480
    ds_read_b64_tr_b16 v[118:119], v63 offset:21504
    s_add_u32 m0, s35, 57344
    s_nop 0
    buffer_load_dwordx4 v36, s[16:19], s33 offen lds
    s_add_u32 s33, s33, 110592
    s_waitcnt lgkmcnt(5)
    v_mfma_f32_32x32x16_bf16 v[64:79], v[104:107], v[96:99], v[64:79]
    v_mfma_f32_32x32x16_bf16 v[80:95], v[108:111], v[96:99], v[80:95]
    s_waitcnt lgkmcnt(0)
    v_mfma_f32_32x32x16_bf16 v[64:79], v[112:115], v[100:103], v[64:79]
    v_mfma_f32_32x32x16_bf16 v[80:95], v[116:119], v[100:103], v[80:95]
    s_waitcnt vmcnt(4)
    s_barrier
    ds_read_b128 v[96:99], v60 offset:16384
    ds_read_b64_tr_b16 v[104:105], v62 offset:24576
    ds_read_b64_tr_b16 v[106:107], v62 offset:25600
    ds_read_b64_tr_b16 v[108:109], v63 offset:24576
    ds_read_b64_tr_b16 v[110:111], v63 offset:25600
    ds_read_b128 v[100:103], v61 offset:16384
    ds_read_b64_tr_b16 v[112:113], v62 offset:28672
    ds_read_b64_tr_b16 v[114:115], v62 offset:29696
    ds_read_b64_tr_b16 v[116:117], v63 offset:28672
    ds_read_b64_tr_b16 v[118:119], v63 offset:29696
    s_waitcnt lgkmcnt(5)
    v_mfma_f32_32x32x16_bf16 v[64:79], v[104:107], v[96:99], v[64:79]
    v_mfma_f32_32x32x16_bf16 v[80:95], v[108:111], v[96:99], v[80:95]
    s_waitcnt lgkmcnt(0)
    v_mfma_f32_32x32x16_bf16 v[64:79], v[112:115], v[100:103], v[64:79]
    v_mfma_f32_32x32x16_bf16 v[80:95], v[116:119], v[100:103], v[80:95]
    s_waitcnt vmcnt(1)
    s_barrier
    ds_read_b128 v[96:99], v58 offset:32768
    ds_read_b64_tr_b16 v[104:105], v62 offset:0
    ds_read_b64_tr_b16 v[106:107], v62 offset:1024
    ds_read_b64_tr_b16 v[108:109], v63 offset:0
    ds_read_b64_tr_b16 v[110:111], v63 offset:1024
    ds_read_b128 v[100:103], v59 offset:32768
    ds_read_b64_tr_b16 v[112:113], v62 offset:4096
    ds_read_b64_tr_b16 v[114:115], v62 offset:5120
    ds_read_b64_tr_b16 v[116:117], v63 offset:4096
    ds_read_b64_tr_b16 v[118:119], v63 offset:5120
    s_waitcnt lgkmcnt(5)
    v_mfma_f32_32x32x16_bf16 v[64:79], v[104:107], v[96:99], v[64:79]
    v_mfma_f32_32x32x16_bf16 v[80:95], v[108:111], v[96:99], v[80:95]
    s_waitcnt lgkmcnt(0)
    v_mfma_f32_32x32x16_bf16 v[64:79], v[112:115], v[100:103], v[64:79]
    v_mfma_f32_32x32x16_bf16 v[80:95], v[116:119], v[100:103], v[80:95]
    s_waitcnt vmcnt(0)
    s_barrier
    ds_read_b128 v[96:99], v60 offset:32768
    ds_read_b64_tr_b16 v[104:105], v62 offset:8192
    ds_read_b64_tr_b16 v[106:107], v62 offset:9216
    ds_read_b64_tr_b16 v[108:109], v63 offset:8192
    ds_read_b64_tr_b16 v[110:111], v63 offset:9216
    ds_read_b128 v[100:103], v61 offset:32768
    ds_read_b64_tr_b16 v[112:113], v62 offset:12288
    ds_read_b64_tr_b16 v[114:115], v62 offset:13312
    ds_read_b64_tr_b16 v[116:117], v63 offset:12288
    ds_read_b64_tr_b16 v[118:119], v63 offset:13312
    s_waitcnt lgkmcnt(5)
    v_mfma_f32_32x32x16_bf16 v[64:79], v[104:107], v[96:99], v[64:79]
    v_mfma_f32_32x32x16_bf16 v[80:95], v[108:111], v[96:99], v[80:95]
    s_waitcnt lgkmcnt(0)
    v_mfma_f32_32x32x16_bf16 v[64:79], v[112:115], v[100:103], v[64:79]
    v_mfma_f32_32x32x16_bf16 v[80:95], v[116:119], v[100:103], v[80:95]
    s_nop 7
    s_nop 3
    v_mul_f32 v64, s46, v64
    v_mul_f32 v65, s46, v65
    v_mul_f32 v66, s46, v66
    v_mul_f32 v67, s46, v67
    v_mul_f32 v68, s46, v68
    v_mul_f32 v69, s46, v69
    v_mul_f32 v70, s46, v70
    v_mul_f32 v71, s46, v71
    v_cvt_pk_bf16_f32 v96, v64, v65
    v_cvt_pk_bf16_f32 v97, v66, v67
    v_cvt_pk_bf16_f32 v98, v68, v69
    v_cvt_pk_bf16_f32 v99, v70, v71
    buffer_store_dwordx4 v[96:99], v30, s[20:23], s44 offen
    v_mul_f32 v40, v64, v64
    v_fmac_f32 v40, v65, v65
    v_fmac_f32 v40, v66, v66
    v_fmac_f32 v40, v67, v67
    v_fmac_f32 v40, v68, v68
    v_fmac_f32 v40, v69, v69
    v_fmac_f32 v40, v70, v70
    v_fmac_f32 v40, v71, v71
    v_mul_f32 v72, s49, v72
    v_mul_f32 v73, s49, v73
    v_mul_f32 v74, s49, v74
    v_mul_f32 v75, s49, v75
    v_mul_f32 v76, s49, v76
    v_mul_f32 v77, s49, v77
    v_mul_f32 v78, s49, v78
    v_mul_f32 v79, s49, v79
    v_cvt_pk_bf16_f32 v100, v72, v73
    v_cvt_pk_bf16_f32 v101, v74, v75
    v_cvt_pk_bf16_f32 v102, v76, v77
    v_cvt_pk_bf16_f32 v103, v78, v79
    buffer_store_dwordx4 v[100:103], v31, s[20:23], s47 offen
    v_mul_f32 v41, v72, v72
    v_fmac_f32 v41, v73, v73
    v_fmac_f32 v41, v74, v74
    v_fmac_f32 v41, v75, v75
    v_fmac_f32 v41, v76, v76
    v_fmac_f32 v41, v77, v77
    v_fmac_f32 v41, v78, v78
    v_fmac_f32 v41, v79, v79
    s_cmp_eq_u32 s30, 0
    s_cbranch_scc0 L_left_100011
    v_mul_f32 v80, s52, v80
    v_mul_f32 v81, s52, v81
    v_mul_f32 v82, s52, v82
    v_mul_f32 v83, s52, v83
    v_mul_f32 v84, s52, v84
    v_mul_f32 v85, s52, v85
    v_mul_f32 v86, s52, v86
    v_mul_f32 v87, s52, v87
    v_cvt_pk_bf16_f32 v104, v80, v81
    v_cvt_pk_bf16_f32 v105, v82, v83
    v_cvt_pk_bf16_f32 v106, v84, v85
    v_cvt_pk_bf16_f32 v107, v86, v87
    buffer_store_dwordx4 v[104:107], v32, s[20:23], s50 offen
    v_mul_f32 v42, v80, v80
    v_fmac_f32 v42, v81, v81
    v_fmac_f32 v42, v82, v82
    v_fmac_f32 v42, v83, v83
    v_fmac_f32 v42, v84, v84
    v_fmac_f32 v42, v85, v85
    v_fmac_f32 v42, v86, v86
    v_fmac_f32 v42, v87, v87
    v_mul_f32 v88, s55, v88
    v_mul_f32 v89, s55, v89
    v_mul_f32 v90, s55, v90
    v_mul_f32 v91, s55, v91
    v_mul_f32 v92, s55, v92
    v_mul_f32 v93, s55, v93
    v_mul_f32 v94, s55, v94
    v_mul_f32 v95, s55, v95
    v_cvt_pk_bf16_f32 v108, v88, v89
    v_cvt_pk_bf16_f32 v109, v90, v91
    v_cvt_pk_bf16_f32 v110, v92, v93
    v_cvt_pk_bf16_f32 v111, v94, v95
    buffer_store_dwordx4 v[108:111], v33, s[20:23], s53 offen
    v_mul_f32 v43, v88, v88
    v_fmac_f32 v43, v89, v89
    v_fmac_f32 v43, v90, v90
    v_fmac_f32 v43, v91, v91
    v_fmac_f32 v43, v92, v92
    v_fmac_f32 v43, v93, v93
    v_fmac_f32 v43, v94, v94
    v_fmac_f32 v43, v95, v95
    v_max_f32_dpp v40, v40, v40 row_shr:1 row_mask:0xf bank_mask:0xf
    v_max_f32_dpp v41, v41, v41 row_shr:1 row_mask:0xf bank_mask:0xf
    v_max_f32_dpp v42, v42, v42 row_shr:1 row_mask:0xf bank_mask:0xf
    v_max_f32_dpp v43, v43, v43 row_shr:1 row_mask:0xf bank_mask:0xf
    v_max_f32_dpp v40, v40, v40 row_shr:2 row_mask:0xf bank_mask:0xf
    v_max_f32_dpp v41, v41, v41 row_shr:2 row_mask:0xf bank_mask:0xf
    v_max_f32_dpp v42, v42, v42 row_shr:2 row_mask:0xf bank_mask:0xf
    v_max_f32_dpp v43, v43, v43 row_shr:2 row_mask:0xf bank_mask:0xf
    v_max_f32_dpp v40, v40, v40 row_shr:4 row_mask:0xf bank_mask:0xf
    v_max_f32_dpp v41, v41, v41 row_shr:4 row_mask:0xf bank_mask:0xf
    v_max_f32_dpp v42, v42, v42 row_shr:4 row_mask:0xf bank_mask:0xf
    v_max_f32_dpp v43, v43, v43 row_shr:4 row_mask:0xf bank_mask:0xf
    v_max_f32_dpp v40, v40, v40 row_shr:8 row_mask:0xf bank_mask:0xf
    v_max_f32_dpp v41, v41, v41 row_shr:8 row_mask:0xf bank_mask:0xf
    v_max_f32_dpp v42, v42, v42 row_shr:8 row_mask:0xf bank_mask:0xf
    v_max_f32_dpp v43, v43, v43 row_shr:8 row_mask:0xf bank_mask:0xf
    v_max_f32_dpp v40, v40, v40 row_bcast:15 row_mask:0xa bank_mask:0xf
    v_max_f32_dpp v41, v41, v41 row_bcast:15 row_mask:0xa bank_mask:0xf
    v_max_f32_dpp v42, v42, v42 row_bcast:15 row_mask:0xa bank_mask:0xf
    v_max_f32_dpp v43, v43, v43 row_bcast:15 row_mask:0xa bank_mask:0xf
    s_mov_b64 exec, s[60:61]
    buffer_store_dword v40, v25, s[20:23], s45 offen
    buffer_store_dword v41, v25, s[20:23], s48 offen
    buffer_store_dword v42, v25, s[20:23], s51 offen
    buffer_store_dword v43, v25, s[20:23], s54 offen
    s_mov_b64 exec, -1
    s_branch L_k1_kernel_fin
L_left_100011:
    v_cmp_eq_u32 s[62:63], 0, v4
    v_cmp_eq_u32 s[68:69], 1, v4
    v_cmp_eq_u32 s[54:55], 63, v2
    v_cmp_eq_u32 s[56:57], 31, v2
    v_mov_b32 v44, 0x3f80
    v_lshlrev_b32 v45, 2, v24
    v_mul_u32_u24 v46, 40, v24
    v_mov_b32 v47, 0

    s_add_u32 s40, s39, 0
    s_lshr_b32 s41, s40, 5
    s_and_b32 s42, s40, 31
    s_mov_b32 s36, 1.0
    s_mul_i32 s43, s42, 155648
    s_add_u32 s43, s43, 2424832
    s_lshl_b32 s37, s42, 13
    s_add_u32 s37, s37, 2097152
    s_cmp_eq_u32 s41, 0
    s_cselect_b32 s43, s37, s43
    s_cselect_b32 s36, 1051597459, s36
    v_mul_f32 v48, s36, v80
    v_mul_f32 v49, s36, v81
    v_mul_f32 v52, v48, v48
    v_fmac_f32 v52, v49, v49
    v_cvt_pk_bf16_f32 v104, v48, v49
    v_mov_b32 v105, v44
    s_mov_b64 exec, s[62:63]
    s_cmp_eq_u32 s41, 2
    s_cbranch_scc1 L_lv_100012
    buffer_store_dword v104, v45, s[20:23], s43 offen
    s_branch L_lst_100013

L_lv_100012:
    s_add_u32 s43, s43, 8224
    buffer_store_dwordx2 v[104:105], v46, s[20:23], s43 offen

L_lst_100013:
    s_mov_b64 exec, -1
    s_add_u32 s40, s39, 1
    s_lshr_b32 s41, s40, 5
    s_and_b32 s42, s40, 31
    s_mov_b32 s36, 1.0
    s_mul_i32 s43, s42, 155648
    s_add_u32 s43, s43, 2424832
    s_lshl_b32 s37, s42, 13
    s_add_u32 s37, s37, 2097152
    s_cmp_eq_u32 s41, 0
    s_cselect_b32 s43, s37, s43
    s_cselect_b32 s36, 1051597459, s36
    v_mul_f32 v48, s36, v82
    v_mul_f32 v49, s36, v83
    v_mul_f32 v53, v48, v48
    v_fmac_f32 v53, v49, v49
    v_cvt_pk_bf16_f32 v106, v48, v49
    v_mov_b32 v107, v44
    s_mov_b64 exec, s[62:63]
    s_cmp_eq_u32 s41, 2
    s_cbranch_scc1 L_lv_100014
    buffer_store_dword v106, v45, s[20:23], s43 offen
    s_branch L_lst_100015

L_lv_100014:
    s_add_u32 s43, s43, 8224
    buffer_store_dwordx2 v[106:107], v46, s[20:23], s43 offen

L_lst_100015:
    s_mov_b64 exec, -1
    s_add_u32 s40, s39, 2
    s_lshr_b32 s41, s40, 5
    s_and_b32 s42, s40, 31
    s_mov_b32 s36, 1.0
    s_mul_i32 s43, s42, 155648
    s_add_u32 s43, s43, 2424832
    s_lshl_b32 s37, s42, 13
    s_add_u32 s37, s37, 2097152
    s_cmp_eq_u32 s41, 0
    s_cselect_b32 s43, s37, s43
    s_cselect_b32 s36, 1051597459, s36
    v_mul_f32 v48, s36, v80
    v_mul_f32 v49, s36, v81
    v_mul_f32 v54, v48, v48
    v_fmac_f32 v54, v49, v49
    v_cvt_pk_bf16_f32 v108, v48, v49
    v_mov_b32 v109, v44
    s_mov_b64 exec, s[68:69]
    s_cmp_eq_u32 s41, 2
    s_cbranch_scc1 L_lv_100016
    buffer_store_dword v108, v45, s[20:23], s43 offen
    s_branch L_lst_100017

L_lv_100016:
    s_add_u32 s43, s43, 8224
    buffer_store_dwordx2 v[108:109], v46, s[20:23], s43 offen

L_lst_100017:
    s_mov_b64 exec, -1
    s_add_u32 s40, s39, 3
    s_lshr_b32 s41, s40, 5
    s_and_b32 s42, s40, 31
    s_mov_b32 s36, 1.0
    s_mul_i32 s43, s42, 155648
    s_add_u32 s43, s43, 2424832
    s_lshl_b32 s37, s42, 13
    s_add_u32 s37, s37, 2097152
    s_cmp_eq_u32 s41, 0
    s_cselect_b32 s43, s37, s43
    s_cselect_b32 s36, 1051597459, s36
    v_mul_f32 v48, s36, v82
    v_mul_f32 v49, s36, v83
    v_mul_f32 v55, v48, v48
    v_fmac_f32 v55, v49, v49
    v_cvt_pk_bf16_f32 v110, v48, v49
    v_mov_b32 v111, v44
    s_mov_b64 exec, s[68:69]
    s_cmp_eq_u32 s41, 2
    s_cbranch_scc1 L_lv_100018
    buffer_store_dword v110, v45, s[20:23], s43 offen
    s_branch L_lst_100019

L_lv_100018:
    s_add_u32 s43, s43, 8224
    buffer_store_dwordx2 v[110:111], v46, s[20:23], s43 offen

L_lst_100019:
    s_mov_b64 exec, -1
    s_add_u32 s40, s39, 4
    s_lshr_b32 s41, s40, 5
    s_and_b32 s42, s40, 31
    s_mov_b32 s36, 1.0
    s_mul_i32 s43, s42, 155648
    s_add_u32 s43, s43, 2424832
    s_lshl_b32 s37, s42, 13
    s_add_u32 s37, s37, 2097152
    s_cmp_eq_u32 s41, 0
    s_cselect_b32 s43, s37, s43
    s_cselect_b32 s36, 1051597459, s36
    v_mul_f32 v48, s36, v84
    v_mul_f32 v49, s36, v85
    v_mul_f32 v56, v48, v48
    v_fmac_f32 v56, v49, v49
    v_cvt_pk_bf16_f32 v112, v48, v49
    v_mov_b32 v113, v44
    s_mov_b64 exec, s[62:63]
    s_cmp_eq_u32 s41, 2
    s_cbranch_scc1 L_lv_100020
    buffer_store_dword v112, v45, s[20:23], s43 offen
    s_branch L_lst_100021

L_lv_100020:
    s_add_u32 s43, s43, 8224
    buffer_store_dwordx2 v[112:113], v46, s[20:23], s43 offen

L_lst_100021:
    s_mov_b64 exec, -1
    s_add_u32 s40, s39, 5
    s_lshr_b32 s41, s40, 5
    s_and_b32 s42, s40, 31
    s_mov_b32 s36, 1.0
    s_mul_i32 s43, s42, 155648
    s_add_u32 s43, s43, 2424832
    s_lshl_b32 s37, s42, 13
    s_add_u32 s37, s37, 2097152
    s_cmp_eq_u32 s41, 0
    s_cselect_b32 s43, s37, s43
    s_cselect_b32 s36, 1051597459, s36
    v_mul_f32 v48, s36, v86
    v_mul_f32 v49, s36, v87
    v_mul_f32 v57, v48, v48
    v_fmac_f32 v57, v49, v49
    v_cvt_pk_bf16_f32 v114, v48, v49
    v_mov_b32 v115, v44
    s_mov_b64 exec, s[62:63]
    s_cmp_eq_u32 s41, 2
    s_cbranch_scc1 L_lv_100022
    buffer_store_dword v114, v45, s[20:23], s43 offen
    s_branch L_lst_100023

L_lv_100022:
    s_add_u32 s43, s43, 8224
    buffer_store_dwordx2 v[114:115], v46, s[20:23], s43 offen

L_lst_100023:
    s_mov_b64 exec, -1
    v_max_f32_dpp v40, v40, v40 row_shr:1 row_mask:0xf bank_mask:0xf
    v_max_f32_dpp v41, v41, v41 row_shr:1 row_mask:0xf bank_mask:0xf
    v_max_f32_dpp v52, v52, v52 row_shr:1 row_mask:0xf bank_mask:0xf
    v_max_f32_dpp v53, v53, v53 row_shr:1 row_mask:0xf bank_mask:0xf
    v_max_f32_dpp v54, v54, v54 row_shr:1 row_mask:0xf bank_mask:0xf
    v_max_f32_dpp v55, v55, v55 row_shr:1 row_mask:0xf bank_mask:0xf
    v_max_f32_dpp v56, v56, v56 row_shr:1 row_mask:0xf bank_mask:0xf
    v_max_f32_dpp v57, v57, v57 row_shr:1 row_mask:0xf bank_mask:0xf
    v_max_f32_dpp v40, v40, v40 row_shr:2 row_mask:0xf bank_mask:0xf
    v_max_f32_dpp v41, v41, v41 row_shr:2 row_mask:0xf bank_mask:0xf
    v_max_f32_dpp v52, v52, v52 row_shr:2 row_mask:0xf bank_mask:0xf
    v_max_f32_dpp v53, v53, v53 row_shr:2 row_mask:0xf bank_mask:0xf
    v_max_f32_dpp v54, v54, v54 row_shr:2 row_mask:0xf bank_mask:0xf
    v_max_f32_dpp v55, v55, v55 row_shr:2 row_mask:0xf bank_mask:0xf
    v_max_f32_dpp v56, v56, v56 row_shr:2 row_mask:0xf bank_mask:0xf
    v_max_f32_dpp v57, v57, v57 row_shr:2 row_mask:0xf bank_mask:0xf
    v_max_f32_dpp v40, v40, v40 row_shr:4 row_mask:0xf bank_mask:0xf
    v_max_f32_dpp v41, v41, v41 row_shr:4 row_mask:0xf bank_mask:0xf
    v_max_f32_dpp v52, v52, v52 row_shr:4 row_mask:0xf bank_mask:0xf
    v_max_f32_dpp v53, v53, v53 row_shr:4 row_mask:0xf bank_mask:0xf
    v_max_f32_dpp v54, v54, v54 row_shr:4 row_mask:0xf bank_mask:0xf
    v_max_f32_dpp v55, v55, v55 row_shr:4 row_mask:0xf bank_mask:0xf
    v_max_f32_dpp v56, v56, v56 row_shr:4 row_mask:0xf bank_mask:0xf
    v_max_f32_dpp v57, v57, v57 row_shr:4 row_mask:0xf bank_mask:0xf
    v_max_f32_dpp v40, v40, v40 row_shr:8 row_mask:0xf bank_mask:0xf
    v_max_f32_dpp v41, v41, v41 row_shr:8 row_mask:0xf bank_mask:0xf
    v_max_f32_dpp v52, v52, v52 row_shr:8 row_mask:0xf bank_mask:0xf
    v_max_f32_dpp v53, v53, v53 row_shr:8 row_mask:0xf bank_mask:0xf
    v_max_f32_dpp v54, v54, v54 row_shr:8 row_mask:0xf bank_mask:0xf
    v_max_f32_dpp v55, v55, v55 row_shr:8 row_mask:0xf bank_mask:0xf
    v_max_f32_dpp v56, v56, v56 row_shr:8 row_mask:0xf bank_mask:0xf
    v_max_f32_dpp v57, v57, v57 row_shr:8 row_mask:0xf bank_mask:0xf
    v_max_f32_dpp v40, v40, v40 row_bcast:15 row_mask:0xa bank_mask:0xf
    v_max_f32_dpp v41, v41, v41 row_bcast:15 row_mask:0xa bank_mask:0xf
    v_max_f32_dpp v52, v52, v52 row_bcast:15 row_mask:0xa bank_mask:0xf
    v_max_f32_dpp v53, v53, v53 row_bcast:15 row_mask:0xa bank_mask:0xf
    v_max_f32_dpp v54, v54, v54 row_bcast:15 row_mask:0xa bank_mask:0xf
    v_max_f32_dpp v55, v55, v55 row_bcast:15 row_mask:0xa bank_mask:0xf
    v_max_f32_dpp v56, v56, v56 row_bcast:15 row_mask:0xa bank_mask:0xf
    v_max_f32_dpp v57, v57, v57 row_bcast:15 row_mask:0xa bank_mask:0xf
    s_mov_b64 exec, s[60:61]
    buffer_store_dword v40, v25, s[20:23], s45 offen
    buffer_store_dword v41, v25, s[20:23], s48 offen
    s_add_u32 s40, s39, 0
    s_lshl_b32 s37, s40, 10
    s_add_u32 s37, s37, s38
    s_add_u32 s37, s37, 512
    s_mov_b64 exec, s[56:57]
    buffer_store_dword v52, v47, s[20:23], s37 offen

    s_add_u32 s40, s39, 1
    s_lshl_b32 s37, s40, 10
    s_add_u32 s37, s37, s38
    s_add_u32 s37, s37, 512
    s_mov_b64 exec, s[56:57]
    buffer_store_dword v53, v47, s[20:23], s37 offen

    s_add_u32 s40, s39, 2
    s_lshl_b32 s37, s40, 10
    s_add_u32 s37, s37, s38
    s_add_u32 s37, s37, 512
    s_mov_b64 exec, s[54:55]
    buffer_store_dword v54, v47, s[20:23], s37 offen

    s_add_u32 s40, s39, 3
    s_lshl_b32 s37, s40, 10
    s_add_u32 s37, s37, s38
    s_add_u32 s37, s37, 512
    s_mov_b64 exec, s[54:55]
    buffer_store_dword v55, v47, s[20:23], s37 offen

    s_add_u32 s40, s39, 4
    s_lshl_b32 s37, s40, 10
    s_add_u32 s37, s37, s38
    s_add_u32 s37, s37, 512
    s_mov_b64 exec, s[56:57]
    buffer_store_dword v56, v47, s[20:23], s37 offen

    s_add_u32 s40, s39, 5
    s_lshl_b32 s37, s40, 10
    s_add_u32 s37, s37, s38
    s_add_u32 s37, s37, 512
    s_mov_b64 exec, s[56:57]
    buffer_store_dword v57, v47, s[20:23], s37 offen

    s_mov_b64 exec, -1
L_k1_kernel_fin:
L_k1_kernel_end:
    s_endpgm
.text
.globl k2_kernel
.p2align 8
.type k2_kernel,@function
k2_kernel:
    s_cmp_ge_u32 s2, 256
    s_cbranch_scc1 L_k2_kernel_end
    s_load_dwordx2 s[8:9], s[0:1], 112
    s_load_dwordx2 s[4:5], s[0:1], 64
    s_load_dwordx4 s[88:91], s[0:1], 96
    v_lshrrev_b32 v1, 6, v0
    v_and_b32 v2, 63, v0
    s_and_b32 s25, s2, 7
    v_readfirstlane_b32 s24, v1
    s_lshr_b32 s26, s2, 3
    s_lshl_b32 s27, s25, 2
    s_and_b32 s28, s26, 3
    s_add_u32 s27, s27, s28
    s_lshr_b32 s28, s26, 2
    v_and_b32 v3, 31, v2
    v_lshrrev_b32 v4, 5, v2
    v_lshlrev_b32 v5, 4, v2
    v_lshlrev_b32 v6, 2, v2
    s_mul_i32 s30, s27, 155648
    s_add_u32 s30, s30, 2359296
    s_waitcnt lgkmcnt(0)

    s_mov_b32 s20, s8
    s_mov_b32 s21, s9
    s_mov_b32 s22, 67108864
    s_mov_b32 s23, 0x20000
    s_mov_b32 s68, s90
    s_mov_b32 s69, s91
    s_mov_b32 s70, 256
    s_mov_b32 s71, 0x20000
    s_mov_b32 s16, s88
    s_mov_b32 s17, s89
    s_mov_b32 s18, 4718592
    s_mov_b32 s19, 0x20000
    s_cmp_ge_u32 s24, 8
    s_cbranch_scc1 L_conv_200001
    s_and_b32 s31, s24, 3
    s_lshr_b32 s32, s24, 2
    s_lshl_b32 s33, s32, 14
    s_lshl_b32 s34, s31, 10
    s_add_u32 s33, s33, s34
    s_mul_i32 s35, s32, 40960
    s_mul_i32 s36, s31, 2560
    s_add_u32 s35, s35, s36
    s_add_u32 s35, s35, 73728
    s_lshl_b32 s36, s32, 12
    s_lshl_b32 s37, s31, 8
    s_add_u32 s36, s36, s37
    s_add_u32 s36, s36, 65536
    s_mov_b32 s62, -1
    s_mov_b32 s63, 0

    s_add_u32 s38, s33, 0
    s_mov_b32 m0, s38
    s_add_u32 s39, s38, s30
    buffer_load_dwordx4 v5, s[20:23], s39 offen lds
    s_add_u32 s38, s33, 32768
    s_mov_b32 m0, s38
    s_add_u32 s39, s38, s30
    buffer_load_dwordx4 v5, s[20:23], s39 offen lds
    s_add_u32 s38, s36, 0
    s_mov_b32 m0, s38
    s_add_u32 s39, s38, s30
    buffer_load_dword v6, s[20:23], s39 offen lds
    s_add_u32 s38, s35, 0
    s_mov_b32 m0, s38
    s_add_u32 s39, s38, s30
    buffer_load_dwordx4 v5, s[20:23], s39 offen lds
    s_add_u32 s38, s35, 1024
    s_mov_b32 m0, s38
    s_add_u32 s39, s38, s30
    buffer_load_dwordx4 v5, s[20:23], s39 offen lds
    s_add_u32 s38, s35, 2048
    s_mov_b32 m0, s38
    s_add_u32 s39, s38, s30
    s_mov_b64 exec, s[62:63]
    buffer_load_dwordx4 v5, s[20:23], s39 offen lds
    s_mov_b64 exec, -1
    s_lshl_b32 s34, s28, 8
    s_lshl_b32 s37, s31, 6
    s_add_u32 s34, s34, s37
    v_add_u32 v7, s34, v3
    v_lshlrev_b32 v20, 4, v7
    v_lshlrev_b32 v21, 15, v4
    v_add_u32 v20, v20, v21
    s_lshl_b32 s37, s27, 16
    buffer_load_dwordx4 v[8:11], v20, s[20:23], s37 offen
    buffer_load_dwordx4 v[12:15], v20, s[20:23], s37 offen offset:512
    v_lshlrev_b32 v21, 2, v7
    s_lshl_b32 s37, s27, 13
    s_add_u32 s37, s37, 2097152
    buffer_load_dword v16, v21, s[20:23], s37 offen
    buffer_load_dword v18, v21, s[20:23], s37 offen offset:128
    s_lshl_b32 s37, s27, 10
    s_add_u32 s37, s37, 7340032

    buffer_load_dword v32, v6, s[20:23], s37 offen offset:0
    buffer_load_dword v33, v6, s[20:23], s37 offen offset:256
    buffer_load_dword v34, v6, s[20:23], s37 offen offset:512
    s_add_u32 s37, s37, 32768
    buffer_load_dword v35, v6, s[20:23], s37 offen offset:0
    buffer_load_dword v36, v6, s[20:23], s37 offen offset:256
    buffer_load_dword v37, v6, s[20:23], s37 offen offset:512
    s_add_u32 s37, s37, 32768
    buffer_load_dword v38, v6, s[20:23], s37 offen offset:0
    buffer_load_dword v39, v6, s[20:23], s37 offen offset:256
    buffer_load_dword v40, v6, s[20:23], s37 offen offset:512
    v_and_b32 v7, 0x13, v3
    v_and_b32 v20, 4, v3
    v_lshlrev_b32 v20, 1, v20
    v_or_b32 v7, v7, v20
    v_and_b32 v20, 8, v3
    v_lshrrev_b32 v20, 1, v20
    v_or_b32 v7, v7, v20
    s_lshl_b32 s37, s32, 10
    v_add_u32 v7, s37, v7
    v_lshlrev_b32 v132, 4, v7
    v_lshlrev_b32 v20, 15, v4
    v_add_u32 v132, v132, v20
    v_lshlrev_b32 v133, 2, v7
    v_add_u32 v133, 65536, v133
    v_lshrrev_b32 v20, 2, v2
    v_and_b32 v20, 3, v20
    v_lshlrev_b32 v21, 3, v4
    v_add_u32 v20, v20, v21
    v_add_u32 v20, s37, v20
    v_mul_u32_u24 v20, 40, v20
    v_and_b32 v21, 1, v2
    v_lshlrev_b32 v21, 4, v21
    v_bfe_u32 v7, v2, 1, 1
    v_lshlrev_b32 v7, 3, v7
    v_add_u32 v21, v21, v7
    v_bfe_u32 v7, v2, 4, 1
    v_cmp_eq_u32 vcc, 1, v7
    v_mov_b32 v7, 32
    v_mov_b32 v113, 0
    v_cndmask_b32 v21, v21, v7, vcc
    v_add_u32 v20, v20, v21
    v_add_u32 v134, 73728, v20
    v_mov_b32 v115, 0
    v_mov_b32 v17, 0
    v_mov_b32 v19, 0

    v_mov_b32 v72, 0
    v_mov_b32 v73, 0
    v_mov_b32 v74, 0
    v_mov_b32 v75, 0
    v_mov_b32 v76, 0
    v_mov_b32 v77, 0
    v_mov_b32 v78, 0
    v_mov_b32 v79, 0
    v_mov_b32 v80, 0
    v_mov_b32 v81, 0
    v_mov_b32 v82, 0
    v_mov_b32 v83, 0
    v_mov_b32 v84, 0
    v_mov_b32 v85, 0
    v_mov_b32 v86, 0
    v_mov_b32 v87, 0
    v_mov_b32 v88, 0
    v_mov_b32 v89, 0
    v_mov_b32 v90, 0
    v_mov_b32 v91, 0
    v_mov_b32 v92, 0
    v_mov_b32 v93, 0
    v_mov_b32 v94, 0
    v_mov_b32 v95, 0
    v_mov_b32 v96, 0
    v_mov_b32 v97, 0
    v_mov_b32 v98, 0
    v_mov_b32 v99, 0
    v_mov_b32 v100, 0
    v_mov_b32 v101, 0
    v_mov_b32 v102, 0
    v_mov_b32 v103, 0
    s_waitcnt vmcnt(0) lgkmcnt(0)
    s_barrier
    v_cmp_eq_u32 vcc, 0, v4
    s_nop 1
    v_cndmask_b32 v16, 0, v16, vcc
    v_cndmask_b32 v18, 0, v18, vcc

    ds_read_b128 v[104:107], v132 offset:0
    ds_read_b32 v112, v133 offset:0
    ds_read_b64_tr_b16 v[116:117], v134 offset:0
    ds_read_b64_tr_b16 v[118:119], v134 offset:160
    ds_read_b64_tr_b16 v[120:121], v134 offset:640
    ds_read_b64_tr_b16 v[122:123], v134 offset:800
    v_max_f32_dpp v32, v32, v32 row_shr:1 row_mask:0xf bank_mask:0xf
    v_max_f32_dpp v33, v33, v33 row_shr:1 row_mask:0xf bank_mask:0xf
    v_max_f32_dpp v34, v34, v34 row_shr:1 row_mask:0xf bank_mask:0xf
    v_max_f32_dpp v35, v35, v35 row_shr:1 row_mask:0xf bank_mask:0xf
    v_max_f32_dpp v36, v36, v36 row_shr:1 row_mask:0xf bank_mask:0xf
    v_max_f32_dpp v37, v37, v37 row_shr:1 row_mask:0xf bank_mask:0xf
    v_max_f32_dpp v38, v38, v38 row_shr:1 row_mask:0xf bank_mask:0xf
    v_max_f32_dpp v39, v39, v39 row_shr:1 row_mask:0xf bank_mask:0xf
    v_max_f32_dpp v40, v40, v40 row_shr:1 row_mask:0xf bank_mask:0xf
    v_max_f32_dpp v32, v32, v32 row_shr:2 row_mask:0xf bank_mask:0xf
    v_max_f32_dpp v33, v33, v33 row_shr:2 row_mask:0xf bank_mask:0xf
    v_max_f32_dpp v34, v34, v34 row_shr:2 row_mask:0xf bank_mask:0xf
    v_max_f32_dpp v35, v35, v35 row_shr:2 row_mask:0xf bank_mask:0xf
    v_max_f32_dpp v36, v36, v36 row_shr:2 row_mask:0xf bank_mask:0xf
    v_max_f32_dpp v37, v37, v37 row_shr:2 row_mask:0xf bank_mask:0xf
    v_max_f32_dpp v38, v38, v38 row_shr:2 row_mask:0xf bank_mask:0xf
    v_max_f32_dpp v39, v39, v39 row_shr:2 row_mask:0xf bank_mask:0xf
    v_max_f32_dpp v40, v40, v40 row_shr:2 row_mask:0xf bank_mask:0xf
    v_max_f32_dpp v32, v32, v32 row_shr:4 row_mask:0xf bank_mask:0xf
    v_max_f32_dpp v33, v33, v33 row_shr:4 row_mask:0xf bank_mask:0xf
    v_max_f32_dpp v34, v34, v34 row_shr:4 row_mask:0xf bank_mask:0xf
    v_max_f32_dpp v35, v35, v35 row_shr:4 row_mask:0xf bank_mask:0xf
    v_max_f32_dpp v36, v36, v36 row_shr:4 row_mask:0xf bank_mask:0xf
    v_max_f32_dpp v37, v37, v37 row_shr:4 row_mask:0xf bank_mask:0xf
    v_max_f32_dpp v38, v38, v38 row_shr:4 row_mask:0xf bank_mask:0xf
    v_max_f32_dpp v39, v39, v39 row_shr:4 row_mask:0xf bank_mask:0xf
    v_max_f32_dpp v40, v40, v40 row_shr:4 row_mask:0xf bank_mask:0xf
    v_max_f32_dpp v32, v32, v32 row_shr:8 row_mask:0xf bank_mask:0xf
    v_max_f32_dpp v33, v33, v33 row_shr:8 row_mask:0xf bank_mask:0xf
    v_max_f32_dpp v34, v34, v34 row_shr:8 row_mask:0xf bank_mask:0xf
    v_max_f32_dpp v35, v35, v35 row_shr:8 row_mask:0xf bank_mask:0xf
    v_max_f32_dpp v36, v36, v36 row_shr:8 row_mask:0xf bank_mask:0xf
    v_max_f32_dpp v37, v37, v37 row_shr:8 row_mask:0xf bank_mask:0xf
    v_max_f32_dpp v38, v38, v38 row_shr:8 row_mask:0xf bank_mask:0xf
    v_max_f32_dpp v39, v39, v39 row_shr:8 row_mask:0xf bank_mask:0xf
    v_max_f32_dpp v40, v40, v40 row_shr:8 row_mask:0xf bank_mask:0xf
    v_max_f32_dpp v32, v32, v32 row_bcast:15 row_mask:0xa bank_mask:0xf
    v_max_f32_dpp v33, v33, v33 row_bcast:15 row_mask:0xa bank_mask:0xf
    v_max_f32_dpp v34, v34, v34 row_bcast:15 row_mask:0xa bank_mask:0xf
    v_max_f32_dpp v35, v35, v35 row_bcast:15 row_mask:0xa bank_mask:0xf
    v_max_f32_dpp v36, v36, v36 row_bcast:15 row_mask:0xa bank_mask:0xf
    v_max_f32_dpp v37, v37, v37 row_bcast:15 row_mask:0xa bank_mask:0xf
    v_max_f32_dpp v38, v38, v38 row_bcast:15 row_mask:0xa bank_mask:0xf
    v_max_f32_dpp v39, v39, v39 row_bcast:15 row_mask:0xa bank_mask:0xf
    v_max_f32_dpp v40, v40, v40 row_bcast:15 row_mask:0xa bank_mask:0xf
    s_nop 1
    v_readlane_b32 s40, v32, 31
    v_readlane_b32 s50, v32, 63
    v_readlane_b32 s41, v33, 31
    v_readlane_b32 s51, v33, 63
    v_readlane_b32 s42, v34, 31
    v_readlane_b32 s52, v34, 63
    v_readlane_b32 s43, v35, 31
    v_readlane_b32 s53, v35, 63
    v_readlane_b32 s44, v36, 31
    v_readlane_b32 s54, v36, 63
    v_readlane_b32 s45, v37, 31
    v_readlane_b32 s55, v37, 63
    v_readlane_b32 s46, v38, 31
    v_readlane_b32 s56, v38, 63
    v_readlane_b32 s47, v39, 31
    v_readlane_b32 s57, v39, 63
    v_readlane_b32 s48, v40, 31
    v_readlane_b32 s58, v40, 63
    s_nop 1
    v_mov_b32 v32, s40
    v_max_f32 v32, s50, v32
    v_mov_b32 v33, s41
    v_max_f32 v33, s51, v33
    v_mov_b32 v34, s42
    v_max_f32 v34, s52, v34
    v_mov_b32 v35, s43
    v_max_f32 v35, s53, v35
    v_mov_b32 v36, s44
    v_max_f32 v36, s54, v36
    v_mov_b32 v37, s45
    v_max_f32 v37, s55, v37
    v_mov_b32 v38, s46
    v_max_f32 v38, s56, v38
    v_mov_b32 v39, s47
    v_max_f32 v39, s57, v39
    v_mov_b32 v40, s48
    v_max_f32 v40, s58, v40
    v_add_f32 v32, v32, v33
    v_add_f32 v32, v32, v34
    v_add_f32 v35, v35, v36
    v_add_f32 v35, v35, v37
    v_add_f32 v38, v38, v39
    v_add_f32 v38, v38, v40
    v_mul_f32 v32, v32, v35
    v_mov_b32 v33, 0x44c80000
    v_mov_b32 v34, 0x7b000000
    v_cmp_le_f32 vcc, v32, v33
    v_cmp_le_f32 s[64:65], v38, v34
    v_mov_b32 v22, 0
    v_mov_b32 v23, 0
    s_nop 2
    s_and_b64 s[64:65], s[64:65], vcc

    s_cmp_eq_u64 s[64:65], 0
    s_cbranch_scc1 L_slow_200002
    s_waitcnt lgkmcnt(0)
    v_mfma_f32_32x32x16_bf16 v[32:47], v[104:107], v[8:11], 0
    v_mfma_f32_32x32x8_bf16 v[32:47], v[112:113], v[16:17], v[32:47]
    s_nop 7
    s_nop 3
    s_setprio 2
    s_waitcnt lgkmcnt(0)
    v_mfma_f32_32x32x16_bf16 v[48:63], v[104:107], v[12:15], 0
    ds_read_b128 v[108:111], v132 offset:512
    ds_read_b32 v114, v133 offset:128
    v_exp_f32 v32, v32
    v_exp_f32 v33, v33
    v_exp_f32 v34, v34
    v_exp_f32 v35, v35
    v_cvt_pk_bf16_f32 v64, v32, v33
    v_exp_f32 v36, v36
    v_exp_f32 v37, v37
    v_cvt_pk_bf16_f32 v65, v34, v35
    v_exp_f32 v38, v38
    v_exp_f32 v39, v39
    v_cvt_pk_bf16_f32 v66, v36, v37
    v_mfma_f32_32x32x8_bf16 v[48:63], v[112:113], v[18:19], v[48:63]
    v_exp_f32 v40, v40
    v_exp_f32 v41, v41
    v_cvt_pk_bf16_f32 v67, v38, v39
    v_exp_f32 v42, v42
    v_exp_f32 v43, v43
    v_mfma_f32_32x32x16_bf16 v[72:87], v[116:119], v[64:67], v[72:87]
    v_cvt_pk_bf16_f32 v68, v40, v41
    v_exp_f32 v44, v44
    v_exp_f32 v45, v45
    v_cvt_pk_bf16_f32 v69, v42, v43
    v_exp_f32 v46, v46
    v_exp_f32 v47, v47
    v_cvt_pk_bf16_f32 v70, v44, v45
    v_cvt_pk_bf16_f32 v71, v46, v47
    s_waitcnt lgkmcnt(0)
    v_mfma_f32_32x32x16_bf16 v[32:47], v[108:111], v[8:11], 0
    ds_read_b64_tr_b16 v[124:125], v134 offset:1280
    ds_read_b64_tr_b16 v[126:127], v134 offset:1440
    ds_read_b64_tr_b16 v[128:129], v134 offset:1920
    ds_read_b64_tr_b16 v[130:131], v134 offset:2080
    v_exp_f32 v48, v48
    v_exp_f32 v49, v49
    v_exp_f32 v50, v50
    v_exp_f32 v51, v51
    v_cvt_pk_bf16_f32 v64, v48, v49
    v_mfma_f32_32x32x16_bf16 v[72:87], v[120:123], v[68:71], v[72:87]
    v_exp_f32 v52, v52
    v_exp_f32 v53, v53
    v_cvt_pk_bf16_f32 v65, v50, v51
    v_exp_f32 v54, v54
    v_exp_f32 v55, v55
    v_cvt_pk_bf16_f32 v66, v52, v53
    v_mfma_f32_32x32x8_bf16 v[32:47], v[114:115], v[16:17], v[32:47]
    v_exp_f32 v56, v56
    v_exp_f32 v57, v57
    v_cvt_pk_bf16_f32 v67, v54, v55
    v_exp_f32 v58, v58
    v_exp_f32 v59, v59
    v_mfma_f32_32x32x16_bf16 v[88:103], v[116:119], v[64:67], v[88:103]
    v_cvt_pk_bf16_f32 v68, v56, v57
    v_exp_f32 v60, v60
    v_exp_f32 v61, v61
    v_cvt_pk_bf16_f32 v69, v58, v59
    v_exp_f32 v62, v62
    v_exp_f32 v63, v63
    v_cvt_pk_bf16_f32 v70, v60, v61
    v_cvt_pk_bf16_f32 v71, v62, v63
    s_waitcnt lgkmcnt(0)
    v_mfma_f32_32x32x16_bf16 v[48:63], v[108:111], v[12:15], 0
    ds_read_b128 v[104:107], v132 offset:1024
    ds_read_b32 v112, v133 offset:256
    v_exp_f32 v32, v32
    v_exp_f32 v33, v33
    v_exp_f32 v34, v34
    v_exp_f32 v35, v35
    v_cvt_pk_bf16_f32 v64, v32, v33
    v_mfma_f32_32x32x16_bf16 v[88:103], v[120:123], v[68:71], v[88:103]
    v_exp_f32 v36, v36
    v_exp_f32 v37, v37
    v_cvt_pk_bf16_f32 v65, v34, v35
    v_exp_f32 v38, v38
    v_exp_f32 v39, v39
    v_cvt_pk_bf16_f32 v66, v36, v37
    v_mfma_f32_32x32x8_bf16 v[48:63], v[114:115], v[18:19], v[48:63]
    v_exp_f32 v40, v40
    v_exp_f32 v41, v41
    v_cvt_pk_bf16_f32 v67, v38, v39
    v_exp_f32 v42, v42
    v_exp_f32 v43, v43
    v_mfma_f32_32x32x16_bf16 v[72:87], v[124:127], v[64:67], v[72:87]
    v_cvt_pk_bf16_f32 v68, v40, v41
    v_exp_f32 v44, v44
    v_exp_f32 v45, v45
    v_cvt_pk_bf16_f32 v69, v42, v43
    v_exp_f32 v46, v46
    v_exp_f32 v47, v47
    v_cvt_pk_bf16_f32 v70, v44, v45
    v_cvt_pk_bf16_f32 v71, v46, v47
    s_waitcnt lgkmcnt(0)
    v_mfma_f32_32x32x16_bf16 v[32:47], v[104:107], v[8:11], 0
    ds_read_b64_tr_b16 v[116:117], v134 offset:2560
    ds_read_b64_tr_b16 v[118:119], v134 offset:2720
    ds_read_b64_tr_b16 v[120:121], v134 offset:3200
    ds_read_b64_tr_b16 v[122:123], v134 offset:3360
    v_exp_f32 v48, v48
    v_exp_f32 v49, v49
    v_exp_f32 v50, v50
    v_exp_f32 v51, v51
    v_cvt_pk_bf16_f32 v64, v48, v49
    v_mfma_f32_32x32x16_bf16 v[72:87], v[128:131], v[68:71], v[72:87]
    v_exp_f32 v52, v52
    v_exp_f32 v53, v53
    v_cvt_pk_bf16_f32 v65, v50, v51
    v_exp_f32 v54, v54
    v_exp_f32 v55, v55
    v_cvt_pk_bf16_f32 v66, v52, v53
    v_mfma_f32_32x32x8_bf16 v[32:47], v[112:113], v[16:17], v[32:47]
    v_exp_f32 v56, v56
    v_exp_f32 v57, v57
    v_cvt_pk_bf16_f32 v67, v54, v55
    v_exp_f32 v58, v58
    v_exp_f32 v59, v59
    v_mfma_f32_32x32x16_bf16 v[88:103], v[124:127], v[64:67], v[88:103]
    v_cvt_pk_bf16_f32 v68, v56, v57
    v_exp_f32 v60, v60
    v_exp_f32 v61, v61
    v_cvt_pk_bf16_f32 v69, v58, v59
    v_exp_f32 v62, v62
    v_exp_f32 v63, v63
    v_cvt_pk_bf16_f32 v70, v60, v61
    v_cvt_pk_bf16_f32 v71, v62, v63
    s_waitcnt lgkmcnt(0)
    v_mfma_f32_32x32x16_bf16 v[48:63], v[104:107], v[12:15], 0
    ds_read_b128 v[108:111], v132 offset:1536
    ds_read_b32 v114, v133 offset:384
    v_exp_f32 v32, v32
    v_exp_f32 v33, v33
    v_exp_f32 v34, v34
    v_exp_f32 v35, v35
    v_cvt_pk_bf16_f32 v64, v32, v33
    v_mfma_f32_32x32x16_bf16 v[88:103], v[128:131], v[68:71], v[88:103]
    v_exp_f32 v36, v36
    v_exp_f32 v37, v37
    v_cvt_pk_bf16_f32 v65, v34, v35
    v_exp_f32 v38, v38
    v_exp_f32 v39, v39
    v_cvt_pk_bf16_f32 v66, v36, v37
    v_mfma_f32_32x32x8_bf16 v[48:63], v[112:113], v[18:19], v[48:63]
    v_exp_f32 v40, v40
    v_exp_f32 v41, v41
    v_cvt_pk_bf16_f32 v67, v38, v39
    v_exp_f32 v42, v42
    v_exp_f32 v43, v43
    v_mfma_f32_32x32x16_bf16 v[72:87], v[116:119], v[64:67], v[72:87]
    v_cvt_pk_bf16_f32 v68, v40, v41
    v_exp_f32 v44, v44
    v_exp_f32 v45, v45
    v_cvt_pk_bf16_f32 v69, v42, v43
    v_exp_f32 v46, v46
    v_exp_f32 v47, v47
    v_cvt_pk_bf16_f32 v70, v44, v45
    v_cvt_pk_bf16_f32 v71, v46, v47
    s_waitcnt lgkmcnt(0)
    v_mfma_f32_32x32x16_bf16 v[32:47], v[108:111], v[8:11], 0
    ds_read_b64_tr_b16 v[124:125], v134 offset:3840
    ds_read_b64_tr_b16 v[126:127], v134 offset:4000
    ds_read_b64_tr_b16 v[128:129], v134 offset:4480
    ds_read_b64_tr_b16 v[130:131], v134 offset:4640
    v_exp_f32 v48, v48
    v_exp_f32 v49, v49
    v_exp_f32 v50, v50
    v_exp_f32 v51, v51
    v_cvt_pk_bf16_f32 v64, v48, v49
    v_mfma_f32_32x32x16_bf16 v[72:87], v[120:123], v[68:71], v[72:87]
    v_exp_f32 v52, v52
    v_exp_f32 v53, v53
    v_cvt_pk_bf16_f32 v65, v50, v51
    v_exp_f32 v54, v54
    v_exp_f32 v55, v55
    v_cvt_pk_bf16_f32 v66, v52, v53
    v_mfma_f32_32x32x8_bf16 v[32:47], v[114:115], v[16:17], v[32:47]
    v_exp_f32 v56, v56
    v_exp_f32 v57, v57
    v_cvt_pk_bf16_f32 v67, v54, v55
    v_exp_f32 v58, v58
    v_exp_f32 v59, v59
    v_mfma_f32_32x32x16_bf16 v[88:103], v[116:119], v[64:67], v[88:103]
    v_cvt_pk_bf16_f32 v68, v56, v57
    v_exp_f32 v60, v60
    v_exp_f32 v61, v61
    v_cvt_pk_bf16_f32 v69, v58, v59
    v_exp_f32 v62, v62
    v_exp_f32 v63, v63
    v_cvt_pk_bf16_f32 v70, v60, v61
    v_cvt_pk_bf16_f32 v71, v62, v63
    s_waitcnt lgkmcnt(0)
    v_mfma_f32_32x32x16_bf16 v[48:63], v[108:111], v[12:15], 0
    ds_read_b128 v[104:107], v132 offset:2048
    ds_read_b32 v112, v133 offset:512
    v_exp_f32 v32, v32
    v_exp_f32 v33, v33
    v_exp_f32 v34, v34
    v_exp_f32 v35, v35
    v_cvt_pk_bf16_f32 v64, v32, v33
    v_mfma_f32_32x32x16_bf16 v[88:103], v[120:123], v[68:71], v[88:103]
    v_exp_f32 v36, v36
    v_exp_f32 v37, v37
    v_cvt_pk_bf16_f32 v65, v34, v35
    v_exp_f32 v38, v38
    v_exp_f32 v39, v39
    v_cvt_pk_bf16_f32 v66, v36, v37
    v_mfma_f32_32x32x8_bf16 v[48:63], v[114:115], v[18:19], v[48:63]
    v_exp_f32 v40, v40
    v_exp_f32 v41, v41
    v_cvt_pk_bf16_f32 v67, v38, v39
    v_exp_f32 v42, v42
    v_exp_f32 v43, v43
    v_mfma_f32_32x32x16_bf16 v[72:87], v[124:127], v[64:67], v[72:87]
    v_cvt_pk_bf16_f32 v68, v40, v41
    v_exp_f32 v44, v44
    v_exp_f32 v45, v45
    v_cvt_pk_bf16_f32 v69, v42, v43
    v_exp_f32 v46, v46
    v_exp_f32 v47, v47
    v_cvt_pk_bf16_f32 v70, v44, v45
    v_cvt_pk_bf16_f32 v71, v46, v47
    s_waitcnt lgkmcnt(0)
    v_mfma_f32_32x32x16_bf16 v[32:47], v[104:107], v[8:11], 0
    ds_read_b64_tr_b16 v[116:117], v134 offset:5120
    ds_read_b64_tr_b16 v[118:119], v134 offset:5280
    ds_read_b64_tr_b16 v[120:121], v134 offset:5760
    ds_read_b64_tr_b16 v[122:123], v134 offset:5920
    v_exp_f32 v48, v48
    v_exp_f32 v49, v49
    v_exp_f32 v50, v50
    v_exp_f32 v51, v51
    v_cvt_pk_bf16_f32 v64, v48, v49
    v_mfma_f32_32x32x16_bf16 v[72:87], v[128:131], v[68:71], v[72:87]
    v_exp_f32 v52, v52
    v_exp_f32 v53, v53
    v_cvt_pk_bf16_f32 v65, v50, v51
    v_exp_f32 v54, v54
    v_exp_f32 v55, v55
    v_cvt_pk_bf16_f32 v66, v52, v53
    v_mfma_f32_32x32x8_bf16 v[32:47], v[112:113], v[16:17], v[32:47]
    v_exp_f32 v56, v56
    v_exp_f32 v57, v57
    v_cvt_pk_bf16_f32 v67, v54, v55
    v_exp_f32 v58, v58
    v_exp_f32 v59, v59
    v_mfma_f32_32x32x16_bf16 v[88:103], v[124:127], v[64:67], v[88:103]
    v_cvt_pk_bf16_f32 v68, v56, v57
    v_exp_f32 v60, v60
    v_exp_f32 v61, v61
    v_cvt_pk_bf16_f32 v69, v58, v59
    v_exp_f32 v62, v62
    v_exp_f32 v63, v63
    v_cvt_pk_bf16_f32 v70, v60, v61
    v_cvt_pk_bf16_f32 v71, v62, v63
    s_waitcnt lgkmcnt(0)
    v_mfma_f32_32x32x16_bf16 v[48:63], v[104:107], v[12:15], 0
    ds_read_b128 v[108:111], v132 offset:2560
    ds_read_b32 v114, v133 offset:640
    v_exp_f32 v32, v32
    v_exp_f32 v33, v33
    v_exp_f32 v34, v34
    v_exp_f32 v35, v35
    v_cvt_pk_bf16_f32 v64, v32, v33
    v_mfma_f32_32x32x16_bf16 v[88:103], v[128:131], v[68:71], v[88:103]
    v_exp_f32 v36, v36
    v_exp_f32 v37, v37
    v_cvt_pk_bf16_f32 v65, v34, v35
    v_exp_f32 v38, v38
    v_exp_f32 v39, v39
    v_cvt_pk_bf16_f32 v66, v36, v37
    v_mfma_f32_32x32x8_bf16 v[48:63], v[112:113], v[18:19], v[48:63]
    v_exp_f32 v40, v40
    v_exp_f32 v41, v41
    v_cvt_pk_bf16_f32 v67, v38, v39
    v_exp_f32 v42, v42
    v_exp_f32 v43, v43
    v_mfma_f32_32x32x16_bf16 v[72:87], v[116:119], v[64:67], v[72:87]
    v_cvt_pk_bf16_f32 v68, v40, v41
    v_exp_f32 v44, v44
    v_exp_f32 v45, v45
    v_cvt_pk_bf16_f32 v69, v42, v43
    v_exp_f32 v46, v46
    v_exp_f32 v47, v47
    v_cvt_pk_bf16_f32 v70, v44, v45
    v_cvt_pk_bf16_f32 v71, v46, v47
    s_waitcnt lgkmcnt(0)
    v_mfma_f32_32x32x16_bf16 v[32:47], v[108:111], v[8:11], 0
    ds_read_b64_tr_b16 v[124:125], v134 offset:6400
    ds_read_b64_tr_b16 v[126:127], v134 offset:6560
    ds_read_b64_tr_b16 v[128:129], v134 offset:7040
    ds_read_b64_tr_b16 v[130:131], v134 offset:7200
    v_exp_f32 v48, v48
    v_exp_f32 v49, v49
    v_exp_f32 v50, v50
    v_exp_f32 v51, v51
    v_cvt_pk_bf16_f32 v64, v48, v49
    v_mfma_f32_32x32x16_bf16 v[72:87], v[120:123], v[68:71], v[72:87]
    v_exp_f32 v52, v52
    v_exp_f32 v53, v53
    v_cvt_pk_bf16_f32 v65, v50, v51
    v_exp_f32 v54, v54
    v_exp_f32 v55, v55
    v_cvt_pk_bf16_f32 v66, v52, v53
    v_mfma_f32_32x32x8_bf16 v[32:47], v[114:115], v[16:17], v[32:47]
    v_exp_f32 v56, v56
    v_exp_f32 v57, v57
    v_cvt_pk_bf16_f32 v67, v54, v55
    v_exp_f32 v58, v58
    v_exp_f32 v59, v59
    v_mfma_f32_32x32x16_bf16 v[88:103], v[116:119], v[64:67], v[88:103]
    v_cvt_pk_bf16_f32 v68, v56, v57
    v_exp_f32 v60, v60
    v_exp_f32 v61, v61
    v_cvt_pk_bf16_f32 v69, v58, v59
    v_exp_f32 v62, v62
    v_exp_f32 v63, v63
    v_cvt_pk_bf16_f32 v70, v60, v61
    v_cvt_pk_bf16_f32 v71, v62, v63
    s_waitcnt lgkmcnt(0)
    v_mfma_f32_32x32x16_bf16 v[48:63], v[108:111], v[12:15], 0
    ds_read_b128 v[104:107], v132 offset:3072
    ds_read_b32 v112, v133 offset:768
    v_exp_f32 v32, v32
    v_exp_f32 v33, v33
    v_exp_f32 v34, v34
    v_exp_f32 v35, v35
    v_cvt_pk_bf16_f32 v64, v32, v33
    v_mfma_f32_32x32x16_bf16 v[88:103], v[120:123], v[68:71], v[88:103]
    v_exp_f32 v36, v36
    v_exp_f32 v37, v37
    v_cvt_pk_bf16_f32 v65, v34, v35
    v_exp_f32 v38, v38
    v_exp_f32 v39, v39
    v_cvt_pk_bf16_f32 v66, v36, v37
    v_mfma_f32_32x32x8_bf16 v[48:63], v[114:115], v[18:19], v[48:63]
    v_exp_f32 v40, v40
    v_exp_f32 v41, v41
    v_cvt_pk_bf16_f32 v67, v38, v39
    v_exp_f32 v42, v42
    v_exp_f32 v43, v43
    v_mfma_f32_32x32x16_bf16 v[72:87], v[124:127], v[64:67], v[72:87]
    v_cvt_pk_bf16_f32 v68, v40, v41
    v_exp_f32 v44, v44
    v_exp_f32 v45, v45
    v_cvt_pk_bf16_f32 v69, v42, v43
    v_exp_f32 v46, v46
    v_exp_f32 v47, v47
    v_cvt_pk_bf16_f32 v70, v44, v45
    v_cvt_pk_bf16_f32 v71, v46, v47
    s_waitcnt lgkmcnt(0)
    v_mfma_f32_32x32x16_bf16 v[32:47], v[104:107], v[8:11], 0
    ds_read_b64_tr_b16 v[116:117], v134 offset:7680
    ds_read_b64_tr_b16 v[118:119], v134 offset:7840
    ds_read_b64_tr_b16 v[120:121], v134 offset:8320
    ds_read_b64_tr_b16 v[122:123], v134 offset:8480
    v_exp_f32 v48, v48
    v_exp_f32 v49, v49
    v_exp_f32 v50, v50
    v_exp_f32 v51, v51
    v_cvt_pk_bf16_f32 v64, v48, v49
    v_mfma_f32_32x32x16_bf16 v[72:87], v[128:131], v[68:71], v[72:87]
    v_exp_f32 v52, v52
    v_exp_f32 v53, v53
    v_cvt_pk_bf16_f32 v65, v50, v51
    v_exp_f32 v54, v54
    v_exp_f32 v55, v55
    v_cvt_pk_bf16_f32 v66, v52, v53
    v_mfma_f32_32x32x8_bf16 v[32:47], v[112:113], v[16:17], v[32:47]
    v_exp_f32 v56, v56
    v_exp_f32 v57, v57
    v_cvt_pk_bf16_f32 v67, v54, v55
    v_exp_f32 v58, v58
    v_exp_f32 v59, v59
    v_mfma_f32_32x32x16_bf16 v[88:103], v[124:127], v[64:67], v[88:103]
    v_cvt_pk_bf16_f32 v68, v56, v57
    v_exp_f32 v60, v60
    v_exp_f32 v61, v61
    v_cvt_pk_bf16_f32 v69, v58, v59
    v_exp_f32 v62, v62
    v_exp_f32 v63, v63
    v_cvt_pk_bf16_f32 v70, v60, v61
    v_cvt_pk_bf16_f32 v71, v62, v63
    v_mov_b32 v20, 73764
L_poll_200004:
    ds_read_b32 v21, v20
    s_waitcnt lgkmcnt(0)
    v_readfirstlane_b32 s66, v21
    s_nop 3
    s_bfe_u32 s66, s66, 0x40010
    s_cmp_lt_u32 s66, 4
    s_cbranch_scc1 L_poll_200004
    s_waitcnt lgkmcnt(0)
    v_mfma_f32_32x32x16_bf16 v[48:63], v[104:107], v[12:15], 0
    ds_read_b128 v[108:111], v132 offset:3584
    ds_read_b32 v114, v133 offset:896
    v_exp_f32 v32, v32
    v_exp_f32 v33, v33
    v_exp_f32 v34, v34
    v_exp_f32 v35, v35
    v_cvt_pk_bf16_f32 v64, v32, v33
    v_mfma_f32_32x32x16_bf16 v[88:103], v[128:131], v[68:71], v[88:103]
    v_exp_f32 v36, v36
    v_exp_f32 v37, v37
    v_cvt_pk_bf16_f32 v65, v34, v35
    v_exp_f32 v38, v38
    v_exp_f32 v39, v39
    v_cvt_pk_bf16_f32 v66, v36, v37
    v_mfma_f32_32x32x8_bf16 v[48:63], v[112:113], v[18:19], v[48:63]
    v_exp_f32 v40, v40
    v_exp_f32 v41, v41
    v_cvt_pk_bf16_f32 v67, v38, v39
    v_exp_f32 v42, v42
    v_exp_f32 v43, v43
    v_mfma_f32_32x32x16_bf16 v[72:87], v[116:119], v[64:67], v[72:87]
    v_cvt_pk_bf16_f32 v68, v40, v41
    v_exp_f32 v44, v44
    v_exp_f32 v45, v45
    v_cvt_pk_bf16_f32 v69, v42, v43
    v_exp_f32 v46, v46
    v_exp_f32 v47, v47
    v_cvt_pk_bf16_f32 v70, v44, v45
    v_cvt_pk_bf16_f32 v71, v46, v47
    s_waitcnt lgkmcnt(0)
    v_mfma_f32_32x32x16_bf16 v[32:47], v[108:111], v[8:11], 0
    ds_read_b64_tr_b16 v[124:125], v134 offset:8960
    ds_read_b64_tr_b16 v[126:127], v134 offset:9120
    ds_read_b64_tr_b16 v[128:129], v134 offset:9600
    ds_read_b64_tr_b16 v[130:131], v134 offset:9760
    v_exp_f32 v48, v48
    v_exp_f32 v49, v49
    v_exp_f32 v50, v50
    v_exp_f32 v51, v51
    v_cvt_pk_bf16_f32 v64, v48, v49
    v_mfma_f32_32x32x16_bf16 v[72:87], v[120:123], v[68:71], v[72:87]
    v_exp_f32 v52, v52
    v_exp_f32 v53, v53
    v_cvt_pk_bf16_f32 v65, v50, v51
    v_exp_f32 v54, v54
    v_exp_f32 v55, v55
    v_cvt_pk_bf16_f32 v66, v52, v53
    v_mfma_f32_32x32x8_bf16 v[32:47], v[114:115], v[16:17], v[32:47]
    v_exp_f32 v56, v56
    v_exp_f32 v57, v57
    v_cvt_pk_bf16_f32 v67, v54, v55
    v_exp_f32 v58, v58
    v_exp_f32 v59, v59
    v_mfma_f32_32x32x16_bf16 v[88:103], v[116:119], v[64:67], v[88:103]
    v_cvt_pk_bf16_f32 v68, v56, v57
    v_exp_f32 v60, v60
    v_exp_f32 v61, v61
    v_cvt_pk_bf16_f32 v69, v58, v59
    v_exp_f32 v62, v62
    v_exp_f32 v63, v63
    v_cvt_pk_bf16_f32 v70, v60, v61
    v_cvt_pk_bf16_f32 v71, v62, v63
    s_waitcnt lgkmcnt(0)
    v_mfma_f32_32x32x16_bf16 v[48:63], v[108:111], v[12:15], 0
    ds_read_b128 v[104:107], v132 offset:4096
    ds_read_b32 v112, v133 offset:1024
    v_exp_f32 v32, v32
    v_exp_f32 v33, v33
    v_exp_f32 v34, v34
    v_exp_f32 v35, v35
    v_cvt_pk_bf16_f32 v64, v32, v33
    v_mfma_f32_32x32x16_bf16 v[88:103], v[120:123], v[68:71], v[88:103]
    v_exp_f32 v36, v36
    v_exp_f32 v37, v37
    v_cvt_pk_bf16_f32 v65, v34, v35
    v_exp_f32 v38, v38
    v_exp_f32 v39, v39
    v_cvt_pk_bf16_f32 v66, v36, v37
    v_mfma_f32_32x32x8_bf16 v[48:63], v[114:115], v[18:19], v[48:63]
    v_exp_f32 v40, v40
    v_exp_f32 v41, v41
    v_cvt_pk_bf16_f32 v67, v38, v39
    v_exp_f32 v42, v42
    v_exp_f32 v43, v43
    v_mfma_f32_32x32x16_bf16 v[72:87], v[124:127], v[64:67], v[72:87]
    v_cvt_pk_bf16_f32 v68, v40, v41
    v_exp_f32 v44, v44
    v_exp_f32 v45, v45
    v_cvt_pk_bf16_f32 v69, v42, v43
    v_exp_f32 v46, v46
    v_exp_f32 v47, v47
    v_cvt_pk_bf16_f32 v70, v44, v45
    v_cvt_pk_bf16_f32 v71, v46, v47
    s_waitcnt lgkmcnt(0)
    v_mfma_f32_32x32x16_bf16 v[32:47], v[104:107], v[8:11], 0
    ds_read_b64_tr_b16 v[116:117], v134 offset:10240
    ds_read_b64_tr_b16 v[118:119], v134 offset:10400
    ds_read_b64_tr_b16 v[120:121], v134 offset:10880
    ds_read_b64_tr_b16 v[122:123], v134 offset:11040
    v_exp_f32 v48, v48
    v_exp_f32 v49, v49
    v_exp_f32 v50, v50
    v_exp_f32 v51, v51
    v_cvt_pk_bf16_f32 v64, v48, v49
    v_mfma_f32_32x32x16_bf16 v[72:87], v[128:131], v[68:71], v[72:87]
    v_exp_f32 v52, v52
    v_exp_f32 v53, v53
    v_cvt_pk_bf16_f32 v65, v50, v51
    v_exp_f32 v54, v54
    v_exp_f32 v55, v55
    v_cvt_pk_bf16_f32 v66, v52, v53
    v_mfma_f32_32x32x8_bf16 v[32:47], v[112:113], v[16:17], v[32:47]
    v_exp_f32 v56, v56
    v_exp_f32 v57, v57
    v_cvt_pk_bf16_f32 v67, v54, v55
    v_exp_f32 v58, v58
    v_exp_f32 v59, v59
    v_mfma_f32_32x32x16_bf16 v[88:103], v[124:127], v[64:67], v[88:103]
    v_cvt_pk_bf16_f32 v68, v56, v57
    v_exp_f32 v60, v60
    v_exp_f32 v61, v61
    v_cvt_pk_bf16_f32 v69, v58, v59
    v_exp_f32 v62, v62
    v_exp_f32 v63, v63
    v_cvt_pk_bf16_f32 v70, v60, v61
    v_cvt_pk_bf16_f32 v71, v62, v63
    s_waitcnt lgkmcnt(0)
    v_mfma_f32_32x32x16_bf16 v[48:63], v[104:107], v[12:15], 0
    ds_read_b128 v[108:111], v132 offset:4608
    ds_read_b32 v114, v133 offset:1152
    v_exp_f32 v32, v32
    v_exp_f32 v33, v33
    v_exp_f32 v34, v34
    v_exp_f32 v35, v35
    v_cvt_pk_bf16_f32 v64, v32, v33
    v_mfma_f32_32x32x16_bf16 v[88:103], v[128:131], v[68:71], v[88:103]
    v_exp_f32 v36, v36
    v_exp_f32 v37, v37
    v_cvt_pk_bf16_f32 v65, v34, v35
    v_exp_f32 v38, v38
    v_exp_f32 v39, v39
    v_cvt_pk_bf16_f32 v66, v36, v37
    v_mfma_f32_32x32x8_bf16 v[48:63], v[112:113], v[18:19], v[48:63]
    v_exp_f32 v40, v40
    v_exp_f32 v41, v41
    v_cvt_pk_bf16_f32 v67, v38, v39
    v_exp_f32 v42, v42
    v_exp_f32 v43, v43
    v_mfma_f32_32x32x16_bf16 v[72:87], v[116:119], v[64:67], v[72:87]
    v_cvt_pk_bf16_f32 v68, v40, v41
    v_exp_f32 v44, v44
    v_exp_f32 v45, v45
    v_cvt_pk_bf16_f32 v69, v42, v43
    v_exp_f32 v46, v46
    v_exp_f32 v47, v47
    v_cvt_pk_bf16_f32 v70, v44, v45
    v_cvt_pk_bf16_f32 v71, v46, v47
    s_waitcnt lgkmcnt(0)
    v_mfma_f32_32x32x16_bf16 v[32:47], v[108:111], v[8:11], 0
    ds_read_b64_tr_b16 v[124:125], v134 offset:11520
    ds_read_b64_tr_b16 v[126:127], v134 offset:11680
    ds_read_b64_tr_b16 v[128:129], v134 offset:12160
    ds_read_b64_tr_b16 v[130:131], v134 offset:12320
    v_exp_f32 v48, v48
    v_exp_f32 v49, v49
    v_exp_f32 v50, v50
    v_exp_f32 v51, v51
    v_cvt_pk_bf16_f32 v64, v48, v49
    v_mfma_f32_32x32x16_bf16 v[72:87], v[120:123], v[68:71], v[72:87]
    v_exp_f32 v52, v52
    v_exp_f32 v53, v53
    v_cvt_pk_bf16_f32 v65, v50, v51
    v_exp_f32 v54, v54
    v_exp_f32 v55, v55
    v_cvt_pk_bf16_f32 v66, v52, v53
    v_mfma_f32_32x32x8_bf16 v[32:47], v[114:115], v[16:17], v[32:47]
    v_exp_f32 v56, v56
    v_exp_f32 v57, v57
    v_cvt_pk_bf16_f32 v67, v54, v55
    v_exp_f32 v58, v58
    v_exp_f32 v59, v59
    v_mfma_f32_32x32x16_bf16 v[88:103], v[116:119], v[64:67], v[88:103]
    v_cvt_pk_bf16_f32 v68, v56, v57
    v_exp_f32 v60, v60
    v_exp_f32 v61, v61
    v_cvt_pk_bf16_f32 v69, v58, v59
    v_exp_f32 v62, v62
    v_exp_f32 v63, v63
    v_cvt_pk_bf16_f32 v70, v60, v61
    v_cvt_pk_bf16_f32 v71, v62, v63
    s_waitcnt lgkmcnt(0)
    v_mfma_f32_32x32x16_bf16 v[48:63], v[108:111], v[12:15], 0
    ds_read_b128 v[104:107], v132 offset:5120
    ds_read_b32 v112, v133 offset:1280
    v_exp_f32 v32, v32
    v_exp_f32 v33, v33
    v_exp_f32 v34, v34
    v_exp_f32 v35, v35
    v_cvt_pk_bf16_f32 v64, v32, v33
    v_mfma_f32_32x32x16_bf16 v[88:103], v[120:123], v[68:71], v[88:103]
    v_exp_f32 v36, v36
    v_exp_f32 v37, v37
    v_cvt_pk_bf16_f32 v65, v34, v35
    v_exp_f32 v38, v38
    v_exp_f32 v39, v39
    v_cvt_pk_bf16_f32 v66, v36, v37
    v_mfma_f32_32x32x8_bf16 v[48:63], v[114:115], v[18:19], v[48:63]
    v_exp_f32 v40, v40
    v_exp_f32 v41, v41
    v_cvt_pk_bf16_f32 v67, v38, v39
    v_exp_f32 v42, v42
    v_exp_f32 v43, v43
    v_mfma_f32_32x32x16_bf16 v[72:87], v[124:127], v[64:67], v[72:87]
    v_cvt_pk_bf16_f32 v68, v40, v41
    v_exp_f32 v44, v44
    v_exp_f32 v45, v45
    v_cvt_pk_bf16_f32 v69, v42, v43
    v_exp_f32 v46, v46
    v_exp_f32 v47, v47
    v_cvt_pk_bf16_f32 v70, v44, v45
    v_cvt_pk_bf16_f32 v71, v46, v47
    s_waitcnt lgkmcnt(0)
    v_mfma_f32_32x32x16_bf16 v[32:47], v[104:107], v[8:11], 0
    ds_read_b64_tr_b16 v[116:117], v134 offset:12800
    ds_read_b64_tr_b16 v[118:119], v134 offset:12960
    ds_read_b64_tr_b16 v[120:121], v134 offset:13440
    ds_read_b64_tr_b16 v[122:123], v134 offset:13600
    v_exp_f32 v48, v48
    v_exp_f32 v49, v49
    v_exp_f32 v50, v50
    v_exp_f32 v51, v51
    v_cvt_pk_bf16_f32 v64, v48, v49
    v_mfma_f32_32x32x16_bf16 v[72:87], v[128:131], v[68:71], v[72:87]
    v_exp_f32 v52, v52
    v_exp_f32 v53, v53
    v_cvt_pk_bf16_f32 v65, v50, v51
    v_exp_f32 v54, v54
    v_exp_f32 v55, v55
    v_cvt_pk_bf16_f32 v66, v52, v53
    v_mfma_f32_32x32x8_bf16 v[32:47], v[112:113], v[16:17], v[32:47]
    v_exp_f32 v56, v56
    v_exp_f32 v57, v57
    v_cvt_pk_bf16_f32 v67, v54, v55
    v_exp_f32 v58, v58
    v_exp_f32 v59, v59
    v_mfma_f32_32x32x16_bf16 v[88:103], v[124:127], v[64:67], v[88:103]
    v_cvt_pk_bf16_f32 v68, v56, v57
    v_exp_f32 v60, v60
    v_exp_f32 v61, v61
    v_cvt_pk_bf16_f32 v69, v58, v59
    v_exp_f32 v62, v62
    v_exp_f32 v63, v63
    v_cvt_pk_bf16_f32 v70, v60, v61
    v_cvt_pk_bf16_f32 v71, v62, v63
    s_waitcnt lgkmcnt(0)
    v_mfma_f32_32x32x16_bf16 v[48:63], v[104:107], v[12:15], 0
    ds_read_b128 v[108:111], v132 offset:5632
    ds_read_b32 v114, v133 offset:1408
    v_exp_f32 v32, v32
    v_exp_f32 v33, v33
    v_exp_f32 v34, v34
    v_exp_f32 v35, v35
    v_cvt_pk_bf16_f32 v64, v32, v33
    v_mfma_f32_32x32x16_bf16 v[88:103], v[128:131], v[68:71], v[88:103]
    v_exp_f32 v36, v36
    v_exp_f32 v37, v37
    v_cvt_pk_bf16_f32 v65, v34, v35
    v_exp_f32 v38, v38
    v_exp_f32 v39, v39
    v_cvt_pk_bf16_f32 v66, v36, v37
    v_mfma_f32_32x32x8_bf16 v[48:63], v[112:113], v[18:19], v[48:63]
    v_exp_f32 v40, v40
    v_exp_f32 v41, v41
    v_cvt_pk_bf16_f32 v67, v38, v39
    v_exp_f32 v42, v42
    v_exp_f32 v43, v43
    v_mfma_f32_32x32x16_bf16 v[72:87], v[116:119], v[64:67], v[72:87]
    v_cvt_pk_bf16_f32 v68, v40, v41
    v_exp_f32 v44, v44
    v_exp_f32 v45, v45
    v_cvt_pk_bf16_f32 v69, v42, v43
    v_exp_f32 v46, v46
    v_exp_f32 v47, v47
    v_cvt_pk_bf16_f32 v70, v44, v45
    v_cvt_pk_bf16_f32 v71, v46, v47
    s_waitcnt lgkmcnt(0)
    v_mfma_f32_32x32x16_bf16 v[32:47], v[108:111], v[8:11], 0
    ds_read_b64_tr_b16 v[124:125], v134 offset:14080
    ds_read_b64_tr_b16 v[126:127], v134 offset:14240
    ds_read_b64_tr_b16 v[128:129], v134 offset:14720
    ds_read_b64_tr_b16 v[130:131], v134 offset:14880
    v_exp_f32 v48, v48
    v_exp_f32 v49, v49
    v_exp_f32 v50, v50
    v_exp_f32 v51, v51
    v_cvt_pk_bf16_f32 v64, v48, v49
    v_mfma_f32_32x32x16_bf16 v[72:87], v[120:123], v[68:71], v[72:87]
    v_exp_f32 v52, v52
    v_exp_f32 v53, v53
    v_cvt_pk_bf16_f32 v65, v50, v51
    v_exp_f32 v54, v54
    v_exp_f32 v55, v55
    v_cvt_pk_bf16_f32 v66, v52, v53
    v_mfma_f32_32x32x8_bf16 v[32:47], v[114:115], v[16:17], v[32:47]
    v_exp_f32 v56, v56
    v_exp_f32 v57, v57
    v_cvt_pk_bf16_f32 v67, v54, v55
    v_exp_f32 v58, v58
    v_exp_f32 v59, v59
    v_mfma_f32_32x32x16_bf16 v[88:103], v[116:119], v[64:67], v[88:103]
    v_cvt_pk_bf16_f32 v68, v56, v57
    v_exp_f32 v60, v60
    v_exp_f32 v61, v61
    v_cvt_pk_bf16_f32 v69, v58, v59
    v_exp_f32 v62, v62
    v_exp_f32 v63, v63
    v_cvt_pk_bf16_f32 v70, v60, v61
    v_cvt_pk_bf16_f32 v71, v62, v63
    s_setprio 1
    s_waitcnt lgkmcnt(0)
    v_mfma_f32_32x32x16_bf16 v[48:63], v[108:111], v[12:15], 0
    ds_read_b128 v[104:107], v132 offset:6144
    ds_read_b32 v112, v133 offset:1536
    v_exp_f32 v32, v32
    v_exp_f32 v33, v33
    v_exp_f32 v34, v34
    v_exp_f32 v35, v35
    v_cvt_pk_bf16_f32 v64, v32, v33
    v_mfma_f32_32x32x16_bf16 v[88:103], v[120:123], v[68:71], v[88:103]
    v_exp_f32 v36, v36
    v_exp_f32 v37, v37
    v_cvt_pk_bf16_f32 v65, v34, v35
    v_exp_f32 v38, v38
    v_exp_f32 v39, v39
    v_cvt_pk_bf16_f32 v66, v36, v37
    v_mfma_f32_32x32x8_bf16 v[48:63], v[114:115], v[18:19], v[48:63]
    v_exp_f32 v40, v40
    v_exp_f32 v41, v41
    v_cvt_pk_bf16_f32 v67, v38, v39
    v_exp_f32 v42, v42
    v_exp_f32 v43, v43
    v_mfma_f32_32x32x16_bf16 v[72:87], v[124:127], v[64:67], v[72:87]
    v_cvt_pk_bf16_f32 v68, v40, v41
    v_exp_f32 v44, v44
    v_exp_f32 v45, v45
    v_cvt_pk_bf16_f32 v69, v42, v43
    v_exp_f32 v46, v46
    v_exp_f32 v47, v47
    v_cvt_pk_bf16_f32 v70, v44, v45
    v_cvt_pk_bf16_f32 v71, v46, v47
    s_waitcnt lgkmcnt(0)
    v_mfma_f32_32x32x16_bf16 v[32:47], v[104:107], v[8:11], 0
    ds_read_b64_tr_b16 v[116:117], v134 offset:15360
    ds_read_b64_tr_b16 v[118:119], v134 offset:15520
    ds_read_b64_tr_b16 v[120:121], v134 offset:16000
    ds_read_b64_tr_b16 v[122:123], v134 offset:16160
    v_exp_f32 v48, v48
    v_exp_f32 v49, v49
    v_exp_f32 v50, v50
    v_exp_f32 v51, v51
    v_cvt_pk_bf16_f32 v64, v48, v49
    v_mfma_f32_32x32x16_bf16 v[72:87], v[128:131], v[68:71], v[72:87]
    v_exp_f32 v52, v52
    v_exp_f32 v53, v53
    v_cvt_pk_bf16_f32 v65, v50, v51
    v_exp_f32 v54, v54
    v_exp_f32 v55, v55
    v_cvt_pk_bf16_f32 v66, v52, v53
    v_mfma_f32_32x32x8_bf16 v[32:47], v[112:113], v[16:17], v[32:47]
    v_exp_f32 v56, v56
    v_exp_f32 v57, v57
    v_cvt_pk_bf16_f32 v67, v54, v55
    v_exp_f32 v58, v58
    v_exp_f32 v59, v59
    v_mfma_f32_32x32x16_bf16 v[88:103], v[124:127], v[64:67], v[88:103]
    v_cvt_pk_bf16_f32 v68, v56, v57
    v_exp_f32 v60, v60
    v_exp_f32 v61, v61
    v_cvt_pk_bf16_f32 v69, v58, v59
    v_exp_f32 v62, v62
    v_exp_f32 v63, v63
    v_cvt_pk_bf16_f32 v70, v60, v61
    v_cvt_pk_bf16_f32 v71, v62, v63
    s_waitcnt lgkmcnt(0)
    v_mfma_f32_32x32x16_bf16 v[48:63], v[104:107], v[12:15], 0
    ds_read_b128 v[108:111], v132 offset:6656
    ds_read_b32 v114, v133 offset:1664
    v_exp_f32 v32, v32
    v_exp_f32 v33, v33
    v_exp_f32 v34, v34
    v_exp_f32 v35, v35
    v_cvt_pk_bf16_f32 v64, v32, v33
    v_mfma_f32_32x32x16_bf16 v[88:103], v[128:131], v[68:71], v[88:103]
    v_exp_f32 v36, v36
    v_exp_f32 v37, v37
    v_cvt_pk_bf16_f32 v65, v34, v35
    v_exp_f32 v38, v38
    v_exp_f32 v39, v39
    v_cvt_pk_bf16_f32 v66, v36, v37
    v_mfma_f32_32x32x8_bf16 v[48:63], v[112:113], v[18:19], v[48:63]
    v_exp_f32 v40, v40
    v_exp_f32 v41, v41
    v_cvt_pk_bf16_f32 v67, v38, v39
    v_exp_f32 v42, v42
    v_exp_f32 v43, v43
    v_mfma_f32_32x32x16_bf16 v[72:87], v[116:119], v[64:67], v[72:87]
    v_cvt_pk_bf16_f32 v68, v40, v41
    v_exp_f32 v44, v44
    v_exp_f32 v45, v45
    v_cvt_pk_bf16_f32 v69, v42, v43
    v_exp_f32 v46, v46
    v_exp_f32 v47, v47
    v_cvt_pk_bf16_f32 v70, v44, v45
    v_cvt_pk_bf16_f32 v71, v46, v47
    s_waitcnt lgkmcnt(0)
    v_mfma_f32_32x32x16_bf16 v[32:47], v[108:111], v[8:11], 0
    ds_read_b64_tr_b16 v[124:125], v134 offset:16640
    ds_read_b64_tr_b16 v[126:127], v134 offset:16800
    ds_read_b64_tr_b16 v[128:129], v134 offset:17280
    ds_read_b64_tr_b16 v[130:131], v134 offset:17440
    v_exp_f32 v48, v48
    v_exp_f32 v49, v49
    v_exp_f32 v50, v50
    v_exp_f32 v51, v51
    v_cvt_pk_bf16_f32 v64, v48, v49
    v_mfma_f32_32x32x16_bf16 v[72:87], v[120:123], v[68:71], v[72:87]
    v_exp_f32 v52, v52
    v_exp_f32 v53, v53
    v_cvt_pk_bf16_f32 v65, v50, v51
    v_exp_f32 v54, v54
    v_exp_f32 v55, v55
    v_cvt_pk_bf16_f32 v66, v52, v53
    v_mfma_f32_32x32x8_bf16 v[32:47], v[114:115], v[16:17], v[32:47]
    v_exp_f32 v56, v56
    v_exp_f32 v57, v57
    v_cvt_pk_bf16_f32 v67, v54, v55
    v_exp_f32 v58, v58
    v_exp_f32 v59, v59
    v_mfma_f32_32x32x16_bf16 v[88:103], v[116:119], v[64:67], v[88:103]
    v_cvt_pk_bf16_f32 v68, v56, v57
    v_exp_f32 v60, v60
    v_exp_f32 v61, v61
    v_cvt_pk_bf16_f32 v69, v58, v59
    v_exp_f32 v62, v62
    v_exp_f32 v63, v63
    v_cvt_pk_bf16_f32 v70, v60, v61
    v_cvt_pk_bf16_f32 v71, v62, v63
    s_waitcnt lgkmcnt(0)
    v_mfma_f32_32x32x16_bf16 v[48:63], v[108:111], v[12:15], 0
    ds_read_b128 v[104:107], v132 offset:7168
    ds_read_b32 v112, v133 offset:1792
    v_exp_f32 v32, v32
    v_exp_f32 v33, v33
    v_exp_f32 v34, v34
    v_exp_f32 v35, v35
    v_cvt_pk_bf16_f32 v64, v32, v33
    v_mfma_f32_32x32x16_bf16 v[88:103], v[120:123], v[68:71], v[88:103]
    v_exp_f32 v36, v36
    v_exp_f32 v37, v37
    v_cvt_pk_bf16_f32 v65, v34, v35
    v_exp_f32 v38, v38
    v_exp_f32 v39, v39
    v_cvt_pk_bf16_f32 v66, v36, v37
    v_mfma_f32_32x32x8_bf16 v[48:63], v[114:115], v[18:19], v[48:63]
    v_exp_f32 v40, v40
    v_exp_f32 v41, v41
    v_cvt_pk_bf16_f32 v67, v38, v39
    v_exp_f32 v42, v42
    v_exp_f32 v43, v43
    v_mfma_f32_32x32x16_bf16 v[72:87], v[124:127], v[64:67], v[72:87]
    v_cvt_pk_bf16_f32 v68, v40, v41
    v_exp_f32 v44, v44
    v_exp_f32 v45, v45
    v_cvt_pk_bf16_f32 v69, v42, v43
    v_exp_f32 v46, v46
    v_exp_f32 v47, v47
    v_cvt_pk_bf16_f32 v70, v44, v45
    v_cvt_pk_bf16_f32 v71, v46, v47
    s_waitcnt lgkmcnt(0)
    v_mfma_f32_32x32x16_bf16 v[32:47], v[104:107], v[8:11], 0
    ds_read_b64_tr_b16 v[116:117], v134 offset:17920
    ds_read_b64_tr_b16 v[118:119], v134 offset:18080
    ds_read_b64_tr_b16 v[120:121], v134 offset:18560
    ds_read_b64_tr_b16 v[122:123], v134 offset:18720
    v_exp_f32 v48, v48
    v_exp_f32 v49, v49
    v_exp_f32 v50, v50
    v_exp_f32 v51, v51
    v_cvt_pk_bf16_f32 v64, v48, v49
    v_mfma_f32_32x32x16_bf16 v[72:87], v[128:131], v[68:71], v[72:87]
    v_exp_f32 v52, v52
    v_exp_f32 v53, v53
    v_cvt_pk_bf16_f32 v65, v50, v51
    v_exp_f32 v54, v54
    v_exp_f32 v55, v55
    v_cvt_pk_bf16_f32 v66, v52, v53
    v_mfma_f32_32x32x8_bf16 v[32:47], v[112:113], v[16:17], v[32:47]
    v_exp_f32 v56, v56
    v_exp_f32 v57, v57
    v_cvt_pk_bf16_f32 v67, v54, v55
    v_exp_f32 v58, v58
    v_exp_f32 v59, v59
    v_mfma_f32_32x32x16_bf16 v[88:103], v[124:127], v[64:67], v[88:103]
    v_cvt_pk_bf16_f32 v68, v56, v57
    v_exp_f32 v60, v60
    v_exp_f32 v61, v61
    v_cvt_pk_bf16_f32 v69, v58, v59
    v_exp_f32 v62, v62
    v_exp_f32 v63, v63
    v_cvt_pk_bf16_f32 v70, v60, v61
    v_cvt_pk_bf16_f32 v71, v62, v63
    s_waitcnt lgkmcnt(0)
    v_mfma_f32_32x32x16_bf16 v[48:63], v[104:107], v[12:15], 0
    ds_read_b128 v[108:111], v132 offset:7680
    ds_read_b32 v114, v133 offset:1920
    v_exp_f32 v32, v32
    v_exp_f32 v33, v33
    v_exp_f32 v34, v34
    v_exp_f32 v35, v35
    v_cvt_pk_bf16_f32 v64, v32, v33
    v_mfma_f32_32x32x16_bf16 v[88:103], v[128:131], v[68:71], v[88:103]
    v_exp_f32 v36, v36
    v_exp_f32 v37, v37
    v_cvt_pk_bf16_f32 v65, v34, v35
    v_exp_f32 v38, v38
    v_exp_f32 v39, v39
    v_cvt_pk_bf16_f32 v66, v36, v37
    v_mfma_f32_32x32x8_bf16 v[48:63], v[112:113], v[18:19], v[48:63]
    v_exp_f32 v40, v40
    v_exp_f32 v41, v41
    v_cvt_pk_bf16_f32 v67, v38, v39
    v_exp_f32 v42, v42
    v_exp_f32 v43, v43
    v_mfma_f32_32x32x16_bf16 v[72:87], v[116:119], v[64:67], v[72:87]
    v_cvt_pk_bf16_f32 v68, v40, v41
    v_exp_f32 v44, v44
    v_exp_f32 v45, v45
    v_cvt_pk_bf16_f32 v69, v42, v43
    v_exp_f32 v46, v46
    v_exp_f32 v47, v47
    v_cvt_pk_bf16_f32 v70, v44, v45
    v_cvt_pk_bf16_f32 v71, v46, v47
    s_waitcnt lgkmcnt(0)
    v_mfma_f32_32x32x16_bf16 v[32:47], v[108:111], v[8:11], 0
    ds_read_b64_tr_b16 v[124:125], v134 offset:19200
    ds_read_b64_tr_b16 v[126:127], v134 offset:19360
    ds_read_b64_tr_b16 v[128:129], v134 offset:19840
    ds_read_b64_tr_b16 v[130:131], v134 offset:20000
    v_exp_f32 v48, v48
    v_exp_f32 v49, v49
    v_exp_f32 v50, v50
    v_exp_f32 v51, v51
    v_cvt_pk_bf16_f32 v64, v48, v49
    v_mfma_f32_32x32x16_bf16 v[72:87], v[120:123], v[68:71], v[72:87]
    v_exp_f32 v52, v52
    v_exp_f32 v53, v53
    v_cvt_pk_bf16_f32 v65, v50, v51
    v_exp_f32 v54, v54
    v_exp_f32 v55, v55
    v_cvt_pk_bf16_f32 v66, v52, v53
    v_mfma_f32_32x32x8_bf16 v[32:47], v[114:115], v[16:17], v[32:47]
    v_exp_f32 v56, v56
    v_exp_f32 v57, v57
    v_cvt_pk_bf16_f32 v67, v54, v55
    v_exp_f32 v58, v58
    v_exp_f32 v59, v59
    v_mfma_f32_32x32x16_bf16 v[88:103], v[116:119], v[64:67], v[88:103]
    v_cvt_pk_bf16_f32 v68, v56, v57
    v_exp_f32 v60, v60
    v_exp_f32 v61, v61
    v_cvt_pk_bf16_f32 v69, v58, v59
    v_exp_f32 v62, v62
    v_exp_f32 v63, v63
    v_cvt_pk_bf16_f32 v70, v60, v61
    v_cvt_pk_bf16_f32 v71, v62, v63
    s_waitcnt lgkmcnt(0)
    v_mfma_f32_32x32x16_bf16 v[48:63], v[108:111], v[12:15], 0
    ds_read_b128 v[104:107], v132 offset:8192
    ds_read_b32 v112, v133 offset:2048
    v_exp_f32 v32, v32
    v_exp_f32 v33, v33
    v_exp_f32 v34, v34
    v_exp_f32 v35, v35
    v_cvt_pk_bf16_f32 v64, v32, v33
    v_mfma_f32_32x32x16_bf16 v[88:103], v[120:123], v[68:71], v[88:103]
    v_exp_f32 v36, v36
    v_exp_f32 v37, v37
    v_cvt_pk_bf16_f32 v65, v34, v35
    v_exp_f32 v38, v38
    v_exp_f32 v39, v39
    v_cvt_pk_bf16_f32 v66, v36, v37
    v_mfma_f32_32x32x8_bf16 v[48:63], v[114:115], v[18:19], v[48:63]
    v_exp_f32 v40, v40
    v_exp_f32 v41, v41
    v_cvt_pk_bf16_f32 v67, v38, v39
    v_exp_f32 v42, v42
    v_exp_f32 v43, v43
    v_mfma_f32_32x32x16_bf16 v[72:87], v[124:127], v[64:67], v[72:87]
    v_cvt_pk_bf16_f32 v68, v40, v41
    v_exp_f32 v44, v44
    v_exp_f32 v45, v45
    v_cvt_pk_bf16_f32 v69, v42, v43
    v_exp_f32 v46, v46
    v_exp_f32 v47, v47
    v_cvt_pk_bf16_f32 v70, v44, v45
    v_cvt_pk_bf16_f32 v71, v46, v47
    s_waitcnt lgkmcnt(0)
    v_mfma_f32_32x32x16_bf16 v[32:47], v[104:107], v[8:11], 0
    ds_read_b64_tr_b16 v[116:117], v134 offset:20480
    ds_read_b64_tr_b16 v[118:119], v134 offset:20640
    ds_read_b64_tr_b16 v[120:121], v134 offset:21120
    ds_read_b64_tr_b16 v[122:123], v134 offset:21280
    v_exp_f32 v48, v48
    v_exp_f32 v49, v49
    v_exp_f32 v50, v50
    v_exp_f32 v51, v51
    v_cvt_pk_bf16_f32 v64, v48, v49
    v_mfma_f32_32x32x16_bf16 v[72:87], v[128:131], v[68:71], v[72:87]
    v_exp_f32 v52, v52
    v_exp_f32 v53, v53
    v_cvt_pk_bf16_f32 v65, v50, v51
    v_exp_f32 v54, v54
    v_exp_f32 v55, v55
    v_cvt_pk_bf16_f32 v66, v52, v53
    v_mfma_f32_32x32x8_bf16 v[32:47], v[112:113], v[16:17], v[32:47]
    v_exp_f32 v56, v56
    v_exp_f32 v57, v57
    v_cvt_pk_bf16_f32 v67, v54, v55
    v_exp_f32 v58, v58
    v_exp_f32 v59, v59
    v_mfma_f32_32x32x16_bf16 v[88:103], v[124:127], v[64:67], v[88:103]
    v_cvt_pk_bf16_f32 v68, v56, v57
    v_exp_f32 v60, v60
    v_exp_f32 v61, v61
    v_cvt_pk_bf16_f32 v69, v58, v59
    v_exp_f32 v62, v62
    v_exp_f32 v63, v63
    v_cvt_pk_bf16_f32 v70, v60, v61
    v_cvt_pk_bf16_f32 v71, v62, v63
    s_waitcnt lgkmcnt(0)
    v_mfma_f32_32x32x16_bf16 v[48:63], v[104:107], v[12:15], 0
    ds_read_b128 v[108:111], v132 offset:8704
    ds_read_b32 v114, v133 offset:2176
    v_exp_f32 v32, v32
    v_exp_f32 v33, v33
    v_exp_f32 v34, v34
    v_exp_f32 v35, v35
    v_cvt_pk_bf16_f32 v64, v32, v33
    v_mfma_f32_32x32x16_bf16 v[88:103], v[128:131], v[68:71], v[88:103]
    v_exp_f32 v36, v36
    v_exp_f32 v37, v37
    v_cvt_pk_bf16_f32 v65, v34, v35
    v_exp_f32 v38, v38
    v_exp_f32 v39, v39
    v_cvt_pk_bf16_f32 v66, v36, v37
    v_mfma_f32_32x32x8_bf16 v[48:63], v[112:113], v[18:19], v[48:63]
    v_exp_f32 v40, v40
    v_exp_f32 v41, v41
    v_cvt_pk_bf16_f32 v67, v38, v39
    v_exp_f32 v42, v42
    v_exp_f32 v43, v43
    v_mfma_f32_32x32x16_bf16 v[72:87], v[116:119], v[64:67], v[72:87]
    v_cvt_pk_bf16_f32 v68, v40, v41
    v_exp_f32 v44, v44
    v_exp_f32 v45, v45
    v_cvt_pk_bf16_f32 v69, v42, v43
    v_exp_f32 v46, v46
    v_exp_f32 v47, v47
    v_cvt_pk_bf16_f32 v70, v44, v45
    v_cvt_pk_bf16_f32 v71, v46, v47
    s_waitcnt lgkmcnt(0)
    v_mfma_f32_32x32x16_bf16 v[32:47], v[108:111], v[8:11], 0
    ds_read_b64_tr_b16 v[124:125], v134 offset:21760
    ds_read_b64_tr_b16 v[126:127], v134 offset:21920
    ds_read_b64_tr_b16 v[128:129], v134 offset:22400
    ds_read_b64_tr_b16 v[130:131], v134 offset:22560
    v_exp_f32 v48, v48
    v_exp_f32 v49, v49
    v_exp_f32 v50, v50
    v_exp_f32 v51, v51
    v_cvt_pk_bf16_f32 v64, v48, v49
    v_mfma_f32_32x32x16_bf16 v[72:87], v[120:123], v[68:71], v[72:87]
    v_exp_f32 v52, v52
    v_exp_f32 v53, v53
    v_cvt_pk_bf16_f32 v65, v50, v51
    v_exp_f32 v54, v54
    v_exp_f32 v55, v55
    v_cvt_pk_bf16_f32 v66, v52, v53
    v_mfma_f32_32x32x8_bf16 v[32:47], v[114:115], v[16:17], v[32:47]
    v_exp_f32 v56, v56
    v_exp_f32 v57, v57
    v_cvt_pk_bf16_f32 v67, v54, v55
    v_exp_f32 v58, v58
    v_exp_f32 v59, v59
    v_mfma_f32_32x32x16_bf16 v[88:103], v[116:119], v[64:67], v[88:103]
    v_cvt_pk_bf16_f32 v68, v56, v57
    v_exp_f32 v60, v60
    v_exp_f32 v61, v61
    v_cvt_pk_bf16_f32 v69, v58, v59
    v_exp_f32 v62, v62
    v_exp_f32 v63, v63
    v_cvt_pk_bf16_f32 v70, v60, v61
    v_cvt_pk_bf16_f32 v71, v62, v63
    s_waitcnt lgkmcnt(0)
    v_mfma_f32_32x32x16_bf16 v[48:63], v[108:111], v[12:15], 0
    ds_read_b128 v[104:107], v132 offset:9216
    ds_read_b32 v112, v133 offset:2304
    v_exp_f32 v32, v32
    v_exp_f32 v33, v33
    v_exp_f32 v34, v34
    v_exp_f32 v35, v35
    v_cvt_pk_bf16_f32 v64, v32, v33
    v_mfma_f32_32x32x16_bf16 v[88:103], v[120:123], v[68:71], v[88:103]
    v_exp_f32 v36, v36
    v_exp_f32 v37, v37
    v_cvt_pk_bf16_f32 v65, v34, v35
    v_exp_f32 v38, v38
    v_exp_f32 v39, v39
    v_cvt_pk_bf16_f32 v66, v36, v37
    v_mfma_f32_32x32x8_bf16 v[48:63], v[114:115], v[18:19], v[48:63]
    v_exp_f32 v40, v40
    v_exp_f32 v41, v41
    v_cvt_pk_bf16_f32 v67, v38, v39
    v_exp_f32 v42, v42
    v_exp_f32 v43, v43
    v_mfma_f32_32x32x16_bf16 v[72:87], v[124:127], v[64:67], v[72:87]
    v_cvt_pk_bf16_f32 v68, v40, v41
    v_exp_f32 v44, v44
    v_exp_f32 v45, v45
    v_cvt_pk_bf16_f32 v69, v42, v43
    v_exp_f32 v46, v46
    v_exp_f32 v47, v47
    v_cvt_pk_bf16_f32 v70, v44, v45
    v_cvt_pk_bf16_f32 v71, v46, v47
    s_waitcnt lgkmcnt(0)
    v_mfma_f32_32x32x16_bf16 v[32:47], v[104:107], v[8:11], 0
    ds_read_b64_tr_b16 v[116:117], v134 offset:23040
    ds_read_b64_tr_b16 v[118:119], v134 offset:23200
    ds_read_b64_tr_b16 v[120:121], v134 offset:23680
    ds_read_b64_tr_b16 v[122:123], v134 offset:23840
    v_exp_f32 v48, v48
    v_exp_f32 v49, v49
    v_exp_f32 v50, v50
    v_exp_f32 v51, v51
    v_cvt_pk_bf16_f32 v64, v48, v49
    v_mfma_f32_32x32x16_bf16 v[72:87], v[128:131], v[68:71], v[72:87]
    v_exp_f32 v52, v52
    v_exp_f32 v53, v53
    v_cvt_pk_bf16_f32 v65, v50, v51
    v_exp_f32 v54, v54
    v_exp_f32 v55, v55
    v_cvt_pk_bf16_f32 v66, v52, v53
    v_mfma_f32_32x32x8_bf16 v[32:47], v[112:113], v[16:17], v[32:47]
    v_exp_f32 v56, v56
    v_exp_f32 v57, v57
    v_cvt_pk_bf16_f32 v67, v54, v55
    v_exp_f32 v58, v58
    v_exp_f32 v59, v59
    v_mfma_f32_32x32x16_bf16 v[88:103], v[124:127], v[64:67], v[88:103]
    v_cvt_pk_bf16_f32 v68, v56, v57
    v_exp_f32 v60, v60
    v_exp_f32 v61, v61
    v_cvt_pk_bf16_f32 v69, v58, v59
    v_exp_f32 v62, v62
    v_exp_f32 v63, v63
    v_cvt_pk_bf16_f32 v70, v60, v61
    v_cvt_pk_bf16_f32 v71, v62, v63
    s_waitcnt lgkmcnt(0)
    v_mfma_f32_32x32x16_bf16 v[48:63], v[104:107], v[12:15], 0
    ds_read_b128 v[108:111], v132 offset:9728
    ds_read_b32 v114, v133 offset:2432
    v_exp_f32 v32, v32
    v_exp_f32 v33, v33
    v_exp_f32 v34, v34
    v_exp_f32 v35, v35
    v_cvt_pk_bf16_f32 v64, v32, v33
    v_mfma_f32_32x32x16_bf16 v[88:103], v[128:131], v[68:71], v[88:103]
    v_exp_f32 v36, v36
    v_exp_f32 v37, v37
    v_cvt_pk_bf16_f32 v65, v34, v35
    v_exp_f32 v38, v38
    v_exp_f32 v39, v39
    v_cvt_pk_bf16_f32 v66, v36, v37
    v_mfma_f32_32x32x8_bf16 v[48:63], v[112:113], v[18:19], v[48:63]
    v_exp_f32 v40, v40
    v_exp_f32 v41, v41
    v_cvt_pk_bf16_f32 v67, v38, v39
    v_exp_f32 v42, v42
    v_exp_f32 v43, v43
    v_mfma_f32_32x32x16_bf16 v[72:87], v[116:119], v[64:67], v[72:87]
    v_cvt_pk_bf16_f32 v68, v40, v41
    v_exp_f32 v44, v44
    v_exp_f32 v45, v45
    v_cvt_pk_bf16_f32 v69, v42, v43
    v_exp_f32 v46, v46
    v_exp_f32 v47, v47
    v_cvt_pk_bf16_f32 v70, v44, v45
    v_cvt_pk_bf16_f32 v71, v46, v47
    s_waitcnt lgkmcnt(0)
    v_mfma_f32_32x32x16_bf16 v[32:47], v[108:111], v[8:11], 0
    ds_read_b64_tr_b16 v[124:125], v134 offset:24320
    ds_read_b64_tr_b16 v[126:127], v134 offset:24480
    ds_read_b64_tr_b16 v[128:129], v134 offset:24960
    ds_read_b64_tr_b16 v[130:131], v134 offset:25120
    v_exp_f32 v48, v48
    v_exp_f32 v49, v49
    v_exp_f32 v50, v50
    v_exp_f32 v51, v51
    v_cvt_pk_bf16_f32 v64, v48, v49
    v_mfma_f32_32x32x16_bf16 v[72:87], v[120:123], v[68:71], v[72:87]
    v_exp_f32 v52, v52
    v_exp_f32 v53, v53
    v_cvt_pk_bf16_f32 v65, v50, v51
    v_exp_f32 v54, v54
    v_exp_f32 v55, v55
    v_cvt_pk_bf16_f32 v66, v52, v53
    v_mfma_f32_32x32x8_bf16 v[32:47], v[114:115], v[16:17], v[32:47]
    v_exp_f32 v56, v56
    v_exp_f32 v57, v57
    v_cvt_pk_bf16_f32 v67, v54, v55
    v_exp_f32 v58, v58
    v_exp_f32 v59, v59
    v_mfma_f32_32x32x16_bf16 v[88:103], v[116:119], v[64:67], v[88:103]
    v_cvt_pk_bf16_f32 v68, v56, v57
    v_exp_f32 v60, v60
    v_exp_f32 v61, v61
    v_cvt_pk_bf16_f32 v69, v58, v59
    v_exp_f32 v62, v62
    v_exp_f32 v63, v63
    v_cvt_pk_bf16_f32 v70, v60, v61
    v_cvt_pk_bf16_f32 v71, v62, v63
    s_waitcnt lgkmcnt(0)
    v_mfma_f32_32x32x16_bf16 v[48:63], v[108:111], v[12:15], 0
    ds_read_b128 v[104:107], v132 offset:10240
    ds_read_b32 v112, v133 offset:2560
    v_exp_f32 v32, v32
    v_exp_f32 v33, v33
    v_exp_f32 v34, v34
    v_exp_f32 v35, v35
    v_cvt_pk_bf16_f32 v64, v32, v33
    v_mfma_f32_32x32x16_bf16 v[88:103], v[120:123], v[68:71], v[88:103]
    v_exp_f32 v36, v36
    v_exp_f32 v37, v37
    v_cvt_pk_bf16_f32 v65, v34, v35
    v_exp_f32 v38, v38
    v_exp_f32 v39, v39
    v_cvt_pk_bf16_f32 v66, v36, v37
    v_mfma_f32_32x32x8_bf16 v[48:63], v[114:115], v[18:19], v[48:63]
    v_exp_f32 v40, v40
    v_exp_f32 v41, v41
    v_cvt_pk_bf16_f32 v67, v38, v39
    v_exp_f32 v42, v42
    v_exp_f32 v43, v43
    v_mfma_f32_32x32x16_bf16 v[72:87], v[124:127], v[64:67], v[72:87]
    v_cvt_pk_bf16_f32 v68, v40, v41
    v_exp_f32 v44, v44
    v_exp_f32 v45, v45
    v_cvt_pk_bf16_f32 v69, v42, v43
    v_exp_f32 v46, v46
    v_exp_f32 v47, v47
    v_cvt_pk_bf16_f32 v70, v44, v45
    v_cvt_pk_bf16_f32 v71, v46, v47
    s_waitcnt lgkmcnt(0)
    v_mfma_f32_32x32x16_bf16 v[32:47], v[104:107], v[8:11], 0
    ds_read_b64_tr_b16 v[116:117], v134 offset:25600
    ds_read_b64_tr_b16 v[118:119], v134 offset:25760
    ds_read_b64_tr_b16 v[120:121], v134 offset:26240
    ds_read_b64_tr_b16 v[122:123], v134 offset:26400
    v_exp_f32 v48, v48
    v_exp_f32 v49, v49
    v_exp_f32 v50, v50
    v_exp_f32 v51, v51
    v_cvt_pk_bf16_f32 v64, v48, v49
    v_mfma_f32_32x32x16_bf16 v[72:87], v[128:131], v[68:71], v[72:87]
    v_exp_f32 v52, v52
    v_exp_f32 v53, v53
    v_cvt_pk_bf16_f32 v65, v50, v51
    v_exp_f32 v54, v54
    v_exp_f32 v55, v55
    v_cvt_pk_bf16_f32 v66, v52, v53
    v_mfma_f32_32x32x8_bf16 v[32:47], v[112:113], v[16:17], v[32:47]
    v_exp_f32 v56, v56
    v_exp_f32 v57, v57
    v_cvt_pk_bf16_f32 v67, v54, v55
    v_exp_f32 v58, v58
    v_exp_f32 v59, v59
    v_mfma_f32_32x32x16_bf16 v[88:103], v[124:127], v[64:67], v[88:103]
    v_cvt_pk_bf16_f32 v68, v56, v57
    v_exp_f32 v60, v60
    v_exp_f32 v61, v61
    v_cvt_pk_bf16_f32 v69, v58, v59
    v_exp_f32 v62, v62
    v_exp_f32 v63, v63
    v_cvt_pk_bf16_f32 v70, v60, v61
    v_cvt_pk_bf16_f32 v71, v62, v63
    s_waitcnt lgkmcnt(0)
    v_mfma_f32_32x32x16_bf16 v[48:63], v[104:107], v[12:15], 0
    ds_read_b128 v[108:111], v132 offset:10752
    ds_read_b32 v114, v133 offset:2688
    v_exp_f32 v32, v32
    v_exp_f32 v33, v33
    v_exp_f32 v34, v34
    v_exp_f32 v35, v35
    v_cvt_pk_bf16_f32 v64, v32, v33
    v_mfma_f32_32x32x16_bf16 v[88:103], v[128:131], v[68:71], v[88:103]
    v_exp_f32 v36, v36
    v_exp_f32 v37, v37
    v_cvt_pk_bf16_f32 v65, v34, v35
    v_exp_f32 v38, v38
    v_exp_f32 v39, v39
    v_cvt_pk_bf16_f32 v66, v36, v37
    v_mfma_f32_32x32x8_bf16 v[48:63], v[112:113], v[18:19], v[48:63]
    v_exp_f32 v40, v40
    v_exp_f32 v41, v41
    v_cvt_pk_bf16_f32 v67, v38, v39
    v_exp_f32 v42, v42
    v_exp_f32 v43, v43
    v_mfma_f32_32x32x16_bf16 v[72:87], v[116:119], v[64:67], v[72:87]
    v_cvt_pk_bf16_f32 v68, v40, v41
    v_exp_f32 v44, v44
    v_exp_f32 v45, v45
    v_cvt_pk_bf16_f32 v69, v42, v43
    v_exp_f32 v46, v46
    v_exp_f32 v47, v47
    v_cvt_pk_bf16_f32 v70, v44, v45
    v_cvt_pk_bf16_f32 v71, v46, v47
    s_waitcnt lgkmcnt(0)
    v_mfma_f32_32x32x16_bf16 v[32:47], v[108:111], v[8:11], 0
    ds_read_b64_tr_b16 v[124:125], v134 offset:26880
    ds_read_b64_tr_b16 v[126:127], v134 offset:27040
    ds_read_b64_tr_b16 v[128:129], v134 offset:27520
    ds_read_b64_tr_b16 v[130:131], v134 offset:27680
    v_exp_f32 v48, v48
    v_exp_f32 v49, v49
    v_exp_f32 v50, v50
    v_exp_f32 v51, v51
    v_cvt_pk_bf16_f32 v64, v48, v49
    v_mfma_f32_32x32x16_bf16 v[72:87], v[120:123], v[68:71], v[72:87]
    v_exp_f32 v52, v52
    v_exp_f32 v53, v53
    v_cvt_pk_bf16_f32 v65, v50, v51
    v_exp_f32 v54, v54
    v_exp_f32 v55, v55
    v_cvt_pk_bf16_f32 v66, v52, v53
    v_mfma_f32_32x32x8_bf16 v[32:47], v[114:115], v[16:17], v[32:47]
    v_exp_f32 v56, v56
    v_exp_f32 v57, v57
    v_cvt_pk_bf16_f32 v67, v54, v55
    v_exp_f32 v58, v58
    v_exp_f32 v59, v59
    v_mfma_f32_32x32x16_bf16 v[88:103], v[116:119], v[64:67], v[88:103]
    v_cvt_pk_bf16_f32 v68, v56, v57
    v_exp_f32 v60, v60
    v_exp_f32 v61, v61
    v_cvt_pk_bf16_f32 v69, v58, v59
    v_exp_f32 v62, v62
    v_exp_f32 v63, v63
    v_cvt_pk_bf16_f32 v70, v60, v61
    v_cvt_pk_bf16_f32 v71, v62, v63
    s_waitcnt lgkmcnt(0)
    v_mfma_f32_32x32x16_bf16 v[48:63], v[108:111], v[12:15], 0
    ds_read_b128 v[104:107], v132 offset:11264
    ds_read_b32 v112, v133 offset:2816
    v_exp_f32 v32, v32
    v_exp_f32 v33, v33
    v_exp_f32 v34, v34
    v_exp_f32 v35, v35
    v_cvt_pk_bf16_f32 v64, v32, v33
    v_mfma_f32_32x32x16_bf16 v[88:103], v[120:123], v[68:71], v[88:103]
    v_exp_f32 v36, v36
    v_exp_f32 v37, v37
    v_cvt_pk_bf16_f32 v65, v34, v35
    v_exp_f32 v38, v38
    v_exp_f32 v39, v39
    v_cvt_pk_bf16_f32 v66, v36, v37
    v_mfma_f32_32x32x8_bf16 v[48:63], v[114:115], v[18:19], v[48:63]
    v_exp_f32 v40, v40
    v_exp_f32 v41, v41
    v_cvt_pk_bf16_f32 v67, v38, v39
    v_exp_f32 v42, v42
    v_exp_f32 v43, v43
    v_mfma_f32_32x32x16_bf16 v[72:87], v[124:127], v[64:67], v[72:87]
    v_cvt_pk_bf16_f32 v68, v40, v41
    v_exp_f32 v44, v44
    v_exp_f32 v45, v45
    v_cvt_pk_bf16_f32 v69, v42, v43
    v_exp_f32 v46, v46
    v_exp_f32 v47, v47
    v_cvt_pk_bf16_f32 v70, v44, v45
    v_cvt_pk_bf16_f32 v71, v46, v47
    s_waitcnt lgkmcnt(0)
    v_mfma_f32_32x32x16_bf16 v[32:47], v[104:107], v[8:11], 0
    ds_read_b64_tr_b16 v[116:117], v134 offset:28160
    ds_read_b64_tr_b16 v[118:119], v134 offset:28320
    ds_read_b64_tr_b16 v[120:121], v134 offset:28800
    ds_read_b64_tr_b16 v[122:123], v134 offset:28960
    v_exp_f32 v48, v48
    v_exp_f32 v49, v49
    v_exp_f32 v50, v50
    v_exp_f32 v51, v51
    v_cvt_pk_bf16_f32 v64, v48, v49
    v_mfma_f32_32x32x16_bf16 v[72:87], v[128:131], v[68:71], v[72:87]
    v_exp_f32 v52, v52
    v_exp_f32 v53, v53
    v_cvt_pk_bf16_f32 v65, v50, v51
    v_exp_f32 v54, v54
    v_exp_f32 v55, v55
    v_cvt_pk_bf16_f32 v66, v52, v53
    v_mfma_f32_32x32x8_bf16 v[32:47], v[112:113], v[16:17], v[32:47]
    v_exp_f32 v56, v56
    v_exp_f32 v57, v57
    v_cvt_pk_bf16_f32 v67, v54, v55
    v_exp_f32 v58, v58
    v_exp_f32 v59, v59
    v_mfma_f32_32x32x16_bf16 v[88:103], v[124:127], v[64:67], v[88:103]
    v_cvt_pk_bf16_f32 v68, v56, v57
    v_exp_f32 v60, v60
    v_exp_f32 v61, v61
    v_cvt_pk_bf16_f32 v69, v58, v59
    v_exp_f32 v62, v62
    v_exp_f32 v63, v63
    v_cvt_pk_bf16_f32 v70, v60, v61
    v_cvt_pk_bf16_f32 v71, v62, v63
    s_setprio 0
    s_waitcnt lgkmcnt(0)
    v_mfma_f32_32x32x16_bf16 v[48:63], v[104:107], v[12:15], 0
    ds_read_b128 v[108:111], v132 offset:11776
    ds_read_b32 v114, v133 offset:2944
    v_exp_f32 v32, v32
    v_exp_f32 v33, v33
    v_exp_f32 v34, v34
    v_exp_f32 v35, v35
    v_cvt_pk_bf16_f32 v64, v32, v33
    v_mfma_f32_32x32x16_bf16 v[88:103], v[128:131], v[68:71], v[88:103]
    v_exp_f32 v36, v36
    v_exp_f32 v37, v37
    v_cvt_pk_bf16_f32 v65, v34, v35
    v_exp_f32 v38, v38
    v_exp_f32 v39, v39
    v_cvt_pk_bf16_f32 v66, v36, v37
    v_mfma_f32_32x32x8_bf16 v[48:63], v[112:113], v[18:19], v[48:63]
    v_exp_f32 v40, v40
    v_exp_f32 v41, v41
    v_cvt_pk_bf16_f32 v67, v38, v39
    v_exp_f32 v42, v42
    v_exp_f32 v43, v43
    v_mfma_f32_32x32x16_bf16 v[72:87], v[116:119], v[64:67], v[72:87]
    v_cvt_pk_bf16_f32 v68, v40, v41
    v_exp_f32 v44, v44
    v_exp_f32 v45, v45
    v_cvt_pk_bf16_f32 v69, v42, v43
    v_exp_f32 v46, v46
    v_exp_f32 v47, v47
    v_cvt_pk_bf16_f32 v70, v44, v45
    v_cvt_pk_bf16_f32 v71, v46, v47
    s_waitcnt lgkmcnt(0)
    v_mfma_f32_32x32x16_bf16 v[32:47], v[108:111], v[8:11], 0
    ds_read_b64_tr_b16 v[124:125], v134 offset:29440
    ds_read_b64_tr_b16 v[126:127], v134 offset:29600
    ds_read_b64_tr_b16 v[128:129], v134 offset:30080
    ds_read_b64_tr_b16 v[130:131], v134 offset:30240
    v_exp_f32 v48, v48
    v_exp_f32 v49, v49
    v_exp_f32 v50, v50
    v_exp_f32 v51, v51
    v_cvt_pk_bf16_f32 v64, v48, v49
    v_mfma_f32_32x32x16_bf16 v[72:87], v[120:123], v[68:71], v[72:87]
    v_exp_f32 v52, v52
    v_exp_f32 v53, v53
    v_cvt_pk_bf16_f32 v65, v50, v51
    v_exp_f32 v54, v54
    v_exp_f32 v55, v55
    v_cvt_pk_bf16_f32 v66, v52, v53
    v_mfma_f32_32x32x8_bf16 v[32:47], v[114:115], v[16:17], v[32:47]
    v_exp_f32 v56, v56
    v_exp_f32 v57, v57
    v_cvt_pk_bf16_f32 v67, v54, v55
    v_exp_f32 v58, v58
    v_exp_f32 v59, v59
    v_mfma_f32_32x32x16_bf16 v[88:103], v[116:119], v[64:67], v[88:103]
    v_cvt_pk_bf16_f32 v68, v56, v57
    v_exp_f32 v60, v60
    v_exp_f32 v61, v61
    v_cvt_pk_bf16_f32 v69, v58, v59
    v_exp_f32 v62, v62
    v_exp_f32 v63, v63
    v_cvt_pk_bf16_f32 v70, v60, v61
    v_cvt_pk_bf16_f32 v71, v62, v63
    s_waitcnt lgkmcnt(0)
    v_mfma_f32_32x32x16_bf16 v[48:63], v[108:111], v[12:15], 0
    ds_read_b128 v[104:107], v132 offset:12288
    ds_read_b32 v112, v133 offset:3072
    v_exp_f32 v32, v32
    v_exp_f32 v33, v33
    v_exp_f32 v34, v34
    v_exp_f32 v35, v35
    v_cvt_pk_bf16_f32 v64, v32, v33
    v_mfma_f32_32x32x16_bf16 v[88:103], v[120:123], v[68:71], v[88:103]
    v_exp_f32 v36, v36
    v_exp_f32 v37, v37
    v_cvt_pk_bf16_f32 v65, v34, v35
    v_exp_f32 v38, v38
    v_exp_f32 v39, v39
    v_cvt_pk_bf16_f32 v66, v36, v37
    v_mfma_f32_32x32x8_bf16 v[48:63], v[114:115], v[18:19], v[48:63]
    v_exp_f32 v40, v40
    v_exp_f32 v41, v41
    v_cvt_pk_bf16_f32 v67, v38, v39
    v_exp_f32 v42, v42
    v_exp_f32 v43, v43
    v_mfma_f32_32x32x16_bf16 v[72:87], v[124:127], v[64:67], v[72:87]
    v_cvt_pk_bf16_f32 v68, v40, v41
    v_exp_f32 v44, v44
    v_exp_f32 v45, v45
    v_cvt_pk_bf16_f32 v69, v42, v43
    v_exp_f32 v46, v46
    v_exp_f32 v47, v47
    v_cvt_pk_bf16_f32 v70, v44, v45
    v_cvt_pk_bf16_f32 v71, v46, v47
    s_waitcnt lgkmcnt(0)
    v_mfma_f32_32x32x16_bf16 v[32:47], v[104:107], v[8:11], 0
    ds_read_b64_tr_b16 v[116:117], v134 offset:30720
    ds_read_b64_tr_b16 v[118:119], v134 offset:30880
    ds_read_b64_tr_b16 v[120:121], v134 offset:31360
    ds_read_b64_tr_b16 v[122:123], v134 offset:31520
    v_exp_f32 v48, v48
    v_exp_f32 v49, v49
    v_exp_f32 v50, v50
    v_exp_f32 v51, v51
    v_cvt_pk_bf16_f32 v64, v48, v49
    v_mfma_f32_32x32x16_bf16 v[72:87], v[128:131], v[68:71], v[72:87]
    v_exp_f32 v52, v52
    v_exp_f32 v53, v53
    v_cvt_pk_bf16_f32 v65, v50, v51
    v_exp_f32 v54, v54
    v_exp_f32 v55, v55
    v_cvt_pk_bf16_f32 v66, v52, v53
    v_mfma_f32_32x32x8_bf16 v[32:47], v[112:113], v[16:17], v[32:47]
    v_exp_f32 v56, v56
    v_exp_f32 v57, v57
    v_cvt_pk_bf16_f32 v67, v54, v55
    v_exp_f32 v58, v58
    v_exp_f32 v59, v59
    v_mfma_f32_32x32x16_bf16 v[88:103], v[124:127], v[64:67], v[88:103]
    v_cvt_pk_bf16_f32 v68, v56, v57
    v_exp_f32 v60, v60
    v_exp_f32 v61, v61
    v_cvt_pk_bf16_f32 v69, v58, v59
    v_exp_f32 v62, v62
    v_exp_f32 v63, v63
    v_cvt_pk_bf16_f32 v70, v60, v61
    v_cvt_pk_bf16_f32 v71, v62, v63
    s_cmp_lg_u32 s24, 4
    s_cbranch_scc1 L_sig_200005
    v_mov_b32 v20, 73764
    v_mov_b32 v21, 0x1000000
    s_mov_b64 exec, 1
    ds_add_u32 v20, v21
    s_mov_b64 exec, -1
L_sig_200005:
    s_waitcnt lgkmcnt(0)
    v_mfma_f32_32x32x16_bf16 v[48:63], v[104:107], v[12:15], 0
    ds_read_b128 v[108:111], v132 offset:12800
    ds_read_b32 v114, v133 offset:3200
    v_exp_f32 v32, v32
    v_exp_f32 v33, v33
    v_exp_f32 v34, v34
    v_exp_f32 v35, v35
    v_cvt_pk_bf16_f32 v64, v32, v33
    v_mfma_f32_32x32x16_bf16 v[88:103], v[128:131], v[68:71], v[88:103]
    v_exp_f32 v36, v36
    v_exp_f32 v37, v37
    v_cvt_pk_bf16_f32 v65, v34, v35
    v_exp_f32 v38, v38
    v_exp_f32 v39, v39
    v_cvt_pk_bf16_f32 v66, v36, v37
    v_mfma_f32_32x32x8_bf16 v[48:63], v[112:113], v[18:19], v[48:63]
    v_exp_f32 v40, v40
    v_exp_f32 v41, v41
    v_cvt_pk_bf16_f32 v67, v38, v39
    v_exp_f32 v42, v42
    v_exp_f32 v43, v43
    v_mfma_f32_32x32x16_bf16 v[72:87], v[116:119], v[64:67], v[72:87]
    v_cvt_pk_bf16_f32 v68, v40, v41
    v_exp_f32 v44, v44
    v_exp_f32 v45, v45
    v_cvt_pk_bf16_f32 v69, v42, v43
    v_exp_f32 v46, v46
    v_exp_f32 v47, v47
    v_cvt_pk_bf16_f32 v70, v44, v45
    v_cvt_pk_bf16_f32 v71, v46, v47
    s_waitcnt lgkmcnt(0)
    v_mfma_f32_32x32x16_bf16 v[32:47], v[108:111], v[8:11], 0
    ds_read_b64_tr_b16 v[124:125], v134 offset:32000
    ds_read_b64_tr_b16 v[126:127], v134 offset:32160
    ds_read_b64_tr_b16 v[128:129], v134 offset:32640
    ds_read_b64_tr_b16 v[130:131], v134 offset:32800
    v_exp_f32 v48, v48
    v_exp_f32 v49, v49
    v_exp_f32 v50, v50
    v_exp_f32 v51, v51
    v_cvt_pk_bf16_f32 v64, v48, v49
    v_mfma_f32_32x32x16_bf16 v[72:87], v[120:123], v[68:71], v[72:87]
    v_exp_f32 v52, v52
    v_exp_f32 v53, v53
    v_cvt_pk_bf16_f32 v65, v50, v51
    v_exp_f32 v54, v54
    v_exp_f32 v55, v55
    v_cvt_pk_bf16_f32 v66, v52, v53
    v_mfma_f32_32x32x8_bf16 v[32:47], v[114:115], v[16:17], v[32:47]
    v_exp_f32 v56, v56
    v_exp_f32 v57, v57
    v_cvt_pk_bf16_f32 v67, v54, v55
    v_exp_f32 v58, v58
    v_exp_f32 v59, v59
    v_mfma_f32_32x32x16_bf16 v[88:103], v[116:119], v[64:67], v[88:103]
    v_cvt_pk_bf16_f32 v68, v56, v57
    v_exp_f32 v60, v60
    v_exp_f32 v61, v61
    v_cvt_pk_bf16_f32 v69, v58, v59
    v_exp_f32 v62, v62
    v_exp_f32 v63, v63
    v_cvt_pk_bf16_f32 v70, v60, v61
    v_cvt_pk_bf16_f32 v71, v62, v63
    s_waitcnt lgkmcnt(0)
    v_mfma_f32_32x32x16_bf16 v[48:63], v[108:111], v[12:15], 0
    ds_read_b128 v[104:107], v132 offset:13312
    ds_read_b32 v112, v133 offset:3328
    v_exp_f32 v32, v32
    v_exp_f32 v33, v33
    v_exp_f32 v34, v34
    v_exp_f32 v35, v35
    v_cvt_pk_bf16_f32 v64, v32, v33
    v_mfma_f32_32x32x16_bf16 v[88:103], v[120:123], v[68:71], v[88:103]
    v_exp_f32 v36, v36
    v_exp_f32 v37, v37
    v_cvt_pk_bf16_f32 v65, v34, v35
    v_exp_f32 v38, v38
    v_exp_f32 v39, v39
    v_cvt_pk_bf16_f32 v66, v36, v37
    v_mfma_f32_32x32x8_bf16 v[48:63], v[114:115], v[18:19], v[48:63]
    v_exp_f32 v40, v40
    v_exp_f32 v41, v41
    v_cvt_pk_bf16_f32 v67, v38, v39
    v_exp_f32 v42, v42
    v_exp_f32 v43, v43
    v_mfma_f32_32x32x16_bf16 v[72:87], v[124:127], v[64:67], v[72:87]
    v_cvt_pk_bf16_f32 v68, v40, v41
    v_exp_f32 v44, v44
    v_exp_f32 v45, v45
    v_cvt_pk_bf16_f32 v69, v42, v43
    v_exp_f32 v46, v46
    v_exp_f32 v47, v47
    v_cvt_pk_bf16_f32 v70, v44, v45
    v_cvt_pk_bf16_f32 v71, v46, v47
    s_waitcnt lgkmcnt(0)
    v_mfma_f32_32x32x16_bf16 v[32:47], v[104:107], v[8:11], 0
    ds_read_b64_tr_b16 v[116:117], v134 offset:33280
    ds_read_b64_tr_b16 v[118:119], v134 offset:33440
    ds_read_b64_tr_b16 v[120:121], v134 offset:33920
    ds_read_b64_tr_b16 v[122:123], v134 offset:34080
    v_exp_f32 v48, v48
    v_exp_f32 v49, v49
    v_exp_f32 v50, v50
    v_exp_f32 v51, v51
    v_cvt_pk_bf16_f32 v64, v48, v49
    v_mfma_f32_32x32x16_bf16 v[72:87], v[128:131], v[68:71], v[72:87]
    v_exp_f32 v52, v52
    v_exp_f32 v53, v53
    v_cvt_pk_bf16_f32 v65, v50, v51
    v_exp_f32 v54, v54
    v_exp_f32 v55, v55
    v_cvt_pk_bf16_f32 v66, v52, v53
    v_mfma_f32_32x32x8_bf16 v[32:47], v[112:113], v[16:17], v[32:47]
    v_exp_f32 v56, v56
    v_exp_f32 v57, v57
    v_cvt_pk_bf16_f32 v67, v54, v55
    v_exp_f32 v58, v58
    v_exp_f32 v59, v59
    v_mfma_f32_32x32x16_bf16 v[88:103], v[124:127], v[64:67], v[88:103]
    v_cvt_pk_bf16_f32 v68, v56, v57
    v_exp_f32 v60, v60
    v_exp_f32 v61, v61
    v_cvt_pk_bf16_f32 v69, v58, v59
    v_exp_f32 v62, v62
    v_exp_f32 v63, v63
    v_cvt_pk_bf16_f32 v70, v60, v61
    v_cvt_pk_bf16_f32 v71, v62, v63
    s_waitcnt lgkmcnt(0)
    v_mfma_f32_32x32x16_bf16 v[48:63], v[104:107], v[12:15], 0
    ds_read_b128 v[108:111], v132 offset:13824
    ds_read_b32 v114, v133 offset:3456
    v_exp_f32 v32, v32
    v_exp_f32 v33, v33
    v_exp_f32 v34, v34
    v_exp_f32 v35, v35
    v_cvt_pk_bf16_f32 v64, v32, v33
    v_mfma_f32_32x32x16_bf16 v[88:103], v[128:131], v[68:71], v[88:103]
    v_exp_f32 v36, v36
    v_exp_f32 v37, v37
    v_cvt_pk_bf16_f32 v65, v34, v35
    v_exp_f32 v38, v38
    v_exp_f32 v39, v39
    v_cvt_pk_bf16_f32 v66, v36, v37
    v_mfma_f32_32x32x8_bf16 v[48:63], v[112:113], v[18:19], v[48:63]
    v_exp_f32 v40, v40
    v_exp_f32 v41, v41
    v_cvt_pk_bf16_f32 v67, v38, v39
    v_exp_f32 v42, v42
    v_exp_f32 v43, v43
    v_mfma_f32_32x32x16_bf16 v[72:87], v[116:119], v[64:67], v[72:87]
    v_cvt_pk_bf16_f32 v68, v40, v41
    v_exp_f32 v44, v44
    v_exp_f32 v45, v45
    v_cvt_pk_bf16_f32 v69, v42, v43
    v_exp_f32 v46, v46
    v_exp_f32 v47, v47
    v_cvt_pk_bf16_f32 v70, v44, v45
    v_cvt_pk_bf16_f32 v71, v46, v47
    s_waitcnt lgkmcnt(0)
    v_mfma_f32_32x32x16_bf16 v[32:47], v[108:111], v[8:11], 0
    ds_read_b64_tr_b16 v[124:125], v134 offset:34560
    ds_read_b64_tr_b16 v[126:127], v134 offset:34720
    ds_read_b64_tr_b16 v[128:129], v134 offset:35200
    ds_read_b64_tr_b16 v[130:131], v134 offset:35360
    v_exp_f32 v48, v48
    v_exp_f32 v49, v49
    v_exp_f32 v50, v50
    v_exp_f32 v51, v51
    v_cvt_pk_bf16_f32 v64, v48, v49
    v_mfma_f32_32x32x16_bf16 v[72:87], v[120:123], v[68:71], v[72:87]
    v_exp_f32 v52, v52
    v_exp_f32 v53, v53
    v_cvt_pk_bf16_f32 v65, v50, v51
    v_exp_f32 v54, v54
    v_exp_f32 v55, v55
    v_cvt_pk_bf16_f32 v66, v52, v53
    v_mfma_f32_32x32x8_bf16 v[32:47], v[114:115], v[16:17], v[32:47]
    v_exp_f32 v56, v56
    v_exp_f32 v57, v57
    v_cvt_pk_bf16_f32 v67, v54, v55
    v_exp_f32 v58, v58
    v_exp_f32 v59, v59
    v_mfma_f32_32x32x16_bf16 v[88:103], v[116:119], v[64:67], v[88:103]
    v_cvt_pk_bf16_f32 v68, v56, v57
    v_exp_f32 v60, v60
    v_exp_f32 v61, v61
    v_cvt_pk_bf16_f32 v69, v58, v59
    v_exp_f32 v62, v62
    v_exp_f32 v63, v63
    v_cvt_pk_bf16_f32 v70, v60, v61
    v_cvt_pk_bf16_f32 v71, v62, v63
    s_waitcnt lgkmcnt(0)
    v_mfma_f32_32x32x16_bf16 v[48:63], v[108:111], v[12:15], 0
    ds_read_b128 v[104:107], v132 offset:14336
    ds_read_b32 v112, v133 offset:3584
    v_exp_f32 v32, v32
    v_exp_f32 v33, v33
    v_exp_f32 v34, v34
    v_exp_f32 v35, v35
    v_cvt_pk_bf16_f32 v64, v32, v33
    v_mfma_f32_32x32x16_bf16 v[88:103], v[120:123], v[68:71], v[88:103]
    v_exp_f32 v36, v36
    v_exp_f32 v37, v37
    v_cvt_pk_bf16_f32 v65, v34, v35
    v_exp_f32 v38, v38
    v_exp_f32 v39, v39
    v_cvt_pk_bf16_f32 v66, v36, v37
    v_mfma_f32_32x32x8_bf16 v[48:63], v[114:115], v[18:19], v[48:63]
    v_exp_f32 v40, v40
    v_exp_f32 v41, v41
    v_cvt_pk_bf16_f32 v67, v38, v39
    v_exp_f32 v42, v42
    v_exp_f32 v43, v43
    v_mfma_f32_32x32x16_bf16 v[72:87], v[124:127], v[64:67], v[72:87]
    v_cvt_pk_bf16_f32 v68, v40, v41
    v_exp_f32 v44, v44
    v_exp_f32 v45, v45
    v_cvt_pk_bf16_f32 v69, v42, v43
    v_exp_f32 v46, v46
    v_exp_f32 v47, v47
    v_cvt_pk_bf16_f32 v70, v44, v45
    v_cvt_pk_bf16_f32 v71, v46, v47
    s_waitcnt lgkmcnt(0)
    v_mfma_f32_32x32x16_bf16 v[32:47], v[104:107], v[8:11], 0
    ds_read_b64_tr_b16 v[116:117], v134 offset:35840
    ds_read_b64_tr_b16 v[118:119], v134 offset:36000
    ds_read_b64_tr_b16 v[120:121], v134 offset:36480
    ds_read_b64_tr_b16 v[122:123], v134 offset:36640
    v_exp_f32 v48, v48
    v_exp_f32 v49, v49
    v_exp_f32 v50, v50
    v_exp_f32 v51, v51
    v_cvt_pk_bf16_f32 v64, v48, v49
    v_mfma_f32_32x32x16_bf16 v[72:87], v[128:131], v[68:71], v[72:87]
    v_exp_f32 v52, v52
    v_exp_f32 v53, v53
    v_cvt_pk_bf16_f32 v65, v50, v51
    v_exp_f32 v54, v54
    v_exp_f32 v55, v55
    v_cvt_pk_bf16_f32 v66, v52, v53
    v_mfma_f32_32x32x8_bf16 v[32:47], v[112:113], v[16:17], v[32:47]
    v_exp_f32 v56, v56
    v_exp_f32 v57, v57
    v_cvt_pk_bf16_f32 v67, v54, v55
    v_exp_f32 v58, v58
    v_exp_f32 v59, v59
    v_mfma_f32_32x32x16_bf16 v[88:103], v[124:127], v[64:67], v[88:103]
    v_cvt_pk_bf16_f32 v68, v56, v57
    v_exp_f32 v60, v60
    v_exp_f32 v61, v61
    v_cvt_pk_bf16_f32 v69, v58, v59
    v_exp_f32 v62, v62
    v_exp_f32 v63, v63
    v_cvt_pk_bf16_f32 v70, v60, v61
    v_cvt_pk_bf16_f32 v71, v62, v63
    s_waitcnt lgkmcnt(0)
    v_mfma_f32_32x32x16_bf16 v[48:63], v[104:107], v[12:15], 0
    ds_read_b128 v[108:111], v132 offset:14848
    ds_read_b32 v114, v133 offset:3712
    v_exp_f32 v32, v32
    v_exp_f32 v33, v33
    v_exp_f32 v34, v34
    v_exp_f32 v35, v35
    v_cvt_pk_bf16_f32 v64, v32, v33
    v_mfma_f32_32x32x16_bf16 v[88:103], v[128:131], v[68:71], v[88:103]
    v_exp_f32 v36, v36
    v_exp_f32 v37, v37
    v_cvt_pk_bf16_f32 v65, v34, v35
    v_exp_f32 v38, v38
    v_exp_f32 v39, v39
    v_cvt_pk_bf16_f32 v66, v36, v37
    v_mfma_f32_32x32x8_bf16 v[48:63], v[112:113], v[18:19], v[48:63]
    v_exp_f32 v40, v40
    v_exp_f32 v41, v41
    v_cvt_pk_bf16_f32 v67, v38, v39
    v_exp_f32 v42, v42
    v_exp_f32 v43, v43
    v_mfma_f32_32x32x16_bf16 v[72:87], v[116:119], v[64:67], v[72:87]
    v_cvt_pk_bf16_f32 v68, v40, v41
    v_exp_f32 v44, v44
    v_exp_f32 v45, v45
    v_cvt_pk_bf16_f32 v69, v42, v43
    v_exp_f32 v46, v46
    v_exp_f32 v47, v47
    v_cvt_pk_bf16_f32 v70, v44, v45
    v_cvt_pk_bf16_f32 v71, v46, v47
    s_waitcnt lgkmcnt(0)
    v_mfma_f32_32x32x16_bf16 v[32:47], v[108:111], v[8:11], 0
    ds_read_b64_tr_b16 v[124:125], v134 offset:37120
    ds_read_b64_tr_b16 v[126:127], v134 offset:37280
    ds_read_b64_tr_b16 v[128:129], v134 offset:37760
    ds_read_b64_tr_b16 v[130:131], v134 offset:37920
    v_exp_f32 v48, v48
    v_exp_f32 v49, v49
    v_exp_f32 v50, v50
    v_exp_f32 v51, v51
    v_cvt_pk_bf16_f32 v64, v48, v49
    v_mfma_f32_32x32x16_bf16 v[72:87], v[120:123], v[68:71], v[72:87]
    v_exp_f32 v52, v52
    v_exp_f32 v53, v53
    v_cvt_pk_bf16_f32 v65, v50, v51
    v_exp_f32 v54, v54
    v_exp_f32 v55, v55
    v_cvt_pk_bf16_f32 v66, v52, v53
    v_mfma_f32_32x32x8_bf16 v[32:47], v[114:115], v[16:17], v[32:47]
    v_exp_f32 v56, v56
    v_exp_f32 v57, v57
    v_cvt_pk_bf16_f32 v67, v54, v55
    v_exp_f32 v58, v58
    v_exp_f32 v59, v59
    v_mfma_f32_32x32x16_bf16 v[88:103], v[116:119], v[64:67], v[88:103]
    v_cvt_pk_bf16_f32 v68, v56, v57
    v_exp_f32 v60, v60
    v_exp_f32 v61, v61
    v_cvt_pk_bf16_f32 v69, v58, v59
    v_exp_f32 v62, v62
    v_exp_f32 v63, v63
    v_cvt_pk_bf16_f32 v70, v60, v61
    v_cvt_pk_bf16_f32 v71, v62, v63
    s_waitcnt lgkmcnt(0)
    v_mfma_f32_32x32x16_bf16 v[48:63], v[108:111], v[12:15], 0
    ds_read_b128 v[104:107], v132 offset:15360
    ds_read_b32 v112, v133 offset:3840
    v_exp_f32 v32, v32
    v_exp_f32 v33, v33
    v_exp_f32 v34, v34
    v_exp_f32 v35, v35
    v_cvt_pk_bf16_f32 v64, v32, v33
    v_mfma_f32_32x32x16_bf16 v[88:103], v[120:123], v[68:71], v[88:103]
    v_exp_f32 v36, v36
    v_exp_f32 v37, v37
    v_cvt_pk_bf16_f32 v65, v34, v35
    v_exp_f32 v38, v38
    v_exp_f32 v39, v39
    v_cvt_pk_bf16_f32 v66, v36, v37
    v_mfma_f32_32x32x8_bf16 v[48:63], v[114:115], v[18:19], v[48:63]
    v_exp_f32 v40, v40
    v_exp_f32 v41, v41
    v_cvt_pk_bf16_f32 v67, v38, v39
    v_exp_f32 v42, v42
    v_exp_f32 v43, v43
    v_mfma_f32_32x32x16_bf16 v[72:87], v[124:127], v[64:67], v[72:87]
    v_cvt_pk_bf16_f32 v68, v40, v41
    v_exp_f32 v44, v44
    v_exp_f32 v45, v45
    v_cvt_pk_bf16_f32 v69, v42, v43
    v_exp_f32 v46, v46
    v_exp_f32 v47, v47
    v_cvt_pk_bf16_f32 v70, v44, v45
    v_cvt_pk_bf16_f32 v71, v46, v47
    s_waitcnt lgkmcnt(0)
    v_mfma_f32_32x32x16_bf16 v[32:47], v[104:107], v[8:11], 0
    ds_read_b64_tr_b16 v[116:117], v134 offset:38400
    ds_read_b64_tr_b16 v[118:119], v134 offset:38560
    ds_read_b64_tr_b16 v[120:121], v134 offset:39040
    ds_read_b64_tr_b16 v[122:123], v134 offset:39200
    v_exp_f32 v48, v48
    v_exp_f32 v49, v49
    v_exp_f32 v50, v50
    v_exp_f32 v51, v51
    v_cvt_pk_bf16_f32 v64, v48, v49
    v_mfma_f32_32x32x16_bf16 v[72:87], v[128:131], v[68:71], v[72:87]
    v_exp_f32 v52, v52
    v_exp_f32 v53, v53
    v_cvt_pk_bf16_f32 v65, v50, v51
    v_exp_f32 v54, v54
    v_exp_f32 v55, v55
    v_cvt_pk_bf16_f32 v66, v52, v53
    v_mfma_f32_32x32x8_bf16 v[32:47], v[112:113], v[16:17], v[32:47]
    v_exp_f32 v56, v56
    v_exp_f32 v57, v57
    v_cvt_pk_bf16_f32 v67, v54, v55
    v_exp_f32 v58, v58
    v_exp_f32 v59, v59
    v_mfma_f32_32x32x16_bf16 v[88:103], v[124:127], v[64:67], v[88:103]
    v_cvt_pk_bf16_f32 v68, v56, v57
    v_exp_f32 v60, v60
    v_exp_f32 v61, v61
    v_cvt_pk_bf16_f32 v69, v58, v59
    v_exp_f32 v62, v62
    v_exp_f32 v63, v63
    v_cvt_pk_bf16_f32 v70, v60, v61
    v_cvt_pk_bf16_f32 v71, v62, v63
    s_waitcnt lgkmcnt(0)
    v_mfma_f32_32x32x16_bf16 v[48:63], v[104:107], v[12:15], 0
    ds_read_b128 v[108:111], v132 offset:15872
    ds_read_b32 v114, v133 offset:3968
    v_exp_f32 v32, v32
    v_exp_f32 v33, v33
    v_exp_f32 v34, v34
    v_exp_f32 v35, v35
    v_cvt_pk_bf16_f32 v64, v32, v33
    v_mfma_f32_32x32x16_bf16 v[88:103], v[128:131], v[68:71], v[88:103]
    v_exp_f32 v36, v36
    v_exp_f32 v37, v37
    v_cvt_pk_bf16_f32 v65, v34, v35
    v_exp_f32 v38, v38
    v_exp_f32 v39, v39
    v_cvt_pk_bf16_f32 v66, v36, v37
    v_mfma_f32_32x32x8_bf16 v[48:63], v[112:113], v[18:19], v[48:63]
    v_exp_f32 v40, v40
    v_exp_f32 v41, v41
    v_cvt_pk_bf16_f32 v67, v38, v39
    v_exp_f32 v42, v42
    v_exp_f32 v43, v43
    v_mfma_f32_32x32x16_bf16 v[72:87], v[116:119], v[64:67], v[72:87]
    v_cvt_pk_bf16_f32 v68, v40, v41
    v_exp_f32 v44, v44
    v_exp_f32 v45, v45
    v_cvt_pk_bf16_f32 v69, v42, v43
    v_exp_f32 v46, v46
    v_exp_f32 v47, v47
    v_cvt_pk_bf16_f32 v70, v44, v45
    v_cvt_pk_bf16_f32 v71, v46, v47
    s_waitcnt lgkmcnt(0)
    v_mfma_f32_32x32x16_bf16 v[32:47], v[108:111], v[8:11], 0
    ds_read_b64_tr_b16 v[124:125], v134 offset:39680
    ds_read_b64_tr_b16 v[126:127], v134 offset:39840
    ds_read_b64_tr_b16 v[128:129], v134 offset:40320
    ds_read_b64_tr_b16 v[130:131], v134 offset:40480
    v_exp_f32 v48, v48
    v_exp_f32 v49, v49
    v_exp_f32 v50, v50
    v_exp_f32 v51, v51
    v_cvt_pk_bf16_f32 v64, v48, v49
    v_mfma_f32_32x32x16_bf16 v[72:87], v[120:123], v[68:71], v[72:87]
    v_exp_f32 v52, v52
    v_exp_f32 v53, v53
    v_cvt_pk_bf16_f32 v65, v50, v51
    v_exp_f32 v54, v54
    v_exp_f32 v55, v55
    v_cvt_pk_bf16_f32 v66, v52, v53
    v_mfma_f32_32x32x8_bf16 v[32:47], v[114:115], v[16:17], v[32:47]
    v_exp_f32 v56, v56
    v_exp_f32 v57, v57
    v_cvt_pk_bf16_f32 v67, v54, v55
    v_exp_f32 v58, v58
    v_exp_f32 v59, v59
    v_mfma_f32_32x32x16_bf16 v[88:103], v[116:119], v[64:67], v[88:103]
    v_cvt_pk_bf16_f32 v68, v56, v57
    v_exp_f32 v60, v60
    v_exp_f32 v61, v61
    v_cvt_pk_bf16_f32 v69, v58, v59
    v_exp_f32 v62, v62
    v_exp_f32 v63, v63
    v_cvt_pk_bf16_f32 v70, v60, v61
    v_cvt_pk_bf16_f32 v71, v62, v63
    s_waitcnt lgkmcnt(0)
    v_mfma_f32_32x32x16_bf16 v[48:63], v[108:111], v[12:15], 0
    v_exp_f32 v32, v32
    v_exp_f32 v33, v33
    v_exp_f32 v34, v34
    v_exp_f32 v35, v35
    v_cvt_pk_bf16_f32 v64, v32, v33
    v_mfma_f32_32x32x16_bf16 v[88:103], v[120:123], v[68:71], v[88:103]
    v_exp_f32 v36, v36
    v_exp_f32 v37, v37
    v_cvt_pk_bf16_f32 v65, v34, v35
    v_exp_f32 v38, v38
    v_exp_f32 v39, v39
    v_cvt_pk_bf16_f32 v66, v36, v37
    v_mfma_f32_32x32x8_bf16 v[48:63], v[114:115], v[18:19], v[48:63]
    v_exp_f32 v40, v40
    v_exp_f32 v41, v41
    v_cvt_pk_bf16_f32 v67, v38, v39
    v_exp_f32 v42, v42
    v_exp_f32 v43, v43
    v_mfma_f32_32x32x16_bf16 v[72:87], v[124:127], v[64:67], v[72:87]
    v_cvt_pk_bf16_f32 v68, v40, v41
    v_exp_f32 v44, v44
    v_exp_f32 v45, v45
    v_cvt_pk_bf16_f32 v69, v42, v43
    v_exp_f32 v46, v46
    v_exp_f32 v47, v47
    v_cvt_pk_bf16_f32 v70, v44, v45
    v_cvt_pk_bf16_f32 v71, v46, v47
    s_waitcnt lgkmcnt(0)
    v_exp_f32 v48, v48
    v_exp_f32 v49, v49
    v_exp_f32 v50, v50
    v_exp_f32 v51, v51
    v_cvt_pk_bf16_f32 v64, v48, v49
    v_mfma_f32_32x32x16_bf16 v[72:87], v[128:131], v[68:71], v[72:87]
    v_exp_f32 v52, v52
    v_exp_f32 v53, v53
    v_cvt_pk_bf16_f32 v65, v50, v51
    v_exp_f32 v54, v54
    v_exp_f32 v55, v55
    v_cvt_pk_bf16_f32 v66, v52, v53
    v_exp_f32 v56, v56
    v_exp_f32 v57, v57
    v_cvt_pk_bf16_f32 v67, v54, v55
    v_exp_f32 v58, v58
    v_exp_f32 v59, v59
    v_mfma_f32_32x32x16_bf16 v[88:103], v[124:127], v[64:67], v[88:103]
    v_cvt_pk_bf16_f32 v68, v56, v57
    v_exp_f32 v60, v60
    v_exp_f32 v61, v61
    v_cvt_pk_bf16_f32 v69, v58, v59
    v_exp_f32 v62, v62
    v_exp_f32 v63, v63
    v_cvt_pk_bf16_f32 v70, v60, v61
    v_cvt_pk_bf16_f32 v71, v62, v63
    s_nop 1
    v_mfma_f32_32x32x16_bf16 v[88:103], v[128:131], v[68:71], v[88:103]
L_after_200003:
    s_setprio 0
    v_mov_b32 v12, 73804
    v_mov_b32 v13, 0x10000
    s_mov_b64 exec, 1
    ds_add_u32 v12, v13
    s_mov_b64 exec, -1

    v_mov_b32 v12, 73804
L_sw_200006:
    ds_read_b32 v13, v12
    s_waitcnt lgkmcnt(0)
    v_readfirstlane_b32 s49, v13
    s_sleep 0
    s_cmp_lt_u32 s49, 524288
    s_cbranch_scc1 L_sw_200006

    s_lshl_b32 s35, s24, 12
    v_add_u32 v20, s35, v5
    s_xor_b32 s36, s24, 4
    s_lshl_b32 s36, s36, 12
    v_add_u32 v21, s36, v5
    s_nop 7
    s_cmp_eq_u32 s32, 0

    s_cbranch_scc0 L_kh1_200007
    v_mov_b32 v100, v23
    ds_write_b128 v20, v[88:91] offset:0
    ds_write_b128 v20, v[92:95] offset:1024
    ds_write_b128 v20, v[96:99] offset:2048
    ds_write_b128 v20, v[100:103] offset:3072
    s_waitcnt lgkmcnt(0)
    v_mov_b32 v12, 73844
    v_mov_b32 v13, 0x10000
    s_mov_b64 exec, 1
    ds_add_u32 v12, v13
    s_mov_b64 exec, -1

    v_mov_b32 v12, 73844
L_sw_200009:
    ds_read_b32 v13, v12
    s_waitcnt lgkmcnt(0)
    v_readfirstlane_b32 s49, v13
    s_sleep 0
    s_cmp_lt_u32 s49, 524288
    s_cbranch_scc1 L_sw_200009

    ds_read_b128 v[32:35], v21 offset:0
    ds_read_b128 v[36:39], v21 offset:1024
    ds_read_b128 v[40:43], v21 offset:2048
    ds_read_b128 v[44:47], v21 offset:3072
    s_waitcnt lgkmcnt(0)
    v_max_f32 v24, v22, v44
    v_sub_f32 v25, v22, v24
    v_sub_f32 v26, v44, v24
    v_exp_f32 v25, v25
    v_exp_f32 v26, v26
    s_nop 0

    v_mul_f32 v48, v25, v72
    v_mul_f32 v49, v25, v73
    v_mul_f32 v50, v25, v74
    v_mul_f32 v51, v25, v75
    v_mul_f32 v52, v25, v76
    v_mul_f32 v53, v25, v77
    v_mul_f32 v54, v25, v78
    v_mul_f32 v55, v25, v79
    v_mul_f32 v56, v25, v80
    v_mul_f32 v57, v25, v81
    v_mul_f32 v58, v25, v82
    v_mul_f32 v59, v25, v83
    v_fmac_f32 v48, v26, v32
    v_fmac_f32 v49, v26, v33
    v_fmac_f32 v50, v26, v34
    v_fmac_f32 v51, v26, v35
    v_fmac_f32 v52, v26, v36
    v_fmac_f32 v53, v26, v37
    v_fmac_f32 v54, v26, v38
    v_fmac_f32 v55, v26, v39
    v_fmac_f32 v56, v26, v40
    v_fmac_f32 v57, v26, v41
    v_fmac_f32 v58, v26, v42
    v_fmac_f32 v59, v26, v43
    s_branch L_join_200008
L_kh1_200007:
    v_mov_b32 v84, v22
    ds_write_b128 v20, v[72:75] offset:0
    ds_write_b128 v20, v[76:79] offset:1024
    ds_write_b128 v20, v[80:83] offset:2048
    ds_write_b128 v20, v[84:87] offset:3072
    s_waitcnt lgkmcnt(0)
    v_mov_b32 v12, 73844
    v_mov_b32 v13, 0x10000
    s_mov_b64 exec, 1
    ds_add_u32 v12, v13
    s_mov_b64 exec, -1

    v_mov_b32 v12, 73844
L_sw_200010:
    ds_read_b32 v13, v12
    s_waitcnt lgkmcnt(0)
    v_readfirstlane_b32 s49, v13
    s_sleep 0
    s_cmp_lt_u32 s49, 524288
    s_cbranch_scc1 L_sw_200010

    ds_read_b128 v[32:35], v21 offset:0
    ds_read_b128 v[36:39], v21 offset:1024
    ds_read_b128 v[40:43], v21 offset:2048
    ds_read_b128 v[44:47], v21 offset:3072
    s_waitcnt lgkmcnt(0)
    v_max_f32 v24, v23, v44
    v_sub_f32 v25, v23, v24
    v_sub_f32 v26, v44, v24
    v_exp_f32 v25, v25
    v_exp_f32 v26, v26
    s_nop 0

    v_mul_f32 v48, v25, v88
    v_mul_f32 v49, v25, v89
    v_mul_f32 v50, v25, v90
    v_mul_f32 v51, v25, v91
    v_mul_f32 v52, v25, v92
    v_mul_f32 v53, v25, v93
    v_mul_f32 v54, v25, v94
    v_mul_f32 v55, v25, v95
    v_mul_f32 v56, v25, v96
    v_mul_f32 v57, v25, v97
    v_mul_f32 v58, v25, v98
    v_mul_f32 v59, v25, v99
    v_fmac_f32 v48, v26, v32
    v_fmac_f32 v49, v26, v33
    v_fmac_f32 v50, v26, v34
    v_fmac_f32 v51, v26, v35
    v_fmac_f32 v52, v26, v36
    v_fmac_f32 v53, v26, v37
    v_fmac_f32 v54, v26, v38
    v_fmac_f32 v55, v26, v39
    v_fmac_f32 v56, v26, v40
    v_fmac_f32 v57, v26, v41
    v_fmac_f32 v58, v26, v42
    v_fmac_f32 v59, v26, v43
L_join_200008:
    v_mov_b32 v16, v58
    v_mov_b32 v17, v58
    s_nop 1
    v_permlane32_swap_b32 v16, v17
    s_nop 1
    v_rcp_f32 v16, v16
    s_nop 0

    v_mul_f32 v48, v16, v48
    v_mul_f32 v49, v16, v49
    v_mul_f32 v50, v16, v50
    v_mul_f32 v51, v16, v51
    v_mul_f32 v52, v16, v52
    v_mul_f32 v53, v16, v53
    v_mul_f32 v54, v16, v54
    v_mul_f32 v55, v16, v55
    v_mul_f32 v56, v16, v56
    v_mul_f32 v57, v16, v57
    v_cvt_pk_bf16_f32 v64, v48, v49
    v_cvt_pk_bf16_f32 v65, v50, v51
    v_cvt_pk_bf16_f32 v66, v52, v53
    v_cvt_pk_bf16_f32 v67, v54, v55
    v_cvt_pk_bf16_f32 v68, v56, v57
    s_lshl_b32 s35, s28, 3
    s_lshl_b32 s36, s31, 1
    s_add_u32 s35, s35, s36
    s_add_u32 s35, s35, s32
    s_mul_i32 s35, s35, 36864
    s_add_u32 s35, s35, 7471104
    s_lshl_b32 s36, s27, 10
    s_add_u32 s36, s36, s35
    s_lshl_b32 s37, s27, 7
    s_add_u32 s37, s37, s35
    s_add_u32 s37, s37, 32768
    buffer_store_dwordx4 v[64:67], v5, s[20:23], s36 offen sc1
    s_mov_b64 exec, s[62:63]
    buffer_store_dword v68, v6, s[20:23], s37 offen sc1
    s_mov_b64 exec, -1
    s_waitcnt vmcnt(0)

    s_branch L_k2_kernel_post2
L_slow_200002:
    s_cmp_lg_u32 s24, 4
    s_cbranch_scc1 L_ssig_200011
    v_mov_b32 v20, 73764
    v_mov_b32 v21, 0x1000000
    s_mov_b64 exec, 1
    ds_add_u32 v20, v21
    s_mov_b64 exec, -1

L_ssig_200011:
    v_mov_b32 v20, 73764
L_spoll_200012:
    ds_read_b32 v21, v20
    s_waitcnt lgkmcnt(0)
    v_readfirstlane_b32 s66, v21
    s_nop 3
    s_bfe_u32 s66, s66, 0x40010
    s_cmp_lt_u32 s66, 4
    s_cbranch_scc1 L_spoll_200012
    v_mov_b32 v22, 0xff800000
    v_mov_b32 v23, 0xff800000
    v_mov_b32 v135, v132
    v_mov_b32 v136, v133
    s_mov_b32 s67, 0

L_p1_200013:
    ds_read_b128 v[104:107], v135
    ds_read_b32 v112, v136
    v_add_u32 v135, 512, v135
    v_add_u32 v136, 128, v136
    s_waitcnt lgkmcnt(0)

    v_mfma_f32_32x32x16_bf16 v[32:47], v[104:107], v[8:11], 0
    v_mfma_f32_32x32x8_bf16 v[32:47], v[112:113], v[16:17], v[32:47]
    v_mfma_f32_32x32x16_bf16 v[48:63], v[104:107], v[12:15], 0
    v_mfma_f32_32x32x8_bf16 v[48:63], v[112:113], v[18:19], v[48:63]
    s_nop 7
    s_nop 7
    v_max3_f32 v22, v32, v33, v22
    v_max3_f32 v22, v34, v35, v22
    v_max3_f32 v22, v36, v37, v22
    v_max3_f32 v22, v38, v39, v22
    v_max3_f32 v22, v40, v41, v22
    v_max3_f32 v22, v42, v43, v22
    v_max3_f32 v22, v44, v45, v22
    v_max3_f32 v22, v46, v47, v22
    v_max3_f32 v23, v48, v49, v23
    v_max3_f32 v23, v50, v51, v23
    v_max3_f32 v23, v52, v53, v23
    v_max3_f32 v23, v54, v55, v23
    v_max3_f32 v23, v56, v57, v23
    v_max3_f32 v23, v58, v59, v23
    v_max3_f32 v23, v60, v61, v23
    v_max3_f32 v23, v62, v63, v23
    s_add_u32 s67, s67, 1
    s_cmp_lt_u32 s67, 32
    s_cbranch_scc1 L_p1_200013

    v_mov_b32 v24, v22
    v_mov_b32 v25, v22
    s_nop 1
    v_permlane32_swap_b32 v24, v25
    s_nop 1
    v_max_f32 v22, v24, v25

    v_mov_b32 v24, v23
    v_mov_b32 v25, v23
    s_nop 1
    v_permlane32_swap_b32 v24, v25
    s_nop 1
    v_max_f32 v23, v24, v25

    v_mov_b32 v135, v132
    v_mov_b32 v136, v133
    v_mov_b32 v137, v134
    s_mov_b32 s67, 0

L_p2_200014:
    ds_read_b128 v[104:107], v135
    ds_read_b32 v112, v136

    ds_read_b64_tr_b16 v[116:117], v137 offset:0
    ds_read_b64_tr_b16 v[118:119], v137 offset:160
    ds_read_b64_tr_b16 v[120:121], v137 offset:640
    ds_read_b64_tr_b16 v[122:123], v137 offset:800
    v_add_u32 v135, 512, v135
    v_add_u32 v136, 128, v136
    v_add_u32 v137, 1280, v137
    s_waitcnt lgkmcnt(0)

    v_mfma_f32_32x32x16_bf16 v[32:47], v[104:107], v[8:11], 0
    v_mfma_f32_32x32x8_bf16 v[32:47], v[112:113], v[16:17], v[32:47]
    v_mfma_f32_32x32x16_bf16 v[48:63], v[104:107], v[12:15], 0
    v_mfma_f32_32x32x8_bf16 v[48:63], v[112:113], v[18:19], v[48:63]
    s_nop 7
    s_nop 7
    v_sub_f32 v32, v32, v22
    v_sub_f32 v33, v33, v22
    v_sub_f32 v34, v34, v22
    v_sub_f32 v35, v35, v22
    v_sub_f32 v36, v36, v22
    v_sub_f32 v37, v37, v22
    v_sub_f32 v38, v38, v22
    v_sub_f32 v39, v39, v22
    v_sub_f32 v40, v40, v22
    v_sub_f32 v41, v41, v22
    v_sub_f32 v42, v42, v22
    v_sub_f32 v43, v43, v22
    v_sub_f32 v44, v44, v22
    v_sub_f32 v45, v45, v22
    v_sub_f32 v46, v46, v22
    v_sub_f32 v47, v47, v22
    v_exp_f32 v32, v32
    v_exp_f32 v33, v33
    v_exp_f32 v34, v34
    v_exp_f32 v35, v35
    v_exp_f32 v36, v36
    v_exp_f32 v37, v37
    v_exp_f32 v38, v38
    v_exp_f32 v39, v39
    v_exp_f32 v40, v40
    v_exp_f32 v41, v41
    v_exp_f32 v42, v42
    v_exp_f32 v43, v43
    v_exp_f32 v44, v44
    v_exp_f32 v45, v45
    v_exp_f32 v46, v46
    v_exp_f32 v47, v47
    s_nop 0
    v_cvt_pk_bf16_f32 v64, v32, v33
    v_cvt_pk_bf16_f32 v65, v34, v35
    v_cvt_pk_bf16_f32 v66, v36, v37
    v_cvt_pk_bf16_f32 v67, v38, v39
    v_cvt_pk_bf16_f32 v68, v40, v41
    v_cvt_pk_bf16_f32 v69, v42, v43
    v_cvt_pk_bf16_f32 v70, v44, v45
    v_cvt_pk_bf16_f32 v71, v46, v47
    s_nop 1
    v_mfma_f32_32x32x16_bf16 v[72:87], v[116:119], v[64:67], v[72:87]
    v_mfma_f32_32x32x16_bf16 v[72:87], v[120:123], v[68:71], v[72:87]
    s_nop 1
    v_sub_f32 v48, v48, v23
    v_sub_f32 v49, v49, v23
    v_sub_f32 v50, v50, v23
    v_sub_f32 v51, v51, v23
    v_sub_f32 v52, v52, v23
    v_sub_f32 v53, v53, v23
    v_sub_f32 v54, v54, v23
    v_sub_f32 v55, v55, v23
    v_sub_f32 v56, v56, v23
    v_sub_f32 v57, v57, v23
    v_sub_f32 v58, v58, v23
    v_sub_f32 v59, v59, v23
    v_sub_f32 v60, v60, v23
    v_sub_f32 v61, v61, v23
    v_sub_f32 v62, v62, v23
    v_sub_f32 v63, v63, v23
    v_exp_f32 v48, v48
    v_exp_f32 v49, v49
    v_exp_f32 v50, v50
    v_exp_f32 v51, v51
    v_exp_f32 v52, v52
    v_exp_f32 v53, v53
    v_exp_f32 v54, v54
    v_exp_f32 v55, v55
    v_exp_f32 v56, v56
    v_exp_f32 v57, v57
    v_exp_f32 v58, v58
    v_exp_f32 v59, v59
    v_exp_f32 v60, v60
    v_exp_f32 v61, v61
    v_exp_f32 v62, v62
    v_exp_f32 v63, v63
    s_nop 0
    v_cvt_pk_bf16_f32 v64, v48, v49
    v_cvt_pk_bf16_f32 v65, v50, v51
    v_cvt_pk_bf16_f32 v66, v52, v53
    v_cvt_pk_bf16_f32 v67, v54, v55
    v_cvt_pk_bf16_f32 v68, v56, v57
    v_cvt_pk_bf16_f32 v69, v58, v59
    v_cvt_pk_bf16_f32 v70, v60, v61
    v_cvt_pk_bf16_f32 v71, v62, v63
    s_nop 1
    v_mfma_f32_32x32x16_bf16 v[88:103], v[116:119], v[64:67], v[88:103]
    v_mfma_f32_32x32x16_bf16 v[88:103], v[120:123], v[68:71], v[88:103]
    s_nop 1
    s_add_u32 s67, s67, 1
    s_cmp_lt_u32 s67, 32
    s_cbranch_scc1 L_p2_200014
    s_branch L_after_200003

L_conv_200001:
    s_sub_u32 s40, s24, 8
    s_lshr_b32 s41, s40, 1
    s_and_b32 s42, s40, 1
    s_barrier
    s_setprio 3

    s_lshl_b32 s45, s41, 14
    s_mul_i32 s46, s42, 6144
    s_add_u32 s45, s45, s46
    s_add_u32 s43, s45, 4096

    s_mov_b32 m0, s43
    s_add_u32 s44, s43, s30
    buffer_load_dwordx4 v5, s[20:23], s44 offen lds
    s_add_u32 s43, s43, 1024
    s_mov_b32 m0, s43
    s_add_u32 s44, s43, s30
    buffer_load_dwordx4 v5, s[20:23], s44 offen lds
    s_add_u32 s43, s43, 1024
    s_mov_b32 m0, s43
    s_add_u32 s44, s43, s30
    buffer_load_dwordx4 v5, s[20:23], s44 offen lds
    s_add_u32 s43, s43, 1024
    s_mov_b32 m0, s43
    s_add_u32 s44, s43, s30
    buffer_load_dwordx4 v5, s[20:23], s44 offen lds
    s_add_u32 s43, s43, 1024
    s_mov_b32 m0, s43
    s_add_u32 s44, s43, s30
    buffer_load_dwordx4 v5, s[20:23], s44 offen lds
    s_add_u32 s43, s43, 1024
    s_mov_b32 m0, s43
    s_add_u32 s44, s43, s30
    buffer_load_dwordx4 v5, s[20:23], s44 offen lds
    s_add_u32 s43, s43, 1024
    s_add_u32 s43, s45, 36864
    s_mov_b32 m0, s43
    s_add_u32 s44, s43, s30
    buffer_load_dwordx4 v5, s[20:23], s44 offen lds
    s_add_u32 s43, s43, 1024
    s_mov_b32 m0, s43
    s_add_u32 s44, s43, s30
    buffer_load_dwordx4 v5, s[20:23], s44 offen lds
    s_add_u32 s43, s43, 1024
    s_mov_b32 m0, s43
    s_add_u32 s44, s43, s30
    buffer_load_dwordx4 v5, s[20:23], s44 offen lds
    s_add_u32 s43, s43, 1024
    s_mov_b32 m0, s43
    s_add_u32 s44, s43, s30
    buffer_load_dwordx4 v5, s[20:23], s44 offen lds
    s_add_u32 s43, s43, 1024
    s_mov_b32 m0, s43
    s_add_u32 s44, s43, s30
    buffer_load_dwordx4 v5, s[20:23], s44 offen lds
    s_add_u32 s43, s43, 1024
    s_mov_b32 m0, s43
    s_add_u32 s44, s43, s30
    buffer_load_dwordx4 v5, s[20:23], s44 offen lds
    s_add_u32 s43, s43, 1024
    s_mul_i32 s43, s41, 40960
    s_mul_i32 s46, s42, 15360
    s_add_u32 s43, s43, s46
    s_add_u32 s43, s43, 83968

    s_mov_b32 m0, s43
    s_add_u32 s44, s43, s30
    buffer_load_dwordx4 v5, s[20:23], s44 offen lds
    s_add_u32 s43, s43, 1024
    s_mov_b32 m0, s43
    s_add_u32 s44, s43, s30
    buffer_load_dwordx4 v5, s[20:23], s44 offen lds
    s_add_u32 s43, s43, 1024
    s_mov_b32 m0, s43
    s_add_u32 s44, s43, s30
    buffer_load_dwordx4 v5, s[20:23], s44 offen lds
    s_add_u32 s43, s43, 1024
    s_mov_b32 m0, s43
    s_add_u32 s44, s43, s30
    buffer_load_dwordx4 v5, s[20:23], s44 offen lds
    s_add_u32 s43, s43, 1024
    s_mov_b32 m0, s43
    s_add_u32 s44, s43, s30
    buffer_load_dwordx4 v5, s[20:23], s44 offen lds
    s_add_u32 s43, s43, 1024
    s_mov_b32 m0, s43
    s_add_u32 s44, s43, s30
    buffer_load_dwordx4 v5, s[20:23], s44 offen lds
    s_add_u32 s43, s43, 1024
    s_mov_b32 m0, s43
    s_add_u32 s44, s43, s30
    buffer_load_dwordx4 v5, s[20:23], s44 offen lds
    s_add_u32 s43, s43, 1024
    s_mov_b32 m0, s43
    s_add_u32 s44, s43, s30
    buffer_load_dwordx4 v5, s[20:23], s44 offen lds
    s_add_u32 s43, s43, 1024
    s_mov_b32 m0, s43
    s_add_u32 s44, s43, s30
    buffer_load_dwordx4 v5, s[20:23], s44 offen lds
    s_add_u32 s43, s43, 1024
    s_mov_b32 m0, s43
    s_add_u32 s44, s43, s30
    buffer_load_dwordx4 v5, s[20:23], s44 offen lds
    s_add_u32 s43, s43, 1024
    s_mov_b32 m0, s43
    s_add_u32 s44, s43, s30
    buffer_load_dwordx4 v5, s[20:23], s44 offen lds
    s_add_u32 s43, s43, 1024
    s_mov_b32 m0, s43
    s_add_u32 s44, s43, s30
    buffer_load_dwordx4 v5, s[20:23], s44 offen lds
    s_add_u32 s43, s43, 1024
    s_mov_b32 m0, s43
    s_add_u32 s44, s43, s30
    buffer_load_dwordx4 v5, s[20:23], s44 offen lds
    s_add_u32 s43, s43, 1024
    s_mov_b32 m0, s43
    s_add_u32 s44, s43, s30
    buffer_load_dwordx4 v5, s[20:23], s44 offen lds
    s_add_u32 s43, s43, 1024
    s_mov_b32 m0, s43
    s_add_u32 s44, s43, s30
    buffer_load_dwordx4 v5, s[20:23], s44 offen lds
    s_add_u32 s43, s43, 1024
    s_lshl_b32 s43, s41, 12
    s_lshl_b32 s46, s42, 11
    s_add_u32 s43, s43, s46
    s_add_u32 s43, s43, 66560

    s_mov_b32 m0, s43
    s_add_u32 s44, s43, s30
    buffer_load_dwordx4 v5, s[20:23], s44 offen lds
    s_add_u32 s43, s43, 1024
    s_cmp_eq_u32 s42, 1
    s_cbranch_scc1 L_k2skip_200015
    s_mov_b32 m0, s43
    s_add_u32 s44, s43, s30
    buffer_load_dwordx4 v5, s[20:23], s44 offen lds
    s_add_u32 s43, s43, 1024
L_k2skip_200015:
    s_lshl_b32 s46, s40, 8
    s_add_u32 s46, s46, s2

    s_cmp_lt_u32 s46, 576
    s_cbranch_scc1 L_tB_200016
    s_sub_u32 s46, s46, 576
    s_cmp_lt_u32 s46, 288
    s_cbranch_scc1 L_tAA_200017
    s_branch L_tnone_200019

L_tB_200016:
    s_mov_b32 s47, s46
    s_mov_b32 s48, s46
    s_mov_b32 s50, 0

    s_branch L_tgo_200018
L_tAA_200017:
    s_lshl_b32 s47, s46, 1
    s_add_u32 s48, s47, 1
    s_mov_b32 s50, 1

L_tgo_200018:
    v_and_b32 v3, 31, v2
    v_lshrrev_b32 v4, 5, v2
    v_and_b32 v6, 15, v3
    v_lshlrev_b32 v6, 1, v6
    v_lshrrev_b32 v7, 4, v3
    v_add_u32 v6, v6, v7
    v_lshlrev_b32 v8, 3, v4
    v_sub_u32 v8, v8, v6
    v_add_u32 v8, 2047, v8
    v_lshlrev_b32 v8, 1, v8
    v_add_u32 v9, 4158, v8
    v_cmp_eq_u32 vcc, 0, v7
    v_mul_u32_u24 v11, 1536, v4
    v_lshlrev_b32 v12, 4, v3
    v_add_u32 v11, v11, v12
    v_add_u32 v11, 512, v11
    v_cndmask_b32 v10, v8, v9, vcc

    s_mov_b32 s12, s4
    s_mov_b32 s13, s5
    s_mov_b32 s14, 1152
    s_mov_b32 s15, 0x20000
    s_waitcnt vmcnt(0)
    v_mov_b32 v12, 73764
    v_mov_b32 v13, 0x10000
    s_mov_b64 exec, 1
    ds_add_u32 v12, v13
    s_mov_b64 exec, -1

    v_mov_b32 v16, 0
    v_mov_b32 v17, 0
    v_mov_b32 v18, 0
    v_mov_b32 v19, 0
    v_mov_b32 v20, 0
    v_mov_b32 v21, 0
    v_mov_b32 v22, 0
    v_mov_b32 v23, 0
    v_mov_b32 v24, 0
    v_mov_b32 v25, 0
    v_mov_b32 v26, 0
    v_mov_b32 v27, 0
    v_mov_b32 v28, 0
    v_mov_b32 v29, 0
    v_mov_b32 v30, 0
    v_mov_b32 v31, 0
    s_mov_b32 s58, 62
    s_cmp_eq_u32 s50, 0
    s_cselect_b32 s59, 32, 0
    s_mul_i32 s52, s47, 8320
    s_add_u32 s52, s52, 16777216
    s_lshl_b32 s54, s58, 5
    s_sub_u32 s52, s52, s54
    s_mul_i32 s53, s47, 6144
    s_add_u32 s53, s53, 23068672
    s_lshr_b32 s54, s58, 1
    s_sub_u32 s54, s59, s54
    s_lshl_b32 s54, s54, 4
    s_add_u32 s53, s53, s54

    buffer_load_dwordx4 v[32:35], v10, s[20:23], s52 offen offset:0
    buffer_load_dwordx4 v[64:67], v11, s[20:23], s53 offen offset:0
    buffer_load_dwordx4 v[36:39], v10, s[20:23], s52 offen offset:32
    buffer_load_dwordx4 v[68:71], v11, s[20:23], s53 offen offset:3072
    buffer_load_dwordx4 v[40:43], v10, s[20:23], s52 offen offset:64
    buffer_load_dwordx4 v[72:75], v11, s[20:23], s53 offen offset:16
    buffer_load_dwordx4 v[44:47], v10, s[20:23], s52 offen offset:96
    buffer_load_dwordx4 v[76:79], v11, s[20:23], s53 offen offset:3088
    buffer_load_dwordx4 v[48:51], v10, s[20:23], s52 offen offset:128
    buffer_load_dwordx4 v[80:83], v11, s[20:23], s53 offen offset:32
    buffer_load_dwordx4 v[52:55], v10, s[20:23], s52 offen offset:160
    buffer_load_dwordx4 v[84:87], v11, s[20:23], s53 offen offset:3104
    buffer_load_dwordx4 v[56:59], v10, s[20:23], s52 offen offset:192
    buffer_load_dwordx4 v[88:91], v11, s[20:23], s53 offen offset:48
    buffer_load_dwordx4 v[60:63], v10, s[20:23], s52 offen offset:224
    buffer_load_dwordx4 v[92:95], v11, s[20:23], s53 offen offset:3120
    s_waitcnt vmcnt(14)
    v_mfma_f32_32x32x16_bf16 v[16:31], v[32:35], v[64:67], v[16:31]
    buffer_load_dwordx4 v[32:35], v10, s[20:23], s52 offen offset:256
    buffer_load_dwordx4 v[64:67], v11, s[20:23], s53 offen offset:64
    s_waitcnt vmcnt(14)
    v_mfma_f32_32x32x16_bf16 v[16:31], v[36:39], v[68:71], v[16:31]
    buffer_load_dwordx4 v[36:39], v10, s[20:23], s52 offen offset:288
    buffer_load_dwordx4 v[68:71], v11, s[20:23], s53 offen offset:3136
    s_waitcnt vmcnt(14)
    v_mfma_f32_32x32x16_bf16 v[16:31], v[40:43], v[72:75], v[16:31]
    buffer_load_dwordx4 v[40:43], v10, s[20:23], s52 offen offset:320
    buffer_load_dwordx4 v[72:75], v11, s[20:23], s53 offen offset:80
    s_waitcnt vmcnt(14)
    v_mfma_f32_32x32x16_bf16 v[16:31], v[44:47], v[76:79], v[16:31]
    buffer_load_dwordx4 v[44:47], v10, s[20:23], s52 offen offset:352
    buffer_load_dwordx4 v[76:79], v11, s[20:23], s53 offen offset:3152
    s_waitcnt vmcnt(14)
    v_mfma_f32_32x32x16_bf16 v[16:31], v[48:51], v[80:83], v[16:31]
    buffer_load_dwordx4 v[48:51], v10, s[20:23], s52 offen offset:384
    buffer_load_dwordx4 v[80:83], v11, s[20:23], s53 offen offset:96
    s_waitcnt vmcnt(14)
    v_mfma_f32_32x32x16_bf16 v[16:31], v[52:55], v[84:87], v[16:31]
    buffer_load_dwordx4 v[52:55], v10, s[20:23], s52 offen offset:416
    buffer_load_dwordx4 v[84:87], v11, s[20:23], s53 offen offset:3168
    s_waitcnt vmcnt(14)
    v_mfma_f32_32x32x16_bf16 v[16:31], v[56:59], v[88:91], v[16:31]
    buffer_load_dwordx4 v[56:59], v10, s[20:23], s52 offen offset:448
    buffer_load_dwordx4 v[88:91], v11, s[20:23], s53 offen offset:112
    s_waitcnt vmcnt(14)
    v_mfma_f32_32x32x16_bf16 v[16:31], v[60:63], v[92:95], v[16:31]
    buffer_load_dwordx4 v[60:63], v10, s[20:23], s52 offen offset:480
    buffer_load_dwordx4 v[92:95], v11, s[20:23], s53 offen offset:3184
    s_waitcnt vmcnt(14)
    v_mfma_f32_32x32x16_bf16 v[16:31], v[32:35], v[64:67], v[16:31]
    buffer_load_dwordx4 v[32:35], v10, s[20:23], s52 offen offset:512
    buffer_load_dwordx4 v[64:67], v11, s[20:23], s53 offen offset:128
    s_waitcnt vmcnt(14)
    v_mfma_f32_32x32x16_bf16 v[16:31], v[36:39], v[68:71], v[16:31]
    buffer_load_dwordx4 v[36:39], v10, s[20:23], s52 offen offset:544
    buffer_load_dwordx4 v[68:71], v11, s[20:23], s53 offen offset:3200
    s_waitcnt vmcnt(14)
    v_mfma_f32_32x32x16_bf16 v[16:31], v[40:43], v[72:75], v[16:31]
    buffer_load_dwordx4 v[40:43], v10, s[20:23], s52 offen offset:576
    buffer_load_dwordx4 v[72:75], v11, s[20:23], s53 offen offset:144
    s_waitcnt vmcnt(14)
    v_mfma_f32_32x32x16_bf16 v[16:31], v[44:47], v[76:79], v[16:31]
    buffer_load_dwordx4 v[44:47], v10, s[20:23], s52 offen offset:608
    buffer_load_dwordx4 v[76:79], v11, s[20:23], s53 offen offset:3216
    s_waitcnt vmcnt(14)
    v_mfma_f32_32x32x16_bf16 v[16:31], v[48:51], v[80:83], v[16:31]
    buffer_load_dwordx4 v[48:51], v10, s[20:23], s52 offen offset:640
    buffer_load_dwordx4 v[80:83], v11, s[20:23], s53 offen offset:160
    s_waitcnt vmcnt(14)
    v_mfma_f32_32x32x16_bf16 v[16:31], v[52:55], v[84:87], v[16:31]
    buffer_load_dwordx4 v[52:55], v10, s[20:23], s52 offen offset:672
    buffer_load_dwordx4 v[84:87], v11, s[20:23], s53 offen offset:3232
    s_waitcnt vmcnt(14)
    v_mfma_f32_32x32x16_bf16 v[16:31], v[56:59], v[88:91], v[16:31]
    buffer_load_dwordx4 v[56:59], v10, s[20:23], s52 offen offset:704
    buffer_load_dwordx4 v[88:91], v11, s[20:23], s53 offen offset:176
    s_waitcnt vmcnt(14)
    v_mfma_f32_32x32x16_bf16 v[16:31], v[60:63], v[92:95], v[16:31]
    buffer_load_dwordx4 v[60:63], v10, s[20:23], s52 offen offset:736
    buffer_load_dwordx4 v[92:95], v11, s[20:23], s53 offen offset:3248
    s_waitcnt vmcnt(14)
    v_mfma_f32_32x32x16_bf16 v[16:31], v[32:35], v[64:67], v[16:31]
    buffer_load_dwordx4 v[32:35], v10, s[20:23], s52 offen offset:768
    buffer_load_dwordx4 v[64:67], v11, s[20:23], s53 offen offset:192
    s_waitcnt vmcnt(14)
    v_mfma_f32_32x32x16_bf16 v[16:31], v[36:39], v[68:71], v[16:31]
    buffer_load_dwordx4 v[36:39], v10, s[20:23], s52 offen offset:800
    buffer_load_dwordx4 v[68:71], v11, s[20:23], s53 offen offset:3264
    s_waitcnt vmcnt(14)
    v_mfma_f32_32x32x16_bf16 v[16:31], v[40:43], v[72:75], v[16:31]
    buffer_load_dwordx4 v[40:43], v10, s[20:23], s52 offen offset:832
    buffer_load_dwordx4 v[72:75], v11, s[20:23], s53 offen offset:208
    s_waitcnt vmcnt(14)
    v_mfma_f32_32x32x16_bf16 v[16:31], v[44:47], v[76:79], v[16:31]
    buffer_load_dwordx4 v[44:47], v10, s[20:23], s52 offen offset:864
    buffer_load_dwordx4 v[76:79], v11, s[20:23], s53 offen offset:3280
    s_waitcnt vmcnt(14)
    v_mfma_f32_32x32x16_bf16 v[16:31], v[48:51], v[80:83], v[16:31]
    buffer_load_dwordx4 v[48:51], v10, s[20:23], s52 offen offset:896
    buffer_load_dwordx4 v[80:83], v11, s[20:23], s53 offen offset:224
    s_waitcnt vmcnt(14)
    v_mfma_f32_32x32x16_bf16 v[16:31], v[52:55], v[84:87], v[16:31]
    buffer_load_dwordx4 v[52:55], v10, s[20:23], s52 offen offset:928
    buffer_load_dwordx4 v[84:87], v11, s[20:23], s53 offen offset:3296
    s_waitcnt vmcnt(14)
    v_mfma_f32_32x32x16_bf16 v[16:31], v[56:59], v[88:91], v[16:31]
    buffer_load_dwordx4 v[56:59], v10, s[20:23], s52 offen offset:960
    buffer_load_dwordx4 v[88:91], v11, s[20:23], s53 offen offset:240
    s_waitcnt vmcnt(14)
    v_mfma_f32_32x32x16_bf16 v[16:31], v[60:63], v[92:95], v[16:31]
    buffer_load_dwordx4 v[60:63], v10, s[20:23], s52 offen offset:992
    buffer_load_dwordx4 v[92:95], v11, s[20:23], s53 offen offset:3312
    s_waitcnt vmcnt(14)
    v_mfma_f32_32x32x16_bf16 v[16:31], v[32:35], v[64:67], v[16:31]
    buffer_load_dwordx4 v[32:35], v10, s[20:23], s52 offen offset:1024
    buffer_load_dwordx4 v[64:67], v11, s[20:23], s53 offen offset:256
    s_waitcnt vmcnt(14)
    v_mfma_f32_32x32x16_bf16 v[16:31], v[36:39], v[68:71], v[16:31]
    buffer_load_dwordx4 v[36:39], v10, s[20:23], s52 offen offset:1056
    buffer_load_dwordx4 v[68:71], v11, s[20:23], s53 offen offset:3328
    s_waitcnt vmcnt(14)
    v_mfma_f32_32x32x16_bf16 v[16:31], v[40:43], v[72:75], v[16:31]
    buffer_load_dwordx4 v[40:43], v10, s[20:23], s52 offen offset:1088
    buffer_load_dwordx4 v[72:75], v11, s[20:23], s53 offen offset:272
    s_waitcnt vmcnt(14)
    v_mfma_f32_32x32x16_bf16 v[16:31], v[44:47], v[76:79], v[16:31]
    buffer_load_dwordx4 v[44:47], v10, s[20:23], s52 offen offset:1120
    buffer_load_dwordx4 v[76:79], v11, s[20:23], s53 offen offset:3344
    s_waitcnt vmcnt(14)
    v_mfma_f32_32x32x16_bf16 v[16:31], v[48:51], v[80:83], v[16:31]
    buffer_load_dwordx4 v[48:51], v10, s[20:23], s52 offen offset:1152
    buffer_load_dwordx4 v[80:83], v11, s[20:23], s53 offen offset:288
    s_waitcnt vmcnt(14)
    v_mfma_f32_32x32x16_bf16 v[16:31], v[52:55], v[84:87], v[16:31]
    buffer_load_dwordx4 v[52:55], v10, s[20:23], s52 offen offset:1184
    buffer_load_dwordx4 v[84:87], v11, s[20:23], s53 offen offset:3360
    s_waitcnt vmcnt(14)
    v_mfma_f32_32x32x16_bf16 v[16:31], v[56:59], v[88:91], v[16:31]
    buffer_load_dwordx4 v[56:59], v10, s[20:23], s52 offen offset:1216
    buffer_load_dwordx4 v[88:91], v11, s[20:23], s53 offen offset:304
    s_waitcnt vmcnt(14)
    v_mfma_f32_32x32x16_bf16 v[16:31], v[60:63], v[92:95], v[16:31]
    buffer_load_dwordx4 v[60:63], v10, s[20:23], s52 offen offset:1248
    buffer_load_dwordx4 v[92:95], v11, s[20:23], s53 offen offset:3376
    s_waitcnt vmcnt(14)
    v_mfma_f32_32x32x16_bf16 v[16:31], v[32:35], v[64:67], v[16:31]
    buffer_load_dwordx4 v[32:35], v10, s[20:23], s52 offen offset:1280
    buffer_load_dwordx4 v[64:67], v11, s[20:23], s53 offen offset:320
    s_waitcnt vmcnt(14)
    v_mfma_f32_32x32x16_bf16 v[16:31], v[36:39], v[68:71], v[16:31]
    buffer_load_dwordx4 v[36:39], v10, s[20:23], s52 offen offset:1312
    buffer_load_dwordx4 v[68:71], v11, s[20:23], s53 offen offset:3392
    s_waitcnt vmcnt(14)
    v_mfma_f32_32x32x16_bf16 v[16:31], v[40:43], v[72:75], v[16:31]
    buffer_load_dwordx4 v[40:43], v10, s[20:23], s52 offen offset:1344
    buffer_load_dwordx4 v[72:75], v11, s[20:23], s53 offen offset:336
    s_waitcnt vmcnt(14)
    v_mfma_f32_32x32x16_bf16 v[16:31], v[44:47], v[76:79], v[16:31]
    buffer_load_dwordx4 v[44:47], v10, s[20:23], s52 offen offset:1376
    buffer_load_dwordx4 v[76:79], v11, s[20:23], s53 offen offset:3408
    s_waitcnt vmcnt(14)
    v_mfma_f32_32x32x16_bf16 v[16:31], v[48:51], v[80:83], v[16:31]
    buffer_load_dwordx4 v[48:51], v10, s[20:23], s52 offen offset:1408
    buffer_load_dwordx4 v[80:83], v11, s[20:23], s53 offen offset:352
    s_waitcnt vmcnt(14)
    v_mfma_f32_32x32x16_bf16 v[16:31], v[52:55], v[84:87], v[16:31]
    buffer_load_dwordx4 v[52:55], v10, s[20:23], s52 offen offset:1440
    buffer_load_dwordx4 v[84:87], v11, s[20:23], s53 offen offset:3424
    s_waitcnt vmcnt(14)
    v_mfma_f32_32x32x16_bf16 v[16:31], v[56:59], v[88:91], v[16:31]
    buffer_load_dwordx4 v[56:59], v10, s[20:23], s52 offen offset:1472
    buffer_load_dwordx4 v[88:91], v11, s[20:23], s53 offen offset:368
    s_waitcnt vmcnt(14)
    v_mfma_f32_32x32x16_bf16 v[16:31], v[60:63], v[92:95], v[16:31]
    buffer_load_dwordx4 v[60:63], v10, s[20:23], s52 offen offset:1504
    buffer_load_dwordx4 v[92:95], v11, s[20:23], s53 offen offset:3440
    s_waitcnt vmcnt(14)
    v_mfma_f32_32x32x16_bf16 v[16:31], v[32:35], v[64:67], v[16:31]
    buffer_load_dwordx4 v[32:35], v10, s[20:23], s52 offen offset:1536
    buffer_load_dwordx4 v[64:67], v11, s[20:23], s53 offen offset:384
    s_waitcnt vmcnt(14)
    v_mfma_f32_32x32x16_bf16 v[16:31], v[36:39], v[68:71], v[16:31]
    buffer_load_dwordx4 v[36:39], v10, s[20:23], s52 offen offset:1568
    buffer_load_dwordx4 v[68:71], v11, s[20:23], s53 offen offset:3456
    s_waitcnt vmcnt(14)
    v_mfma_f32_32x32x16_bf16 v[16:31], v[40:43], v[72:75], v[16:31]
    buffer_load_dwordx4 v[40:43], v10, s[20:23], s52 offen offset:1600
    buffer_load_dwordx4 v[72:75], v11, s[20:23], s53 offen offset:400
    s_waitcnt vmcnt(14)
    v_mfma_f32_32x32x16_bf16 v[16:31], v[44:47], v[76:79], v[16:31]
    buffer_load_dwordx4 v[44:47], v10, s[20:23], s52 offen offset:1632
    buffer_load_dwordx4 v[76:79], v11, s[20:23], s53 offen offset:3472
    s_waitcnt vmcnt(14)
    v_mfma_f32_32x32x16_bf16 v[16:31], v[48:51], v[80:83], v[16:31]
    buffer_load_dwordx4 v[48:51], v10, s[20:23], s52 offen offset:1664
    buffer_load_dwordx4 v[80:83], v11, s[20:23], s53 offen offset:416
    s_waitcnt vmcnt(14)
    v_mfma_f32_32x32x16_bf16 v[16:31], v[52:55], v[84:87], v[16:31]
    buffer_load_dwordx4 v[52:55], v10, s[20:23], s52 offen offset:1696
    buffer_load_dwordx4 v[84:87], v11, s[20:23], s53 offen offset:3488
    s_waitcnt vmcnt(14)
    v_mfma_f32_32x32x16_bf16 v[16:31], v[56:59], v[88:91], v[16:31]
    buffer_load_dwordx4 v[56:59], v10, s[20:23], s52 offen offset:1728
    buffer_load_dwordx4 v[88:91], v11, s[20:23], s53 offen offset:432
    s_waitcnt vmcnt(14)
    v_mfma_f32_32x32x16_bf16 v[16:31], v[60:63], v[92:95], v[16:31]
    buffer_load_dwordx4 v[60:63], v10, s[20:23], s52 offen offset:1760
    buffer_load_dwordx4 v[92:95], v11, s[20:23], s53 offen offset:3504
    s_waitcnt vmcnt(14)
    v_mfma_f32_32x32x16_bf16 v[16:31], v[32:35], v[64:67], v[16:31]
    buffer_load_dwordx4 v[32:35], v10, s[20:23], s52 offen offset:1792
    buffer_load_dwordx4 v[64:67], v11, s[20:23], s53 offen offset:448
    s_waitcnt vmcnt(14)
    v_mfma_f32_32x32x16_bf16 v[16:31], v[36:39], v[68:71], v[16:31]
    buffer_load_dwordx4 v[36:39], v10, s[20:23], s52 offen offset:1824
    buffer_load_dwordx4 v[68:71], v11, s[20:23], s53 offen offset:3520
    s_waitcnt vmcnt(14)
    v_mfma_f32_32x32x16_bf16 v[16:31], v[40:43], v[72:75], v[16:31]
    buffer_load_dwordx4 v[40:43], v10, s[20:23], s52 offen offset:1856
    buffer_load_dwordx4 v[72:75], v11, s[20:23], s53 offen offset:464
    s_waitcnt vmcnt(14)
    v_mfma_f32_32x32x16_bf16 v[16:31], v[44:47], v[76:79], v[16:31]
    buffer_load_dwordx4 v[44:47], v10, s[20:23], s52 offen offset:1888
    buffer_load_dwordx4 v[76:79], v11, s[20:23], s53 offen offset:3536
    s_waitcnt vmcnt(14)
    v_mfma_f32_32x32x16_bf16 v[16:31], v[48:51], v[80:83], v[16:31]
    buffer_load_dwordx4 v[48:51], v10, s[20:23], s52 offen offset:1920
    buffer_load_dwordx4 v[80:83], v11, s[20:23], s53 offen offset:480
    s_waitcnt vmcnt(14)
    v_mfma_f32_32x32x16_bf16 v[16:31], v[52:55], v[84:87], v[16:31]
    buffer_load_dwordx4 v[52:55], v10, s[20:23], s52 offen offset:1952
    buffer_load_dwordx4 v[84:87], v11, s[20:23], s53 offen offset:3552
    s_waitcnt vmcnt(14)
    v_mfma_f32_32x32x16_bf16 v[16:31], v[56:59], v[88:91], v[16:31]
    buffer_load_dwordx4 v[56:59], v10, s[20:23], s52 offen offset:1984
    buffer_load_dwordx4 v[88:91], v11, s[20:23], s53 offen offset:496
    s_waitcnt vmcnt(14)
    v_mfma_f32_32x32x16_bf16 v[16:31], v[60:63], v[92:95], v[16:31]
    buffer_load_dwordx4 v[60:63], v10, s[20:23], s52 offen offset:2016
    buffer_load_dwordx4 v[92:95], v11, s[20:23], s53 offen offset:3568
    s_waitcnt vmcnt(14)
    v_mfma_f32_32x32x16_bf16 v[16:31], v[32:35], v[64:67], v[16:31]
    s_waitcnt vmcnt(12)
    v_mfma_f32_32x32x16_bf16 v[16:31], v[36:39], v[68:71], v[16:31]
    s_waitcnt vmcnt(10)
    v_mfma_f32_32x32x16_bf16 v[16:31], v[40:43], v[72:75], v[16:31]
    s_waitcnt vmcnt(8)
    v_mfma_f32_32x32x16_bf16 v[16:31], v[44:47], v[76:79], v[16:31]
    s_waitcnt vmcnt(6)
    v_mfma_f32_32x32x16_bf16 v[16:31], v[48:51], v[80:83], v[16:31]
    s_waitcnt vmcnt(4)
    v_mfma_f32_32x32x16_bf16 v[16:31], v[52:55], v[84:87], v[16:31]
    s_waitcnt vmcnt(2)
    v_mfma_f32_32x32x16_bf16 v[16:31], v[56:59], v[88:91], v[16:31]
    s_waitcnt vmcnt(0)
    v_mfma_f32_32x32x16_bf16 v[16:31], v[60:63], v[92:95], v[16:31]
    s_cmp_eq_u32 s50, 0
    s_cbranch_scc1 L_cont_200020
    s_nop 7
    s_nop 3
    s_mul_i32 s54, s47, 6144
    s_add_u32 s54, s54, 23068672
    s_lshl_b32 s55, s59, 4
    s_add_u32 s54, s54, s55
    buffer_load_dwordx4 v[32:35], v11, s[20:23], s54 offen
    buffer_load_dwordx4 v[36:39], v11, s[20:23], s54 offen offset:3072
    s_lshl_b32 s55, s47, 1
    v_mov_b32 v12, s55
    buffer_load_ushort v13, v12, s[12:15], 0 offen
    s_lshl_b32 s56, s47, 12
    s_lshl_b32 s57, s59, 6
    s_add_u32 s56, s56, s57
    s_add_u32 s56, s56, 27262976
    v_lshlrev_b32 v14, 6, v3
    v_lshlrev_b32 v15, 4, v4
    v_add_u32 v14, v14, v15
    s_nop 4
    s_waitcnt vmcnt(0)
    v_lshlrev_b32 v13, 16, v13

    v_lshlrev_b32 v40, 16, v32
    v_and_b32 v41, 0xffff0000, v32
    v_mul_f32 v40, v13, v40
    v_mul_f32 v41, v13, v41
    v_cvt_pk_bf16_f32 v42, v40, v41
    v_cvt_pk_bf16_f32 v43, v16, v24
    v_lshlrev_b32 v40, 16, v42
    v_and_b32 v41, 0xffff0000, v42
    v_lshlrev_b32 v44, 16, v43
    v_and_b32 v45, 0xffff0000, v43
    v_add_f32 v40, v40, v44
    v_add_f32 v41, v41, v45
    v_cvt_pk_bf16_f32 v56, v40, v41

    v_lshlrev_b32 v48, 16, v33
    v_and_b32 v49, 0xffff0000, v33
    v_mul_f32 v48, v13, v48
    v_mul_f32 v49, v13, v49
    v_cvt_pk_bf16_f32 v50, v48, v49
    v_cvt_pk_bf16_f32 v51, v17, v25
    v_lshlrev_b32 v48, 16, v50
    v_and_b32 v49, 0xffff0000, v50
    v_lshlrev_b32 v52, 16, v51
    v_and_b32 v53, 0xffff0000, v51
    v_add_f32 v48, v48, v52
    v_add_f32 v49, v49, v53
    v_cvt_pk_bf16_f32 v57, v48, v49

    v_lshlrev_b32 v40, 16, v34
    v_and_b32 v41, 0xffff0000, v34
    v_mul_f32 v40, v13, v40
    v_mul_f32 v41, v13, v41
    v_cvt_pk_bf16_f32 v42, v40, v41
    v_cvt_pk_bf16_f32 v43, v18, v26
    v_lshlrev_b32 v40, 16, v42
    v_and_b32 v41, 0xffff0000, v42
    v_lshlrev_b32 v44, 16, v43
    v_and_b32 v45, 0xffff0000, v43
    v_add_f32 v40, v40, v44
    v_add_f32 v41, v41, v45
    v_cvt_pk_bf16_f32 v58, v40, v41

    v_lshlrev_b32 v48, 16, v35
    v_and_b32 v49, 0xffff0000, v35
    v_mul_f32 v48, v13, v48
    v_mul_f32 v49, v13, v49
    v_cvt_pk_bf16_f32 v50, v48, v49
    v_cvt_pk_bf16_f32 v51, v19, v27
    v_lshlrev_b32 v48, 16, v50
    v_and_b32 v49, 0xffff0000, v50
    v_lshlrev_b32 v52, 16, v51
    v_and_b32 v53, 0xffff0000, v51
    v_add_f32 v48, v48, v52
    v_add_f32 v49, v49, v53
    v_cvt_pk_bf16_f32 v59, v48, v49

    v_lshlrev_b32 v40, 16, v36
    v_and_b32 v41, 0xffff0000, v36
    v_mul_f32 v40, v13, v40
    v_mul_f32 v41, v13, v41
    v_cvt_pk_bf16_f32 v42, v40, v41
    v_cvt_pk_bf16_f32 v43, v20, v28
    v_lshlrev_b32 v40, 16, v42
    v_and_b32 v41, 0xffff0000, v42
    v_lshlrev_b32 v44, 16, v43
    v_and_b32 v45, 0xffff0000, v43
    v_add_f32 v40, v40, v44
    v_add_f32 v41, v41, v45
    v_cvt_pk_bf16_f32 v60, v40, v41

    v_lshlrev_b32 v48, 16, v37
    v_and_b32 v49, 0xffff0000, v37
    v_mul_f32 v48, v13, v48
    v_mul_f32 v49, v13, v49
    v_cvt_pk_bf16_f32 v50, v48, v49
    v_cvt_pk_bf16_f32 v51, v21, v29
    v_lshlrev_b32 v48, 16, v50
    v_and_b32 v49, 0xffff0000, v50
    v_lshlrev_b32 v52, 16, v51
    v_and_b32 v53, 0xffff0000, v51
    v_add_f32 v48, v48, v52
    v_add_f32 v49, v49, v53
    v_cvt_pk_bf16_f32 v61, v48, v49

    v_lshlrev_b32 v40, 16, v38
    v_and_b32 v41, 0xffff0000, v38
    v_mul_f32 v40, v13, v40
    v_mul_f32 v41, v13, v41
    v_cvt_pk_bf16_f32 v42, v40, v41
    v_cvt_pk_bf16_f32 v43, v22, v30
    v_lshlrev_b32 v40, 16, v42
    v_and_b32 v41, 0xffff0000, v42
    v_lshlrev_b32 v44, 16, v43
    v_and_b32 v45, 0xffff0000, v43
    v_add_f32 v40, v40, v44
    v_add_f32 v41, v41, v45
    v_cvt_pk_bf16_f32 v62, v40, v41

    v_lshlrev_b32 v48, 16, v39
    v_and_b32 v49, 0xffff0000, v39
    v_mul_f32 v48, v13, v48
    v_mul_f32 v49, v13, v49
    v_cvt_pk_bf16_f32 v50, v48, v49
    v_cvt_pk_bf16_f32 v51, v23, v31
    v_lshlrev_b32 v48, 16, v50
    v_and_b32 v49, 0xffff0000, v50
    v_lshlrev_b32 v52, 16, v51
    v_and_b32 v53, 0xffff0000, v51
    v_add_f32 v48, v48, v52
    v_add_f32 v49, v49, v53
    v_cvt_pk_bf16_f32 v63, v48, v49

    s_lshl_b32 s57, s40, 11
    s_add_u32 s57, s57, 155648
    v_add_u32 v15, s57, v14
    ds_write_b128 v15, v[56:59]
    ds_write_b128 v15, v[60:63] offset:32
    v_lshlrev_b32 v14, 4, v2
    v_add_u32 v15, s57, v14
    s_waitcnt lgkmcnt(0)
    ds_read_b128 v[56:59], v15
    ds_read_b128 v[60:63], v15 offset:1024
    s_waitcnt lgkmcnt(0)
    buffer_store_dwordx4 v[56:59], v14, s[20:23], s56 offen sc1
    buffer_store_dwordx4 v[60:63], v14, s[20:23], s56 offen offset:1024 sc1

    s_nop 1
    v_mov_b32 v16, 0
    v_mov_b32 v17, 0
    v_mov_b32 v18, 0
    v_mov_b32 v19, 0
    v_mov_b32 v20, 0
    v_mov_b32 v21, 0
    v_mov_b32 v22, 0
    v_mov_b32 v23, 0
    v_mov_b32 v24, 0
    v_mov_b32 v25, 0
    v_mov_b32 v26, 0
    v_mov_b32 v27, 0
    v_mov_b32 v28, 0
    v_mov_b32 v29, 0
    v_mov_b32 v30, 0
    v_mov_b32 v31, 0
L_cont_200020:
    s_cmp_eq_u32 s50, 0
    s_cselect_b32 s58, 126, 62
    s_cselect_b32 s59, 32, 0
    s_mul_i32 s52, s48, 8320
    s_add_u32 s52, s52, 16777216
    s_lshl_b32 s54, s58, 5
    s_sub_u32 s52, s52, s54
    s_mul_i32 s53, s48, 6144
    s_add_u32 s53, s53, 23068672
    s_lshr_b32 s54, s58, 1
    s_sub_u32 s54, s59, s54
    s_lshl_b32 s54, s54, 4
    s_add_u32 s53, s53, s54

    buffer_load_dwordx4 v[32:35], v10, s[20:23], s52 offen offset:0
    buffer_load_dwordx4 v[64:67], v11, s[20:23], s53 offen offset:0
    buffer_load_dwordx4 v[36:39], v10, s[20:23], s52 offen offset:32
    buffer_load_dwordx4 v[68:71], v11, s[20:23], s53 offen offset:3072
    buffer_load_dwordx4 v[40:43], v10, s[20:23], s52 offen offset:64
    buffer_load_dwordx4 v[72:75], v11, s[20:23], s53 offen offset:16
    buffer_load_dwordx4 v[44:47], v10, s[20:23], s52 offen offset:96
    buffer_load_dwordx4 v[76:79], v11, s[20:23], s53 offen offset:3088
    buffer_load_dwordx4 v[48:51], v10, s[20:23], s52 offen offset:128
    buffer_load_dwordx4 v[80:83], v11, s[20:23], s53 offen offset:32
    buffer_load_dwordx4 v[52:55], v10, s[20:23], s52 offen offset:160
    buffer_load_dwordx4 v[84:87], v11, s[20:23], s53 offen offset:3104
    buffer_load_dwordx4 v[56:59], v10, s[20:23], s52 offen offset:192
    buffer_load_dwordx4 v[88:91], v11, s[20:23], s53 offen offset:48
    buffer_load_dwordx4 v[60:63], v10, s[20:23], s52 offen offset:224
    buffer_load_dwordx4 v[92:95], v11, s[20:23], s53 offen offset:3120
    s_waitcnt vmcnt(14)
    v_mfma_f32_32x32x16_bf16 v[16:31], v[32:35], v[64:67], v[16:31]
    buffer_load_dwordx4 v[32:35], v10, s[20:23], s52 offen offset:256
    buffer_load_dwordx4 v[64:67], v11, s[20:23], s53 offen offset:64
    s_waitcnt vmcnt(14)
    v_mfma_f32_32x32x16_bf16 v[16:31], v[36:39], v[68:71], v[16:31]
    buffer_load_dwordx4 v[36:39], v10, s[20:23], s52 offen offset:288
    buffer_load_dwordx4 v[68:71], v11, s[20:23], s53 offen offset:3136
    s_waitcnt vmcnt(14)
    v_mfma_f32_32x32x16_bf16 v[16:31], v[40:43], v[72:75], v[16:31]
    buffer_load_dwordx4 v[40:43], v10, s[20:23], s52 offen offset:320
    buffer_load_dwordx4 v[72:75], v11, s[20:23], s53 offen offset:80
    s_waitcnt vmcnt(14)
    v_mfma_f32_32x32x16_bf16 v[16:31], v[44:47], v[76:79], v[16:31]
    buffer_load_dwordx4 v[44:47], v10, s[20:23], s52 offen offset:352
    buffer_load_dwordx4 v[76:79], v11, s[20:23], s53 offen offset:3152
    s_waitcnt vmcnt(14)
    v_mfma_f32_32x32x16_bf16 v[16:31], v[48:51], v[80:83], v[16:31]
    buffer_load_dwordx4 v[48:51], v10, s[20:23], s52 offen offset:384
    buffer_load_dwordx4 v[80:83], v11, s[20:23], s53 offen offset:96
    s_waitcnt vmcnt(14)
    v_mfma_f32_32x32x16_bf16 v[16:31], v[52:55], v[84:87], v[16:31]
    buffer_load_dwordx4 v[52:55], v10, s[20:23], s52 offen offset:416
    buffer_load_dwordx4 v[84:87], v11, s[20:23], s53 offen offset:3168
    s_waitcnt vmcnt(14)
    v_mfma_f32_32x32x16_bf16 v[16:31], v[56:59], v[88:91], v[16:31]
    buffer_load_dwordx4 v[56:59], v10, s[20:23], s52 offen offset:448
    buffer_load_dwordx4 v[88:91], v11, s[20:23], s53 offen offset:112
    s_waitcnt vmcnt(14)
    v_mfma_f32_32x32x16_bf16 v[16:31], v[60:63], v[92:95], v[16:31]
    buffer_load_dwordx4 v[60:63], v10, s[20:23], s52 offen offset:480
    buffer_load_dwordx4 v[92:95], v11, s[20:23], s53 offen offset:3184
    s_waitcnt vmcnt(14)
    v_mfma_f32_32x32x16_bf16 v[16:31], v[32:35], v[64:67], v[16:31]
    buffer_load_dwordx4 v[32:35], v10, s[20:23], s52 offen offset:512
    buffer_load_dwordx4 v[64:67], v11, s[20:23], s53 offen offset:128
    s_waitcnt vmcnt(14)
    v_mfma_f32_32x32x16_bf16 v[16:31], v[36:39], v[68:71], v[16:31]
    buffer_load_dwordx4 v[36:39], v10, s[20:23], s52 offen offset:544
    buffer_load_dwordx4 v[68:71], v11, s[20:23], s53 offen offset:3200
    s_waitcnt vmcnt(14)
    v_mfma_f32_32x32x16_bf16 v[16:31], v[40:43], v[72:75], v[16:31]
    buffer_load_dwordx4 v[40:43], v10, s[20:23], s52 offen offset:576
    buffer_load_dwordx4 v[72:75], v11, s[20:23], s53 offen offset:144
    s_waitcnt vmcnt(14)
    v_mfma_f32_32x32x16_bf16 v[16:31], v[44:47], v[76:79], v[16:31]
    buffer_load_dwordx4 v[44:47], v10, s[20:23], s52 offen offset:608
    buffer_load_dwordx4 v[76:79], v11, s[20:23], s53 offen offset:3216
    s_waitcnt vmcnt(14)
    v_mfma_f32_32x32x16_bf16 v[16:31], v[48:51], v[80:83], v[16:31]
    buffer_load_dwordx4 v[48:51], v10, s[20:23], s52 offen offset:640
    buffer_load_dwordx4 v[80:83], v11, s[20:23], s53 offen offset:160
    s_waitcnt vmcnt(14)
    v_mfma_f32_32x32x16_bf16 v[16:31], v[52:55], v[84:87], v[16:31]
    buffer_load_dwordx4 v[52:55], v10, s[20:23], s52 offen offset:672
    buffer_load_dwordx4 v[84:87], v11, s[20:23], s53 offen offset:3232
    s_waitcnt vmcnt(14)
    v_mfma_f32_32x32x16_bf16 v[16:31], v[56:59], v[88:91], v[16:31]
    buffer_load_dwordx4 v[56:59], v10, s[20:23], s52 offen offset:704
    buffer_load_dwordx4 v[88:91], v11, s[20:23], s53 offen offset:176
    s_waitcnt vmcnt(14)
    v_mfma_f32_32x32x16_bf16 v[16:31], v[60:63], v[92:95], v[16:31]
    buffer_load_dwordx4 v[60:63], v10, s[20:23], s52 offen offset:736
    buffer_load_dwordx4 v[92:95], v11, s[20:23], s53 offen offset:3248
    s_waitcnt vmcnt(14)
    v_mfma_f32_32x32x16_bf16 v[16:31], v[32:35], v[64:67], v[16:31]
    buffer_load_dwordx4 v[32:35], v10, s[20:23], s52 offen offset:768
    buffer_load_dwordx4 v[64:67], v11, s[20:23], s53 offen offset:192
    s_waitcnt vmcnt(14)
    v_mfma_f32_32x32x16_bf16 v[16:31], v[36:39], v[68:71], v[16:31]
    buffer_load_dwordx4 v[36:39], v10, s[20:23], s52 offen offset:800
    buffer_load_dwordx4 v[68:71], v11, s[20:23], s53 offen offset:3264
    s_waitcnt vmcnt(14)
    v_mfma_f32_32x32x16_bf16 v[16:31], v[40:43], v[72:75], v[16:31]
    buffer_load_dwordx4 v[40:43], v10, s[20:23], s52 offen offset:832
    buffer_load_dwordx4 v[72:75], v11, s[20:23], s53 offen offset:208
    s_waitcnt vmcnt(14)
    v_mfma_f32_32x32x16_bf16 v[16:31], v[44:47], v[76:79], v[16:31]
    buffer_load_dwordx4 v[44:47], v10, s[20:23], s52 offen offset:864
    buffer_load_dwordx4 v[76:79], v11, s[20:23], s53 offen offset:3280
    s_waitcnt vmcnt(14)
    v_mfma_f32_32x32x16_bf16 v[16:31], v[48:51], v[80:83], v[16:31]
    buffer_load_dwordx4 v[48:51], v10, s[20:23], s52 offen offset:896
    buffer_load_dwordx4 v[80:83], v11, s[20:23], s53 offen offset:224
    s_waitcnt vmcnt(14)
    v_mfma_f32_32x32x16_bf16 v[16:31], v[52:55], v[84:87], v[16:31]
    buffer_load_dwordx4 v[52:55], v10, s[20:23], s52 offen offset:928
    buffer_load_dwordx4 v[84:87], v11, s[20:23], s53 offen offset:3296
    s_waitcnt vmcnt(14)
    v_mfma_f32_32x32x16_bf16 v[16:31], v[56:59], v[88:91], v[16:31]
    buffer_load_dwordx4 v[56:59], v10, s[20:23], s52 offen offset:960
    buffer_load_dwordx4 v[88:91], v11, s[20:23], s53 offen offset:240
    s_waitcnt vmcnt(14)
    v_mfma_f32_32x32x16_bf16 v[16:31], v[60:63], v[92:95], v[16:31]
    buffer_load_dwordx4 v[60:63], v10, s[20:23], s52 offen offset:992
    buffer_load_dwordx4 v[92:95], v11, s[20:23], s53 offen offset:3312
    s_waitcnt vmcnt(14)
    v_mfma_f32_32x32x16_bf16 v[16:31], v[32:35], v[64:67], v[16:31]
    buffer_load_dwordx4 v[32:35], v10, s[20:23], s52 offen offset:1024
    buffer_load_dwordx4 v[64:67], v11, s[20:23], s53 offen offset:256
    s_waitcnt vmcnt(14)
    v_mfma_f32_32x32x16_bf16 v[16:31], v[36:39], v[68:71], v[16:31]
    buffer_load_dwordx4 v[36:39], v10, s[20:23], s52 offen offset:1056
    buffer_load_dwordx4 v[68:71], v11, s[20:23], s53 offen offset:3328
    s_waitcnt vmcnt(14)
    v_mfma_f32_32x32x16_bf16 v[16:31], v[40:43], v[72:75], v[16:31]
    buffer_load_dwordx4 v[40:43], v10, s[20:23], s52 offen offset:1088
    buffer_load_dwordx4 v[72:75], v11, s[20:23], s53 offen offset:272
    s_waitcnt vmcnt(14)
    v_mfma_f32_32x32x16_bf16 v[16:31], v[44:47], v[76:79], v[16:31]
    buffer_load_dwordx4 v[44:47], v10, s[20:23], s52 offen offset:1120
    buffer_load_dwordx4 v[76:79], v11, s[20:23], s53 offen offset:3344
    s_waitcnt vmcnt(14)
    v_mfma_f32_32x32x16_bf16 v[16:31], v[48:51], v[80:83], v[16:31]
    buffer_load_dwordx4 v[48:51], v10, s[20:23], s52 offen offset:1152
    buffer_load_dwordx4 v[80:83], v11, s[20:23], s53 offen offset:288
    s_waitcnt vmcnt(14)
    v_mfma_f32_32x32x16_bf16 v[16:31], v[52:55], v[84:87], v[16:31]
    buffer_load_dwordx4 v[52:55], v10, s[20:23], s52 offen offset:1184
    buffer_load_dwordx4 v[84:87], v11, s[20:23], s53 offen offset:3360
    s_waitcnt vmcnt(14)
    v_mfma_f32_32x32x16_bf16 v[16:31], v[56:59], v[88:91], v[16:31]
    buffer_load_dwordx4 v[56:59], v10, s[20:23], s52 offen offset:1216
    buffer_load_dwordx4 v[88:91], v11, s[20:23], s53 offen offset:304
    s_waitcnt vmcnt(14)
    v_mfma_f32_32x32x16_bf16 v[16:31], v[60:63], v[92:95], v[16:31]
    buffer_load_dwordx4 v[60:63], v10, s[20:23], s52 offen offset:1248
    buffer_load_dwordx4 v[92:95], v11, s[20:23], s53 offen offset:3376
    s_waitcnt vmcnt(14)
    v_mfma_f32_32x32x16_bf16 v[16:31], v[32:35], v[64:67], v[16:31]
    buffer_load_dwordx4 v[32:35], v10, s[20:23], s52 offen offset:1280
    buffer_load_dwordx4 v[64:67], v11, s[20:23], s53 offen offset:320
    s_waitcnt vmcnt(14)
    v_mfma_f32_32x32x16_bf16 v[16:31], v[36:39], v[68:71], v[16:31]
    buffer_load_dwordx4 v[36:39], v10, s[20:23], s52 offen offset:1312
    buffer_load_dwordx4 v[68:71], v11, s[20:23], s53 offen offset:3392
    s_waitcnt vmcnt(14)
    v_mfma_f32_32x32x16_bf16 v[16:31], v[40:43], v[72:75], v[16:31]
    buffer_load_dwordx4 v[40:43], v10, s[20:23], s52 offen offset:1344
    buffer_load_dwordx4 v[72:75], v11, s[20:23], s53 offen offset:336
    s_waitcnt vmcnt(14)
    v_mfma_f32_32x32x16_bf16 v[16:31], v[44:47], v[76:79], v[16:31]
    buffer_load_dwordx4 v[44:47], v10, s[20:23], s52 offen offset:1376
    buffer_load_dwordx4 v[76:79], v11, s[20:23], s53 offen offset:3408
    s_waitcnt vmcnt(14)
    v_mfma_f32_32x32x16_bf16 v[16:31], v[48:51], v[80:83], v[16:31]
    buffer_load_dwordx4 v[48:51], v10, s[20:23], s52 offen offset:1408
    buffer_load_dwordx4 v[80:83], v11, s[20:23], s53 offen offset:352
    s_waitcnt vmcnt(14)
    v_mfma_f32_32x32x16_bf16 v[16:31], v[52:55], v[84:87], v[16:31]
    buffer_load_dwordx4 v[52:55], v10, s[20:23], s52 offen offset:1440
    buffer_load_dwordx4 v[84:87], v11, s[20:23], s53 offen offset:3424
    s_waitcnt vmcnt(14)
    v_mfma_f32_32x32x16_bf16 v[16:31], v[56:59], v[88:91], v[16:31]
    buffer_load_dwordx4 v[56:59], v10, s[20:23], s52 offen offset:1472
    buffer_load_dwordx4 v[88:91], v11, s[20:23], s53 offen offset:368
    s_waitcnt vmcnt(14)
    v_mfma_f32_32x32x16_bf16 v[16:31], v[60:63], v[92:95], v[16:31]
    buffer_load_dwordx4 v[60:63], v10, s[20:23], s52 offen offset:1504
    buffer_load_dwordx4 v[92:95], v11, s[20:23], s53 offen offset:3440
    s_waitcnt vmcnt(14)
    v_mfma_f32_32x32x16_bf16 v[16:31], v[32:35], v[64:67], v[16:31]
    buffer_load_dwordx4 v[32:35], v10, s[20:23], s52 offen offset:1536
    buffer_load_dwordx4 v[64:67], v11, s[20:23], s53 offen offset:384
    s_waitcnt vmcnt(14)
    v_mfma_f32_32x32x16_bf16 v[16:31], v[36:39], v[68:71], v[16:31]
    buffer_load_dwordx4 v[36:39], v10, s[20:23], s52 offen offset:1568
    buffer_load_dwordx4 v[68:71], v11, s[20:23], s53 offen offset:3456
    s_waitcnt vmcnt(14)
    v_mfma_f32_32x32x16_bf16 v[16:31], v[40:43], v[72:75], v[16:31]
    buffer_load_dwordx4 v[40:43], v10, s[20:23], s52 offen offset:1600
    buffer_load_dwordx4 v[72:75], v11, s[20:23], s53 offen offset:400
    s_waitcnt vmcnt(14)
    v_mfma_f32_32x32x16_bf16 v[16:31], v[44:47], v[76:79], v[16:31]
    buffer_load_dwordx4 v[44:47], v10, s[20:23], s52 offen offset:1632
    buffer_load_dwordx4 v[76:79], v11, s[20:23], s53 offen offset:3472
    s_waitcnt vmcnt(14)
    v_mfma_f32_32x32x16_bf16 v[16:31], v[48:51], v[80:83], v[16:31]
    buffer_load_dwordx4 v[48:51], v10, s[20:23], s52 offen offset:1664
    buffer_load_dwordx4 v[80:83], v11, s[20:23], s53 offen offset:416
    s_waitcnt vmcnt(14)
    v_mfma_f32_32x32x16_bf16 v[16:31], v[52:55], v[84:87], v[16:31]
    buffer_load_dwordx4 v[52:55], v10, s[20:23], s52 offen offset:1696
    buffer_load_dwordx4 v[84:87], v11, s[20:23], s53 offen offset:3488
    s_waitcnt vmcnt(14)
    v_mfma_f32_32x32x16_bf16 v[16:31], v[56:59], v[88:91], v[16:31]
    buffer_load_dwordx4 v[56:59], v10, s[20:23], s52 offen offset:1728
    buffer_load_dwordx4 v[88:91], v11, s[20:23], s53 offen offset:432
    s_waitcnt vmcnt(14)
    v_mfma_f32_32x32x16_bf16 v[16:31], v[60:63], v[92:95], v[16:31]
    buffer_load_dwordx4 v[60:63], v10, s[20:23], s52 offen offset:1760
    buffer_load_dwordx4 v[92:95], v11, s[20:23], s53 offen offset:3504
    s_waitcnt vmcnt(14)
    v_mfma_f32_32x32x16_bf16 v[16:31], v[32:35], v[64:67], v[16:31]
    buffer_load_dwordx4 v[32:35], v10, s[20:23], s52 offen offset:1792
    buffer_load_dwordx4 v[64:67], v11, s[20:23], s53 offen offset:448
    s_waitcnt vmcnt(14)
    v_mfma_f32_32x32x16_bf16 v[16:31], v[36:39], v[68:71], v[16:31]
    buffer_load_dwordx4 v[36:39], v10, s[20:23], s52 offen offset:1824
    buffer_load_dwordx4 v[68:71], v11, s[20:23], s53 offen offset:3520
    s_waitcnt vmcnt(14)
    v_mfma_f32_32x32x16_bf16 v[16:31], v[40:43], v[72:75], v[16:31]
    buffer_load_dwordx4 v[40:43], v10, s[20:23], s52 offen offset:1856
    buffer_load_dwordx4 v[72:75], v11, s[20:23], s53 offen offset:464
    s_waitcnt vmcnt(14)
    v_mfma_f32_32x32x16_bf16 v[16:31], v[44:47], v[76:79], v[16:31]
    buffer_load_dwordx4 v[44:47], v10, s[20:23], s52 offen offset:1888
    buffer_load_dwordx4 v[76:79], v11, s[20:23], s53 offen offset:3536
    s_waitcnt vmcnt(14)
    v_mfma_f32_32x32x16_bf16 v[16:31], v[48:51], v[80:83], v[16:31]
    buffer_load_dwordx4 v[48:51], v10, s[20:23], s52 offen offset:1920
    buffer_load_dwordx4 v[80:83], v11, s[20:23], s53 offen offset:480
    s_waitcnt vmcnt(14)
    v_mfma_f32_32x32x16_bf16 v[16:31], v[52:55], v[84:87], v[16:31]
    buffer_load_dwordx4 v[52:55], v10, s[20:23], s52 offen offset:1952
    buffer_load_dwordx4 v[84:87], v11, s[20:23], s53 offen offset:3552
    s_waitcnt vmcnt(14)
    v_mfma_f32_32x32x16_bf16 v[16:31], v[56:59], v[88:91], v[16:31]
    buffer_load_dwordx4 v[56:59], v10, s[20:23], s52 offen offset:1984
    buffer_load_dwordx4 v[88:91], v11, s[20:23], s53 offen offset:496
    s_waitcnt vmcnt(14)
    v_mfma_f32_32x32x16_bf16 v[16:31], v[60:63], v[92:95], v[16:31]
    buffer_load_dwordx4 v[60:63], v10, s[20:23], s52 offen offset:2016
    buffer_load_dwordx4 v[92:95], v11, s[20:23], s53 offen offset:3568
    s_waitcnt vmcnt(14)
    v_mfma_f32_32x32x16_bf16 v[16:31], v[32:35], v[64:67], v[16:31]
    s_waitcnt vmcnt(12)
    v_mfma_f32_32x32x16_bf16 v[16:31], v[36:39], v[68:71], v[16:31]
    s_waitcnt vmcnt(10)
    v_mfma_f32_32x32x16_bf16 v[16:31], v[40:43], v[72:75], v[16:31]
    s_waitcnt vmcnt(8)
    v_mfma_f32_32x32x16_bf16 v[16:31], v[44:47], v[76:79], v[16:31]
    s_waitcnt vmcnt(6)
    v_mfma_f32_32x32x16_bf16 v[16:31], v[48:51], v[80:83], v[16:31]
    s_waitcnt vmcnt(4)
    v_mfma_f32_32x32x16_bf16 v[16:31], v[52:55], v[84:87], v[16:31]
    s_waitcnt vmcnt(2)
    v_mfma_f32_32x32x16_bf16 v[16:31], v[56:59], v[88:91], v[16:31]
    s_waitcnt vmcnt(0)
    v_mfma_f32_32x32x16_bf16 v[16:31], v[60:63], v[92:95], v[16:31]
    s_nop 7
    s_nop 3
    s_mul_i32 s54, s48, 6144
    s_add_u32 s54, s54, 23068672
    s_lshl_b32 s55, s59, 4
    s_add_u32 s54, s54, s55
    buffer_load_dwordx4 v[32:35], v11, s[20:23], s54 offen
    buffer_load_dwordx4 v[36:39], v11, s[20:23], s54 offen offset:3072
    s_lshl_b32 s55, s48, 1
    v_mov_b32 v12, s55
    buffer_load_ushort v13, v12, s[12:15], 0 offen
    s_lshl_b32 s56, s48, 12
    s_lshl_b32 s57, s59, 6
    s_add_u32 s56, s56, s57
    s_add_u32 s56, s56, 27262976
    v_lshlrev_b32 v14, 6, v3
    v_lshlrev_b32 v15, 4, v4
    v_add_u32 v14, v14, v15
    s_nop 4
    s_waitcnt vmcnt(0)
    v_lshlrev_b32 v13, 16, v13

    v_lshlrev_b32 v40, 16, v32
    v_and_b32 v41, 0xffff0000, v32
    v_mul_f32 v40, v13, v40
    v_mul_f32 v41, v13, v41
    v_cvt_pk_bf16_f32 v42, v40, v41
    v_cvt_pk_bf16_f32 v43, v16, v24
    v_lshlrev_b32 v40, 16, v42
    v_and_b32 v41, 0xffff0000, v42
    v_lshlrev_b32 v44, 16, v43
    v_and_b32 v45, 0xffff0000, v43
    v_add_f32 v40, v40, v44
    v_add_f32 v41, v41, v45
    v_cvt_pk_bf16_f32 v56, v40, v41

    v_lshlrev_b32 v48, 16, v33
    v_and_b32 v49, 0xffff0000, v33
    v_mul_f32 v48, v13, v48
    v_mul_f32 v49, v13, v49
    v_cvt_pk_bf16_f32 v50, v48, v49
    v_cvt_pk_bf16_f32 v51, v17, v25
    v_lshlrev_b32 v48, 16, v50
    v_and_b32 v49, 0xffff0000, v50
    v_lshlrev_b32 v52, 16, v51
    v_and_b32 v53, 0xffff0000, v51
    v_add_f32 v48, v48, v52
    v_add_f32 v49, v49, v53
    v_cvt_pk_bf16_f32 v57, v48, v49

    v_lshlrev_b32 v40, 16, v34
    v_and_b32 v41, 0xffff0000, v34
    v_mul_f32 v40, v13, v40
    v_mul_f32 v41, v13, v41
    v_cvt_pk_bf16_f32 v42, v40, v41
    v_cvt_pk_bf16_f32 v43, v18, v26
    v_lshlrev_b32 v40, 16, v42
    v_and_b32 v41, 0xffff0000, v42
    v_lshlrev_b32 v44, 16, v43
    v_and_b32 v45, 0xffff0000, v43
    v_add_f32 v40, v40, v44
    v_add_f32 v41, v41, v45
    v_cvt_pk_bf16_f32 v58, v40, v41

    v_lshlrev_b32 v48, 16, v35
    v_and_b32 v49, 0xffff0000, v35
    v_mul_f32 v48, v13, v48
    v_mul_f32 v49, v13, v49
    v_cvt_pk_bf16_f32 v50, v48, v49
    v_cvt_pk_bf16_f32 v51, v19, v27
    v_lshlrev_b32 v48, 16, v50
    v_and_b32 v49, 0xffff0000, v50
    v_lshlrev_b32 v52, 16, v51
    v_and_b32 v53, 0xffff0000, v51
    v_add_f32 v48, v48, v52
    v_add_f32 v49, v49, v53
    v_cvt_pk_bf16_f32 v59, v48, v49

    v_lshlrev_b32 v40, 16, v36
    v_and_b32 v41, 0xffff0000, v36
    v_mul_f32 v40, v13, v40
    v_mul_f32 v41, v13, v41
    v_cvt_pk_bf16_f32 v42, v40, v41
    v_cvt_pk_bf16_f32 v43, v20, v28
    v_lshlrev_b32 v40, 16, v42
    v_and_b32 v41, 0xffff0000, v42
    v_lshlrev_b32 v44, 16, v43
    v_and_b32 v45, 0xffff0000, v43
    v_add_f32 v40, v40, v44
    v_add_f32 v41, v41, v45
    v_cvt_pk_bf16_f32 v60, v40, v41

    v_lshlrev_b32 v48, 16, v37
    v_and_b32 v49, 0xffff0000, v37
    v_mul_f32 v48, v13, v48
    v_mul_f32 v49, v13, v49
    v_cvt_pk_bf16_f32 v50, v48, v49
    v_cvt_pk_bf16_f32 v51, v21, v29
    v_lshlrev_b32 v48, 16, v50
    v_and_b32 v49, 0xffff0000, v50
    v_lshlrev_b32 v52, 16, v51
    v_and_b32 v53, 0xffff0000, v51
    v_add_f32 v48, v48, v52
    v_add_f32 v49, v49, v53
    v_cvt_pk_bf16_f32 v61, v48, v49

    v_lshlrev_b32 v40, 16, v38
    v_and_b32 v41, 0xffff0000, v38
    v_mul_f32 v40, v13, v40
    v_mul_f32 v41, v13, v41
    v_cvt_pk_bf16_f32 v42, v40, v41
    v_cvt_pk_bf16_f32 v43, v22, v30
    v_lshlrev_b32 v40, 16, v42
    v_and_b32 v41, 0xffff0000, v42
    v_lshlrev_b32 v44, 16, v43
    v_and_b32 v45, 0xffff0000, v43
    v_add_f32 v40, v40, v44
    v_add_f32 v41, v41, v45
    v_cvt_pk_bf16_f32 v62, v40, v41

    v_lshlrev_b32 v48, 16, v39
    v_and_b32 v49, 0xffff0000, v39
    v_mul_f32 v48, v13, v48
    v_mul_f32 v49, v13, v49
    v_cvt_pk_bf16_f32 v50, v48, v49
    v_cvt_pk_bf16_f32 v51, v23, v31
    v_lshlrev_b32 v48, 16, v50
    v_and_b32 v49, 0xffff0000, v50
    v_lshlrev_b32 v52, 16, v51
    v_and_b32 v53, 0xffff0000, v51
    v_add_f32 v48, v48, v52
    v_add_f32 v49, v49, v53
    v_cvt_pk_bf16_f32 v63, v48, v49

    s_lshl_b32 s57, s40, 11
    s_add_u32 s57, s57, 155648
    v_add_u32 v15, s57, v14
    ds_write_b128 v15, v[56:59]
    ds_write_b128 v15, v[60:63] offset:32
    v_lshlrev_b32 v14, 4, v2
    v_add_u32 v15, s57, v14
    s_waitcnt lgkmcnt(0)
    ds_read_b128 v[56:59], v15
    ds_read_b128 v[60:63], v15 offset:1024
    s_waitcnt lgkmcnt(0)
    buffer_store_dwordx4 v[56:59], v14, s[20:23], s56 offen sc1
    buffer_store_dwordx4 v[60:63], v14, s[20:23], s56 offen offset:1024 sc1

    s_waitcnt vmcnt(0)
    s_branch L_k2_kernel_post

L_tnone_200019:
    s_waitcnt vmcnt(0)
    v_mov_b32 v12, 73764
    v_mov_b32 v13, 0x10000
    s_mov_b64 exec, 1
    ds_add_u32 v12, v13
    s_mov_b64 exec, -1

    s_branch L_k2_kernel_post
L_k2_kernel_post:
    v_mov_b32 v12, 73764
    v_mov_b32 v13, 0x100000
    s_mov_b64 exec, 1
    ds_add_rtn_u32 v14, v12, v13
    s_waitcnt lgkmcnt(0)
    v_readfirstlane_b32 s54, v14
    s_nop 3
    s_bfe_u32 s54, s54, 0x40014
    s_cmp_lg_u32 s54, 3
    s_cbranch_scc1 L_agg_200021
    s_and_b32 s54, s2, 7
    s_lshl_b32 s54, s54, 8
    s_add_u32 s54, s54, 31459328
    v_mov_b32 v12, 0
    v_mov_b32 v13, 1
    buffer_atomic_add v13, v12, s[20:23], s54 offen sc1

L_agg_200021:
    s_mov_b64 exec, -1
    s_cmp_lg_u32 s24, 11
    s_cbranch_scc1 L_ny_200022
    s_setprio 3
    v_mov_b32 v20, 73764
L_lw_200024:
    ds_read_b32 v21, v20
    s_waitcnt lgkmcnt(0)
    v_readfirstlane_b32 s66, v21
    s_sleep 8
    s_cmp_lt_u32 s66, 0x1400000
    s_cbranch_scc1 L_lw_200024
    v_and_b32 v12, 7, v2
    v_lshlrev_b32 v12, 8, v12
    s_mov_b32 s48, 0
    s_mov_b32 s49, 31459328
    s_mov_b64 exec, 0xff

L_cp_200023:
    s_add_u32 s48, s48, 1
    buffer_load_dword v14, v12, s[20:23], s49 offen sc1
    s_waitcnt vmcnt(0)
    v_cmp_gt_u32 vcc, 32, v14
    s_cmp_ge_u32 s48, 50000
    s_cbranch_scc1 L_cp_200023x
    s_nop 4
    s_cbranch_vccz L_cp_200023x
    s_sleep 64
    s_branch L_cp_200023

L_cp_200023x:
    s_mov_b64 exec, -1
    s_mov_b32 s47, s2
L_yl_200026:
    s_mul_i32 s49, s47, 7282
    s_lshr_b32 s49, s49, 16
    s_mul_i32 s50, s49, 9
    s_sub_u32 s50, s47, s50
    v_lshrrev_b32 v6, 3, v2
    v_lshlrev_b32 v6, 12, v6
    v_and_b32 v7, 7, v2
    v_lshlrev_b32 v7, 4, v7
    v_add_u32 v6, v6, v7
    s_lshl_b32 s51, s50, 18
    s_lshl_b32 s52, s49, 7
    s_add_u32 s51, s51, s52
    s_add_u32 s51, s51, 27262976
    s_mov_b32 s53, 155648
    s_mov_b32 m0, s53
    s_nop 0

    buffer_load_dwordx4 v6, s[20:23], s51 offen sc1 lds
    s_add_u32 m0, m0, 1024
    s_add_u32 s51, s51, 32768
    buffer_load_dwordx4 v6, s[20:23], s51 offen sc1 lds
    s_add_u32 m0, m0, 1024
    s_add_u32 s51, s51, 32768
    buffer_load_dwordx4 v6, s[20:23], s51 offen sc1 lds
    s_add_u32 m0, m0, 1024
    s_add_u32 s51, s51, 32768
    buffer_load_dwordx4 v6, s[20:23], s51 offen sc1 lds
    s_add_u32 m0, m0, 1024
    s_add_u32 s51, s51, 32768
    buffer_load_dwordx4 v6, s[20:23], s51 offen sc1 lds
    s_add_u32 m0, m0, 1024
    s_add_u32 s51, s51, 32768
    buffer_load_dwordx4 v6, s[20:23], s51 offen sc1 lds
    s_add_u32 m0, m0, 1024
    s_add_u32 s51, s51, 32768
    buffer_load_dwordx4 v6, s[20:23], s51 offen sc1 lds
    s_add_u32 m0, m0, 1024
    s_add_u32 s51, s51, 32768
    buffer_load_dwordx4 v6, s[20:23], s51 offen sc1 lds
    v_bfe_u32 v6, v2, 2, 2
    v_lshlrev_b32 v6, 7, v6
    v_lshrrev_b32 v7, 4, v2
    v_lshlrev_b32 v7, 5, v7
    v_add_u32 v6, v6, v7
    v_and_b32 v7, 3, v2
    v_lshlrev_b32 v7, 3, v7
    v_add_u32 v6, v6, v7
    v_add_u32 v6, s53, v6
    v_lshlrev_b32 v9, 7, v2
    v_add_u32 v9, s53, v9
    v_and_b32 v10, 7, v2
    v_lshrrev_b32 v11, 3, v2
    v_xor_b32 v13, v10, v11
    v_lshlrev_b32 v13, 4, v13
    v_lshlrev_b32 v14, 7, v11
    v_add_u32 v13, v13, v14
    v_add_u32 v13, s53, v13
    s_lshl_b32 s54, s49, 6
    v_add_u32 v8, s54, v11
    v_mul_u32_u24 v8, 2304, v8
    v_lshlrev_b32 v14, 4, v10
    v_add_u32 v8, v8, v14
    s_lshl_b32 s55, s50, 7
    s_waitcnt vmcnt(0)

    ds_read_b64_tr_b16 v[32:33], v6 offset:0
    ds_read_b64_tr_b16 v[34:35], v6 offset:512
    ds_read_b64_tr_b16 v[36:37], v6 offset:1024
    ds_read_b64_tr_b16 v[38:39], v6 offset:1536
    ds_read_b64_tr_b16 v[40:41], v6 offset:2048
    ds_read_b64_tr_b16 v[42:43], v6 offset:2560
    ds_read_b64_tr_b16 v[44:45], v6 offset:3072
    ds_read_b64_tr_b16 v[46:47], v6 offset:3584
    ds_read_b64_tr_b16 v[48:49], v6 offset:4096
    ds_read_b64_tr_b16 v[50:51], v6 offset:4608
    ds_read_b64_tr_b16 v[52:53], v6 offset:5120
    ds_read_b64_tr_b16 v[54:55], v6 offset:5632
    ds_read_b64_tr_b16 v[56:57], v6 offset:6144
    ds_read_b64_tr_b16 v[58:59], v6 offset:6656
    ds_read_b64_tr_b16 v[60:61], v6 offset:7168
    ds_read_b64_tr_b16 v[62:63], v6 offset:7680
    s_waitcnt lgkmcnt(0)
    v_xor_b32 v15, 0, v10
    v_lshlrev_b32 v15, 4, v15
    v_add_u32 v15, v15, v9
    ds_write_b128 v15, v[32:35]
    v_xor_b32 v15, 1, v10
    v_lshlrev_b32 v15, 4, v15
    v_add_u32 v15, v15, v9
    ds_write_b128 v15, v[36:39]
    v_xor_b32 v15, 2, v10
    v_lshlrev_b32 v15, 4, v15
    v_add_u32 v15, v15, v9
    ds_write_b128 v15, v[40:43]
    v_xor_b32 v15, 3, v10
    v_lshlrev_b32 v15, 4, v15
    v_add_u32 v15, v15, v9
    ds_write_b128 v15, v[44:47]
    v_xor_b32 v15, 4, v10
    v_lshlrev_b32 v15, 4, v15
    v_add_u32 v15, v15, v9
    ds_write_b128 v15, v[48:51]
    v_xor_b32 v15, 5, v10
    v_lshlrev_b32 v15, 4, v15
    v_add_u32 v15, v15, v9
    ds_write_b128 v15, v[52:55]
    v_xor_b32 v15, 6, v10
    v_lshlrev_b32 v15, 4, v15
    v_add_u32 v15, v15, v9
    ds_write_b128 v15, v[56:59]
    v_xor_b32 v15, 7, v10
    v_lshlrev_b32 v15, 4, v15
    v_add_u32 v15, v15, v9
    ds_write_b128 v15, v[60:63]
    s_waitcnt lgkmcnt(0)
    ds_read_b128 v[32:35], v13 offset:0
    ds_read_b128 v[36:39], v13 offset:1024
    ds_read_b128 v[40:43], v13 offset:2048
    ds_read_b128 v[44:47], v13 offset:3072
    ds_read_b128 v[48:51], v13 offset:4096
    ds_read_b128 v[52:55], v13 offset:5120
    ds_read_b128 v[56:59], v13 offset:6144
    ds_read_b128 v[60:63], v13 offset:7168
    s_waitcnt lgkmcnt(7)
    buffer_store_dwordx4 v[32:35], v8, s[16:19], s55 offen
    s_add_u32 s55, s55, 18432
    s_waitcnt lgkmcnt(6)
    buffer_store_dwordx4 v[36:39], v8, s[16:19], s55 offen
    s_add_u32 s55, s55, 18432
    s_waitcnt lgkmcnt(5)
    buffer_store_dwordx4 v[40:43], v8, s[16:19], s55 offen
    s_add_u32 s55, s55, 18432
    s_waitcnt lgkmcnt(4)
    buffer_store_dwordx4 v[44:47], v8, s[16:19], s55 offen
    s_add_u32 s55, s55, 18432
    s_waitcnt lgkmcnt(3)
    buffer_store_dwordx4 v[48:51], v8, s[16:19], s55 offen
    s_add_u32 s55, s55, 18432
    s_waitcnt lgkmcnt(2)
    buffer_store_dwordx4 v[52:55], v8, s[16:19], s55 offen
    s_add_u32 s55, s55, 18432
    s_waitcnt lgkmcnt(1)
    buffer_store_dwordx4 v[56:59], v8, s[16:19], s55 offen
    s_add_u32 s55, s55, 18432
    s_waitcnt lgkmcnt(0)
    buffer_store_dwordx4 v[60:63], v8, s[16:19], s55 offen
    s_add_u32 s55, s55, 18432
    s_add_u32 s47, s47, 256
    s_cmp_lt_u32 s47, 288
    s_cbranch_scc0 L_yd_200025
    s_nop 1
    s_branch L_yl_200026

L_yd_200025:
L_ny_200022:
    s_and_b32 s40, s27, 3
    s_mul_i32 s41, s40, 9
    s_add_u32 s41, s41, 1
    s_lshr_b32 s41, s41, 1

    s_sub_u32 s42, s24, 8
    s_mov_b32 s44, s42
    s_add_u32 s42, s42, s41
    s_mul_i32 s43, s42, 36864
    s_add_u32 s43, s43, 30408704
    v_lshlrev_b32 v5, 4, v2

    buffer_load_dwordx4 v[24:27], v5, s[20:23], s43 offen offset:0
    buffer_load_dwordx4 v[28:31], v5, s[20:23], s43 offen offset:1024
    buffer_load_dwordx4 v[32:35], v5, s[20:23], s43 offen offset:2048
    buffer_load_dwordx4 v[36:39], v5, s[20:23], s43 offen offset:3072
    s_add_u32 s43, s43, 4096
    buffer_load_dwordx4 v[40:43], v5, s[20:23], s43 offen offset:0
    buffer_load_dwordx4 v[44:47], v5, s[20:23], s43 offen offset:1024
    buffer_load_dwordx4 v[48:51], v5, s[20:23], s43 offen offset:2048
    buffer_load_dwordx4 v[52:55], v5, s[20:23], s43 offen offset:3072
    s_add_u32 s43, s43, 4096
    buffer_load_dwordx4 v[56:59], v5, s[20:23], s43 offen offset:0
    buffer_load_dwordx4 v[60:63], v5, s[20:23], s43 offen offset:1024
    buffer_load_dwordx4 v[64:67], v5, s[20:23], s43 offen offset:2048
    buffer_load_dwordx4 v[68:71], v5, s[20:23], s43 offen offset:3072
    s_add_u32 s43, s43, 4096
    buffer_load_dwordx4 v[72:75], v5, s[20:23], s43 offen offset:0
    buffer_load_dwordx4 v[76:79], v5, s[20:23], s43 offen offset:1024
    buffer_load_dwordx4 v[80:83], v5, s[20:23], s43 offen offset:2048
    buffer_load_dwordx4 v[84:87], v5, s[20:23], s43 offen offset:3072
    s_add_u32 s43, s43, 4096
    buffer_load_dwordx4 v[88:91], v5, s[20:23], s43 offen offset:0
    buffer_load_dwordx4 v[92:95], v5, s[20:23], s43 offen offset:1024
    buffer_load_dwordx4 v[96:99], v5, s[20:23], s43 offen offset:2048
    buffer_load_dwordx4 v[100:103], v5, s[20:23], s43 offen offset:3072
    s_add_u32 s43, s43, 4096
    buffer_load_dwordx4 v[104:107], v5, s[20:23], s43 offen offset:0
    buffer_load_dwordx4 v[108:111], v5, s[20:23], s43 offen offset:1024
    buffer_load_dwordx4 v[112:115], v5, s[20:23], s43 offen offset:2048
    buffer_load_dwordx4 v[116:119], v5, s[20:23], s43 offen offset:3072
    s_add_u32 s43, s43, 4096
    buffer_load_dwordx4 v[120:123], v5, s[20:23], s43 offen offset:0
    buffer_load_dwordx4 v[124:127], v5, s[20:23], s43 offen offset:1024
    buffer_load_dwordx4 v[128:131], v5, s[20:23], s43 offen offset:2048
    buffer_load_dwordx4 v[132:135], v5, s[20:23], s43 offen offset:3072
    s_add_u32 s43, s43, 4096
    buffer_load_dwordx4 v[136:139], v5, s[20:23], s43 offen offset:0
    buffer_load_dwordx4 v[140:143], v5, s[20:23], s43 offen offset:1024
    buffer_load_dwordx4 v[144:147], v5, s[20:23], s43 offen offset:2048
    buffer_load_dwordx4 v[148:151], v5, s[20:23], s43 offen offset:3072
    s_add_u32 s43, s43, 4096
    buffer_load_dwordx4 v[152:155], v5, s[20:23], s43 offen offset:0
    buffer_load_dwordx4 v[156:159], v5, s[20:23], s43 offen offset:1024
    buffer_load_dwordx4 v[160:163], v5, s[20:23], s43 offen offset:2048
    buffer_load_dwordx4 v[164:167], v5, s[20:23], s43 offen offset:3072
    s_setprio 0
    s_mov_b32 s45, 1
    s_branch L_b3_200027
L_k2_kernel_post2:
    s_mov_b32 s45, 0
    s_cmp_lg_u32 s24, 1
    s_cbranch_scc1 L_n5_200028
    s_and_b32 s40, s27, 1
    s_cmp_lg_u32 s40, 0
    s_cbranch_scc1 L_n5_200028

    s_and_b32 s40, s27, 3
    s_mul_i32 s41, s40, 9
    s_add_u32 s41, s41, 1
    s_lshr_b32 s41, s41, 1

    s_add_u32 s42, s41, 4
    s_mul_i32 s43, s42, 36864
    s_add_u32 s43, s43, 30408704
    v_lshlrev_b32 v5, 4, v2

    buffer_load_dwordx4 v[24:27], v5, s[20:23], s43 offen offset:0
    buffer_load_dwordx4 v[28:31], v5, s[20:23], s43 offen offset:1024
    buffer_load_dwordx4 v[32:35], v5, s[20:23], s43 offen offset:2048
    buffer_load_dwordx4 v[36:39], v5, s[20:23], s43 offen offset:3072
    s_add_u32 s43, s43, 4096
    buffer_load_dwordx4 v[40:43], v5, s[20:23], s43 offen offset:0
    buffer_load_dwordx4 v[44:47], v5, s[20:23], s43 offen offset:1024
    buffer_load_dwordx4 v[48:51], v5, s[20:23], s43 offen offset:2048
    buffer_load_dwordx4 v[52:55], v5, s[20:23], s43 offen offset:3072
    s_add_u32 s43, s43, 4096
    buffer_load_dwordx4 v[56:59], v5, s[20:23], s43 offen offset:0
    buffer_load_dwordx4 v[60:63], v5, s[20:23], s43 offen offset:1024
    buffer_load_dwordx4 v[64:67], v5, s[20:23], s43 offen offset:2048
    buffer_load_dwordx4 v[68:71], v5, s[20:23], s43 offen offset:3072
    s_add_u32 s43, s43, 4096
    buffer_load_dwordx4 v[72:75], v5, s[20:23], s43 offen offset:0
    buffer_load_dwordx4 v[76:79], v5, s[20:23], s43 offen offset:1024
    buffer_load_dwordx4 v[80:83], v5, s[20:23], s43 offen offset:2048
    buffer_load_dwordx4 v[84:87], v5, s[20:23], s43 offen offset:3072
    s_add_u32 s43, s43, 4096
    buffer_load_dwordx4 v[88:91], v5, s[20:23], s43 offen offset:0
    buffer_load_dwordx4 v[92:95], v5, s[20:23], s43 offen offset:1024
    buffer_load_dwordx4 v[96:99], v5, s[20:23], s43 offen offset:2048
    buffer_load_dwordx4 v[100:103], v5, s[20:23], s43 offen offset:3072
    s_add_u32 s43, s43, 4096
    buffer_load_dwordx4 v[104:107], v5, s[20:23], s43 offen offset:0
    buffer_load_dwordx4 v[108:111], v5, s[20:23], s43 offen offset:1024
    buffer_load_dwordx4 v[112:115], v5, s[20:23], s43 offen offset:2048
    buffer_load_dwordx4 v[116:119], v5, s[20:23], s43 offen offset:3072
    s_add_u32 s43, s43, 4096
    buffer_load_dwordx4 v[120:123], v5, s[20:23], s43 offen offset:0
    buffer_load_dwordx4 v[124:127], v5, s[20:23], s43 offen offset:1024
    buffer_load_dwordx4 v[128:131], v5, s[20:23], s43 offen offset:2048
    buffer_load_dwordx4 v[132:135], v5, s[20:23], s43 offen offset:3072
    s_add_u32 s43, s43, 4096
    buffer_load_dwordx4 v[136:139], v5, s[20:23], s43 offen offset:0
    buffer_load_dwordx4 v[140:143], v5, s[20:23], s43 offen offset:1024
    buffer_load_dwordx4 v[144:147], v5, s[20:23], s43 offen offset:2048
    buffer_load_dwordx4 v[148:151], v5, s[20:23], s43 offen offset:3072
    s_add_u32 s43, s43, 4096
    buffer_load_dwordx4 v[152:155], v5, s[20:23], s43 offen offset:0
    buffer_load_dwordx4 v[156:159], v5, s[20:23], s43 offen offset:1024
    buffer_load_dwordx4 v[160:163], v5, s[20:23], s43 offen offset:2048
    buffer_load_dwordx4 v[164:167], v5, s[20:23], s43 offen offset:3072
    s_mov_b32 s45, 1
L_n5_200028:
L_b3_200027:
    s_cmp_ge_u32 s24, 8
    s_cbranch_scc1 L_sk3_200029
    v_mov_b32 v12, 73884
    v_mov_b32 v13, 0x10000
    s_mov_b64 exec, 1
    ds_add_u32 v12, v13
    s_mov_b64 exec, -1

    s_cmp_lg_u32 s24, 0
    s_cbranch_scc1 L_sk3_200029
    v_mov_b32 v12, 73884
L_sw_200030:
    ds_read_b32 v13, v12
    s_waitcnt lgkmcnt(0)
    v_readfirstlane_b32 s49, v13
    s_sleep 0
    s_cmp_lt_u32 s49, 524288
    s_cbranch_scc1 L_sw_200030

L_sk3_200029:
    s_cmp_lg_u32 s24, 0
    s_cbranch_scc1 L_np_200031
    s_lshl_b32 s46, s28, 8
    s_add_u32 s46, s46, 31457280
    v_mov_b32 v12, 0
    v_mov_b32 v13, 1
    s_mov_b64 exec, 1

    buffer_atomic_add v13, v12, s[20:23], s46 offen sc1
    s_mov_b32 s47, 0

L_pl_200032:
    v_mov_b32 v14, 0
    s_add_u32 s47, s47, 1
    buffer_atomic_add v14, v12, s[20:23], s46 offen sc0 sc1
    s_waitcnt vmcnt(0)
    v_readfirstlane_b32 s48, v14
    s_cmp_ge_u32 s48, 32
    s_cbranch_scc1 L_pl_200032x
    s_sleep 4
    s_cmp_lt_u32 s47, 100000
    s_cbranch_scc1 L_pl_200032

L_pl_200032x:
    v_mov_b32 v12, 73924
    v_mov_b32 v13, 0x10000
    s_mov_b64 exec, 1
    ds_add_u32 v12, v13
    s_mov_b64 exec, -1

    s_branch L_k2_kernel_fin
L_np_200031:
    s_sub_u32 s46, s24, 2
    s_cmp_ge_u32 s46, 2
    s_cbranch_scc1 L_nt_200033
    s_lshl_b32 s47, s46, 8
    s_add_u32 s47, s47, s2
    s_cmp_ge_u32 s47, 288
    s_cbranch_scc1 L_k2_kernel_fin

    s_branch L_k2_kernel_fin
L_nt_200033:
    s_sub_u32 s46, s24, 4
    s_cmp_ge_u32 s46, 4
    s_cbranch_scc1 L_nd_200034
    s_lshl_b32 s47, s28, 3
    s_lshr_b32 s48, s27, 2
    s_add_u32 s47, s47, s48
    s_mul_i32 s47, s47, 36864
    s_add_u32 s47, s47, 7471104
    s_mul_i32 s48, s46, 9216
    s_add_u32 s47, s47, s48
    s_mov_b32 m0, s48
    v_lshlrev_b32 v5, 4, v2

    v_mov_b32 v12, 73924
L_sw_200035:
    ds_read_b32 v13, v12
    s_waitcnt lgkmcnt(0)
    v_readfirstlane_b32 s49, v13
    s_sleep 1
    s_cmp_lt_u32 s49, 65536
    s_cbranch_scc1 L_sw_200035

    buffer_load_dwordx4 v5, s[20:23], s47 offen sc1 lds
    s_add_u32 m0, m0, 1024
    s_add_u32 s47, s47, 1024
    buffer_load_dwordx4 v5, s[20:23], s47 offen sc1 lds
    s_add_u32 m0, m0, 1024
    s_add_u32 s47, s47, 1024
    buffer_load_dwordx4 v5, s[20:23], s47 offen sc1 lds
    s_add_u32 m0, m0, 1024
    s_add_u32 s47, s47, 1024
    buffer_load_dwordx4 v5, s[20:23], s47 offen sc1 lds
    s_add_u32 m0, m0, 1024
    s_add_u32 s47, s47, 1024
    buffer_load_dwordx4 v5, s[20:23], s47 offen sc1 lds
    s_add_u32 m0, m0, 1024
    s_add_u32 s47, s47, 1024
    buffer_load_dwordx4 v5, s[20:23], s47 offen sc1 lds
    s_add_u32 m0, m0, 1024
    s_add_u32 s47, s47, 1024
    buffer_load_dwordx4 v5, s[20:23], s47 offen sc1 lds
    s_add_u32 m0, m0, 1024
    s_add_u32 s47, s47, 1024
    buffer_load_dwordx4 v5, s[20:23], s47 offen sc1 lds
    s_add_u32 m0, m0, 1024
    s_add_u32 s47, s47, 1024
    buffer_load_dwordx4 v5, s[20:23], s47 offen sc1 lds
    s_waitcnt vmcnt(0)
    v_mov_b32 v12, 73964
    v_mov_b32 v13, 0x10000
    s_mov_b64 exec, 1
    ds_add_u32 v12, v13
    s_mov_b64 exec, -1

    s_branch L_k2_kernel_fin
L_nd_200034:
    s_cmp_eq_u32 s45, 0
    s_cbranch_scc1 L_k2_kernel_fin
    v_mov_b32 v12, 73964
L_sw_200036:
    ds_read_b32 v13, v12
    s_waitcnt lgkmcnt(0)
    v_readfirstlane_b32 s49, v13
    s_sleep 1
    s_cmp_lt_u32 s49, 262144
    s_cbranch_scc1 L_sw_200036

    v_lshlrev_b32 v5, 4, v2
    s_waitcnt vmcnt(0)
    v_mov_b32 v3, v5
    v_mov_b32 v1, v5
    ds_read_b128 v[4:7], v1
    s_waitcnt lgkmcnt(0)
    v_mfma_f32_32x32x16_bf16 v[8:23], v[24:27], v[4:7], 0
    ds_read_b128 v[4:7], v1 offset:1024
    ds_read_b128 v[24:27], v1 offset:2048
    v_and_b32 v3, 31, v2
    v_lshlrev_b32 v3, 2, v3
    v_lshrrev_b32 v0, 5, v2
    v_lshlrev_b32 v0, 9, v0
    v_add_u32 v3, v3, v0
    v_add_u32 v3, 32768, v3

    s_waitcnt lgkmcnt(1)
    v_mfma_f32_32x32x16_bf16 v[8:23], v[28:31], v[4:7], v[8:23]
    ds_read_b128 v[28:31], v1 offset:3072
    s_waitcnt lgkmcnt(1)
    v_mfma_f32_32x32x16_bf16 v[8:23], v[32:35], v[24:27], v[8:23]
    ds_read_b128 v[32:35], v1 offset:4096
    s_waitcnt lgkmcnt(1)
    v_mfma_f32_32x32x16_bf16 v[8:23], v[36:39], v[28:31], v[8:23]
    ds_read_b128 v[36:39], v1 offset:5120
    s_waitcnt lgkmcnt(1)
    v_mfma_f32_32x32x16_bf16 v[8:23], v[40:43], v[32:35], v[8:23]
    ds_read_b128 v[40:43], v1 offset:6144
    s_waitcnt lgkmcnt(1)
    v_mfma_f32_32x32x16_bf16 v[8:23], v[44:47], v[36:39], v[8:23]
    ds_read_b128 v[44:47], v1 offset:7168
    s_waitcnt lgkmcnt(1)
    v_mfma_f32_32x32x16_bf16 v[8:23], v[48:51], v[40:43], v[8:23]
    ds_read_b128 v[48:51], v1 offset:8192
    s_waitcnt lgkmcnt(1)
    v_mfma_f32_32x32x16_bf16 v[8:23], v[52:55], v[44:47], v[8:23]
    ds_read_b128 v[52:55], v1 offset:9216
    s_waitcnt lgkmcnt(1)
    v_mfma_f32_32x32x16_bf16 v[8:23], v[56:59], v[48:51], v[8:23]
    ds_read_b128 v[56:59], v1 offset:10240
    s_waitcnt lgkmcnt(1)
    v_mfma_f32_32x32x16_bf16 v[8:23], v[60:63], v[52:55], v[8:23]
    ds_read_b128 v[60:63], v1 offset:11264
    s_waitcnt lgkmcnt(1)
    v_mfma_f32_32x32x16_bf16 v[8:23], v[64:67], v[56:59], v[8:23]
    ds_read_b128 v[64:67], v1 offset:12288
    s_waitcnt lgkmcnt(1)
    v_mfma_f32_32x32x16_bf16 v[8:23], v[68:71], v[60:63], v[8:23]
    ds_read_b128 v[68:71], v1 offset:13312
    s_waitcnt lgkmcnt(1)
    v_mfma_f32_32x32x16_bf16 v[8:23], v[72:75], v[64:67], v[8:23]
    ds_read_b128 v[72:75], v1 offset:14336
    s_waitcnt lgkmcnt(1)
    v_mfma_f32_32x32x16_bf16 v[8:23], v[76:79], v[68:71], v[8:23]
    ds_read_b128 v[76:79], v1 offset:15360
    s_waitcnt lgkmcnt(1)
    v_mfma_f32_32x32x16_bf16 v[8:23], v[80:83], v[72:75], v[8:23]
    ds_read_b128 v[80:83], v1 offset:16384
    s_waitcnt lgkmcnt(1)
    v_mfma_f32_32x32x16_bf16 v[8:23], v[84:87], v[76:79], v[8:23]
    ds_read_b128 v[84:87], v1 offset:17408
    s_waitcnt lgkmcnt(1)
    v_mfma_f32_32x32x16_bf16 v[8:23], v[88:91], v[80:83], v[8:23]
    ds_read_b128 v[88:91], v1 offset:18432
    s_waitcnt lgkmcnt(1)
    v_mfma_f32_32x32x16_bf16 v[8:23], v[92:95], v[84:87], v[8:23]
    ds_read_b128 v[92:95], v1 offset:19456
    s_waitcnt lgkmcnt(1)
    v_mfma_f32_32x32x16_bf16 v[8:23], v[96:99], v[88:91], v[8:23]
    ds_read_b128 v[96:99], v1 offset:20480
    s_waitcnt lgkmcnt(1)
    v_mfma_f32_32x32x16_bf16 v[8:23], v[100:103], v[92:95], v[8:23]
    ds_read_b128 v[100:103], v1 offset:21504
    s_waitcnt lgkmcnt(1)
    v_mfma_f32_32x32x16_bf16 v[8:23], v[104:107], v[96:99], v[8:23]
    ds_read_b128 v[104:107], v1 offset:22528
    s_waitcnt lgkmcnt(1)
    v_mfma_f32_32x32x16_bf16 v[8:23], v[108:111], v[100:103], v[8:23]
    ds_read_b128 v[108:111], v1 offset:23552
    s_waitcnt lgkmcnt(1)
    v_mfma_f32_32x32x16_bf16 v[8:23], v[112:115], v[104:107], v[8:23]
    ds_read_b128 v[112:115], v1 offset:24576
    s_waitcnt lgkmcnt(1)
    v_mfma_f32_32x32x16_bf16 v[8:23], v[116:119], v[108:111], v[8:23]
    ds_read_b128 v[116:119], v1 offset:25600
    s_waitcnt lgkmcnt(1)
    v_mfma_f32_32x32x16_bf16 v[8:23], v[120:123], v[112:115], v[8:23]
    ds_read_b128 v[120:123], v1 offset:26624
    s_waitcnt lgkmcnt(1)
    v_mfma_f32_32x32x16_bf16 v[8:23], v[124:127], v[116:119], v[8:23]
    ds_read_b128 v[124:127], v1 offset:27648
    s_waitcnt lgkmcnt(1)
    v_mfma_f32_32x32x16_bf16 v[8:23], v[128:131], v[120:123], v[8:23]
    ds_read_b128 v[128:131], v1 offset:28672
    s_waitcnt lgkmcnt(1)
    v_mfma_f32_32x32x16_bf16 v[8:23], v[132:135], v[124:127], v[8:23]
    ds_read_b128 v[132:135], v1 offset:29696
    s_waitcnt lgkmcnt(1)
    v_mfma_f32_32x32x16_bf16 v[8:23], v[136:139], v[128:131], v[8:23]
    ds_read_b128 v[136:139], v1 offset:30720
    s_waitcnt lgkmcnt(1)
    v_mfma_f32_32x32x16_bf16 v[8:23], v[140:143], v[132:135], v[8:23]
    ds_read_b128 v[140:143], v1 offset:31744
    s_waitcnt lgkmcnt(1)
    v_mfma_f32_32x32x16_bf16 v[8:23], v[144:147], v[136:139], v[8:23]
    ds_read_b32 v144, v3 offset:0
    ds_read_b32 v145, v3 offset:128
    ds_read_b32 v146, v3 offset:256
    ds_read_b32 v147, v3 offset:384
    s_waitcnt lgkmcnt(4)
    v_mfma_f32_32x32x16_bf16 v[8:23], v[148:151], v[140:143], v[8:23]
    ds_read_b32 v148, v3 offset:1024
    ds_read_b32 v149, v3 offset:1152
    ds_read_b32 v150, v3 offset:1280
    ds_read_b32 v151, v3 offset:1408
    s_waitcnt lgkmcnt(4)
    v_mfma_f32_32x32x16_bf16 v[8:23], v[152:155], v[144:147], v[8:23]
    ds_read_b32 v152, v3 offset:2048
    ds_read_b32 v153, v3 offset:2176
    ds_read_b32 v154, v3 offset:2304
    ds_read_b32 v155, v3 offset:2432
    s_waitcnt lgkmcnt(4)
    v_mfma_f32_32x32x16_bf16 v[8:23], v[156:159], v[148:151], v[8:23]
    ds_read_b32 v156, v3 offset:3072
    ds_read_b32 v157, v3 offset:3200
    ds_read_b32 v158, v3 offset:3328
    ds_read_b32 v159, v3 offset:3456
    s_waitcnt lgkmcnt(4)
    v_mfma_f32_32x32x16_bf16 v[8:23], v[160:163], v[152:155], v[8:23]
    s_waitcnt lgkmcnt(0)
    v_mfma_f32_32x32x16_bf16 v[8:23], v[164:167], v[156:159], v[8:23]
    s_nop 7
    s_nop 3
    v_cvt_pk_bf16_f32 v24, v8, v9
    v_cvt_pk_bf16_f32 v25, v10, v11
    v_cvt_pk_bf16_f32 v26, v12, v13
    v_cvt_pk_bf16_f32 v27, v14, v15
    v_cvt_pk_bf16_f32 v28, v16, v17
    v_cvt_pk_bf16_f32 v29, v18, v19
    v_cvt_pk_bf16_f32 v30, v20, v21
    v_cvt_pk_bf16_f32 v31, v22, v23
    s_lshl_b32 s47, s28, 3
    s_lshr_b32 s48, s27, 2
    s_add_u32 s47, s47, s48
    s_lshl_b32 s47, s47, 5
    v_and_b32 v3, 31, v2
    v_lshrrev_b32 v4, 5, v2
    v_add_u32 v6, s47, v3
    v_mul_u32_u24 v6, 2304, v6
    v_lshlrev_b32 v7, 4, v4
    v_add_u32 v6, v6, v7
    s_lshl_b32 s48, s42, 6
    s_add_u32 s48, s48, 1152
    buffer_store_dwordx4 v[24:27], v6, s[16:19], s48 offen
    buffer_store_dwordx4 v[28:31], v6, s[16:19], s48 offen offset:32

L_k2_kernel_fin:
L_k2_kernel_end:
    s_endpgm
.section .rodata,"a"
.p2align 6
.amdhsa_kernel k1_kernel
  .amdhsa_next_free_vgpr 128
  .amdhsa_next_free_sgpr 102
  .amdhsa_accum_offset 128
  .amdhsa_group_segment_fixed_size 0
  .amdhsa_kernarg_size 120
  .amdhsa_user_sgpr_count 2
  .amdhsa_user_sgpr_kernarg_segment_ptr 1
  .amdhsa_system_sgpr_workgroup_id_x 1
.end_amdhsa_kernel
.section .rodata,"a"
.p2align 6
.amdhsa_kernel k2_kernel
  .amdhsa_next_free_vgpr 168
  .amdhsa_next_free_sgpr 102
  .amdhsa_accum_offset 168
  .amdhsa_group_segment_fixed_size 0
  .amdhsa_kernarg_size 120
  .amdhsa_user_sgpr_count 2
  .amdhsa_user_sgpr_kernarg_segment_ptr 1
  .amdhsa_system_sgpr_workgroup_id_x 1
.end_amdhsa_kernel
```
